```python
import torch

def _softmax(x, axis=-1):
    return torch.softmax(x, dim=axis)
def _gelu(x):
    return torch.nn.functional.gelu(x, approximate="tanh")
def _silu(x):
    return torch.nn.functional.silu(x)
def _sigmoid(x):
    return torch.sigmoid(x)
def _layernorm(x, axis=-1, eps=1e-5):
    m = x.mean(dim=axis, keepdim=True)
    v = x.var(dim=axis, keepdim=True, unbiased=False)
    return (x - m) / torch.sqrt(v + eps)
def _scatter_add(tgt, idx, src, axis=0):
    return tgt.clone().index_add_(axis, idx, src)
def _segment_sum(src, seg, n):
    out = torch.zeros((n,) + src.shape[1:], dtype=src.dtype)
    return out.index_add_(0, seg, src)
def _pad(x, pw):
    flat = tuple(v for pair in reversed(pw) for v in pair)
    return torch.nn.functional.pad(x, flat)

kernel_name = 'recurrent_scan__spectral_fnet__swiglu_ffn__prompt'

def setup_inputs():

    _w = (lambda a: (lambda t: t.to(torch.bfloat16) if t.is_floating_point() else t)(torch.as_tensor(a)))
    def _A_setup():
        B, S, D = 1, 2048, 1024
        ns = torch.arange(S)[:, None] * torch.arange(S)[None, :]
        nd = torch.arange(D)[:, None] * torch.arange(D)[None, :]
        Ws_re = torch.cos(-2.0 * torch.pi * ns / S).to(float)
        Ws_im = torch.sin(-2.0 * torch.pi * ns / S).to(float)
        Wd_re = torch.cos(-2.0 * torch.pi * nd / D).to(float)
        Wd_im = torch.sin(-2.0 * torch.pi * nd / D).to(float)
        return {
            "x": _w((lambda *s: torch.randn(*s, dtype=torch.bfloat16) * 0.05)(B, S, D)),
            "dft_seq_re": _w(Ws_re),
            "dft_seq_im": _w(Ws_im),
            "dft_hid_re": _w(Wd_re),
            "dft_hid_im": _w(Wd_im),
        }
    _A_in = _A_setup()

    def _B_setup():
        B, S, D, F = 1, 2048, 1024, 3584
        return {
            "x": _w((lambda *s: torch.randn(*s, dtype=torch.bfloat16) * 0.05)(B, S, D)),
            "w_gate": _w((lambda *s: torch.randn(*s, dtype=torch.bfloat16) * 0.05)(D, F)),
            "w_up": _w((lambda *s: torch.randn(*s, dtype=torch.bfloat16) * 0.05)(D, F)),
            "w_down": _w((lambda *s: torch.randn(*s, dtype=torch.bfloat16) * 0.05)(F, D)),
        }
    _B_in = _B_setup()

    return {
        "A_x": _A_in["x"],
        "A_dft_seq_re": _A_in["dft_seq_re"],
        "A_dft_seq_im": _A_in["dft_seq_im"],
        "A_dft_hid_re": _A_in["dft_hid_re"],
        "A_dft_hid_im": _A_in["dft_hid_im"],
        "B_x": _B_in["x"],
        "B_w_gate": _B_in["w_gate"],
        "B_w_up": _B_in["w_up"],
        "B_w_down": _B_in["w_down"],
    }

def reference(A_x, A_dft_seq_re, A_dft_seq_im, A_dft_hid_re, A_dft_hid_im, B_x, B_w_gate, B_w_up, B_w_down):
    def _A_ref(x, dft_seq_re, dft_seq_im, dft_hid_re, dft_hid_im):
        a = torch.einsum("bsd,ed->bse", x, dft_hid_re)
        b = torch.einsum("bsd,ed->bse", x, dft_hid_im)
        y = torch.einsum("ts,bse->bte", dft_seq_re, a) - torch.einsum("ts,bse->bte", dft_seq_im, b)
        return y

    def _B_ref(x, w_gate, w_up, w_down):
        g = _silu(x @ w_gate)
        u = x @ w_up
        return (g * u) @ w_down

    x = A_x
    xn = _layernorm(x, axis=-1)
    s = _A_ref(xn, A_dft_seq_re, A_dft_seq_im, A_dft_hid_re, A_dft_hid_im)
    g = _silu(_B_ref(xn, B_w_gate, B_w_up, B_w_down))
    return x + s * g
```

```asm
; @launch grid=(256,1,1) block=(512,1,1) lds=163840
.amdgcn_target "amdgcn-amd-amdhsa--gfx950"
.text
.globl recurrent_scan__spectral_fnet__swiglu_ffn__prompt_kernel
.p2align 8
.type recurrent_scan__spectral_fnet__swiglu_ffn__prompt_kernel,@function
recurrent_scan__spectral_fnet__swiglu_ffn__prompt_kernel:
    s_cmp_ge_u32 s2, 256
    s_cbranch_scc1 EXIT
    s_load_dwordx2 s[84:85], s[0:1], 0
    s_load_dwordx2 s[86:87], s[0:1], 88
    s_load_dwordx4 s[88:91], s[0:1], 48
    s_load_dwordx4 s[92:95], s[0:1], 64
    v_lshrrev_b32 v1, 6, v0
    v_and_b32 v0, 63, v0
    s_nop 0
    v_readfirstlane_b32 s96, v1
    s_lshr_b32 s98, s2, 3
    s_and_b32 s98, s98, 3
    s_lshl_b32 s98, s98, 1
    s_add_u32 s98, s98, 1
    s_waitcnt lgkmcnt(0)
    s_add_u32 s4, s86, 0x3000000
    s_addc_u32 s5, s87, 0
    s_load_dword s97, s[4:5], 0
    s_mov_b32 s80, s4
    s_and_b32 s81, s5, 0xffff
    s_mov_b32 s82, 0x3100
    s_mov_b32 s83, 0x20000
    s_and_b32 s30, s2, 1
    s_lshl_b32 s30, s30, 2
    s_bfe_u32 s31, s2, 0x20001
    s_add_u32 s30, s30, s31
    s_lshl_b32 s30, s30, 5
    s_lshr_b32 s31, s2, 3
    s_add_u32 s29, s30, s31
    v_lshrrev_b32 v2, 4, v0
    v_and_b32 v3, 15, v0
    v_lshlrev_b32 v4, 4, v0
    s_lshl_b32 s30, s29, 3
    s_add_u32 s30, s30, s96
    s_lshl_b32 s31, s30, 11
    s_add_u32 s32, s84, s31
    s_addc_u32 s33, s85, 0
    s_mov_b32 s12, s32
    s_and_b32 s13, s33, 0xffff
    s_mov_b32 s14, 0x800
    s_mov_b32 s15, 0x20000
    buffer_load_dwordx4 v[80:83], v4, s[12:15], 0 offen
    buffer_load_dwordx4 v[84:87], v4, s[12:15], 0 offen offset:1024
    s_add_u32 s32, s86, s31
    s_addc_u32 s33, s87, 0
    s_add_u32 s32, s32, 0x0
    s_addc_u32 s33, s33, 0
    s_mov_b32 s16, s32
    s_and_b32 s17, s33, 0xffff
    s_mov_b32 s18, 0x800
    s_mov_b32 s19, 0x20000
    s_add_u32 s32, s86, 0x400000
    s_addc_u32 s33, s87, 0
    s_mov_b32 s20, s32
    s_and_b32 s21, s33, 0xffff
    s_mov_b32 s22, 0x410000
    s_mov_b32 s23, 0x20000
    s_mov_b32 s40, 0x3d000000
    s_mov_b32 s41, 0x3a800000
    s_mov_b32 s47, 0x80008000
    v_add_u32 v5, 114688, v4
    s_cmp_lg_u32 s96, 0
    s_cbranch_scc1 P1_C1
    v_add_u32 v10, 0, v3
    v_lshlrev_b32 v11, 3, v2
    v_mul_u32_u24 v11, v11, v10
    v_mov_b32 v180, v11
    v_and_b32 v181, 31, v180
    v_add_u32 v180, v180, v10
    v_and_b32 v182, 31, v180
    v_add_u32 v180, v180, v10
    v_and_b32 v183, 31, v180
    v_add_u32 v180, v180, v10
    v_and_b32 v184, 31, v180
    v_add_u32 v180, v180, v10
    v_and_b32 v185, 31, v180
    v_add_u32 v180, v180, v10
    v_and_b32 v186, 31, v180
    v_add_u32 v180, v180, v10
    v_and_b32 v187, 31, v180
    v_add_u32 v180, v180, v10
    v_and_b32 v188, 31, v180
    v_cvt_f32_u32 v181, v181
    v_cvt_f32_u32 v182, v182
    v_cvt_f32_u32 v183, v183
    v_cvt_f32_u32 v184, v184
    v_cvt_f32_u32 v185, v185
    v_cvt_f32_u32 v186, v186
    v_cvt_f32_u32 v187, v187
    v_cvt_f32_u32 v188, v188
    v_mul_f32 v181, s40, v181
    v_mul_f32 v182, s40, v182
    v_mul_f32 v183, s40, v183
    v_mul_f32 v184, s40, v184
    v_mul_f32 v185, s40, v185
    v_mul_f32 v186, s40, v186
    v_mul_f32 v187, s40, v187
    v_mul_f32 v188, s40, v188
    v_cos_f32 v190, v181
    v_cos_f32 v191, v182
    v_cos_f32 v192, v183
    v_cos_f32 v193, v184
    v_cos_f32 v194, v185
    v_cos_f32 v195, v186
    v_cos_f32 v196, v187
    v_cos_f32 v197, v188
    s_nop 0
    v_cvt_pk_bf16_f32 v200, v190, v191
    v_cvt_pk_bf16_f32 v201, v192, v193
    v_cvt_pk_bf16_f32 v202, v194, v195
    v_cvt_pk_bf16_f32 v203, v196, v197
    ds_write_b128 v5, v[200:203] offset:0
    s_branch P1_CDONE
P1_C1:
    s_cmp_lg_u32 s96, 1
    s_cbranch_scc1 P1_C2
    v_add_u32 v10, 16, v3
    v_lshlrev_b32 v11, 3, v2
    v_mul_u32_u24 v11, v11, v10
    v_mov_b32 v180, v11
    v_and_b32 v181, 31, v180
    v_add_u32 v180, v180, v10
    v_and_b32 v182, 31, v180
    v_add_u32 v180, v180, v10
    v_and_b32 v183, 31, v180
    v_add_u32 v180, v180, v10
    v_and_b32 v184, 31, v180
    v_add_u32 v180, v180, v10
    v_and_b32 v185, 31, v180
    v_add_u32 v180, v180, v10
    v_and_b32 v186, 31, v180
    v_add_u32 v180, v180, v10
    v_and_b32 v187, 31, v180
    v_add_u32 v180, v180, v10
    v_and_b32 v188, 31, v180
    v_cvt_f32_u32 v181, v181
    v_cvt_f32_u32 v182, v182
    v_cvt_f32_u32 v183, v183
    v_cvt_f32_u32 v184, v184
    v_cvt_f32_u32 v185, v185
    v_cvt_f32_u32 v186, v186
    v_cvt_f32_u32 v187, v187
    v_cvt_f32_u32 v188, v188
    v_mul_f32 v181, s40, v181
    v_mul_f32 v182, s40, v182
    v_mul_f32 v183, s40, v183
    v_mul_f32 v184, s40, v184
    v_mul_f32 v185, s40, v185
    v_mul_f32 v186, s40, v186
    v_mul_f32 v187, s40, v187
    v_mul_f32 v188, s40, v188
    v_cos_f32 v190, v181
    v_cos_f32 v191, v182
    v_cos_f32 v192, v183
    v_cos_f32 v193, v184
    v_cos_f32 v194, v185
    v_cos_f32 v195, v186
    v_cos_f32 v196, v187
    v_cos_f32 v197, v188
    s_nop 0
    v_cvt_pk_bf16_f32 v200, v190, v191
    v_cvt_pk_bf16_f32 v201, v192, v193
    v_cvt_pk_bf16_f32 v202, v194, v195
    v_cvt_pk_bf16_f32 v203, v196, v197
    ds_write_b128 v5, v[200:203] offset:1024
    s_branch P1_CDONE
P1_C2:
    s_cmp_lg_u32 s96, 2
    s_cbranch_scc1 P1_C3
    v_add_u32 v10, 0, v3
    v_lshlrev_b32 v11, 3, v2
    v_mul_u32_u24 v11, v11, v10
    v_mov_b32 v180, v11
    v_and_b32 v181, 31, v180
    v_add_u32 v180, v180, v10
    v_and_b32 v182, 31, v180
    v_add_u32 v180, v180, v10
    v_and_b32 v183, 31, v180
    v_add_u32 v180, v180, v10
    v_and_b32 v184, 31, v180
    v_add_u32 v180, v180, v10
    v_and_b32 v185, 31, v180
    v_add_u32 v180, v180, v10
    v_and_b32 v186, 31, v180
    v_add_u32 v180, v180, v10
    v_and_b32 v187, 31, v180
    v_add_u32 v180, v180, v10
    v_and_b32 v188, 31, v180
    v_cvt_f32_u32 v181, v181
    v_cvt_f32_u32 v182, v182
    v_cvt_f32_u32 v183, v183
    v_cvt_f32_u32 v184, v184
    v_cvt_f32_u32 v185, v185
    v_cvt_f32_u32 v186, v186
    v_cvt_f32_u32 v187, v187
    v_cvt_f32_u32 v188, v188
    v_mul_f32 v181, s40, v181
    v_mul_f32 v182, s40, v182
    v_mul_f32 v183, s40, v183
    v_mul_f32 v184, s40, v184
    v_mul_f32 v185, s40, v185
    v_mul_f32 v186, s40, v186
    v_mul_f32 v187, s40, v187
    v_mul_f32 v188, s40, v188
    v_sin_f32_e64 v190, -v181
    v_sin_f32_e64 v191, -v182
    v_sin_f32_e64 v192, -v183
    v_sin_f32_e64 v193, -v184
    v_sin_f32_e64 v194, -v185
    v_sin_f32_e64 v195, -v186
    v_sin_f32_e64 v196, -v187
    v_sin_f32_e64 v197, -v188
    s_nop 0
    v_cvt_pk_bf16_f32 v200, v190, v191
    v_cvt_pk_bf16_f32 v201, v192, v193
    v_cvt_pk_bf16_f32 v202, v194, v195
    v_cvt_pk_bf16_f32 v203, v196, v197
    ds_write_b128 v5, v[200:203] offset:2048
    s_branch P1_CDONE
P1_C3:
    s_cmp_lg_u32 s96, 3
    s_cbranch_scc1 P1_C4
    v_add_u32 v10, 16, v3
    v_lshlrev_b32 v11, 3, v2
    v_mul_u32_u24 v11, v11, v10
    v_mov_b32 v180, v11
    v_and_b32 v181, 31, v180
    v_add_u32 v180, v180, v10
    v_and_b32 v182, 31, v180
    v_add_u32 v180, v180, v10
    v_and_b32 v183, 31, v180
    v_add_u32 v180, v180, v10
    v_and_b32 v184, 31, v180
    v_add_u32 v180, v180, v10
    v_and_b32 v185, 31, v180
    v_add_u32 v180, v180, v10
    v_and_b32 v186, 31, v180
    v_add_u32 v180, v180, v10
    v_and_b32 v187, 31, v180
    v_add_u32 v180, v180, v10
    v_and_b32 v188, 31, v180
    v_cvt_f32_u32 v181, v181
    v_cvt_f32_u32 v182, v182
    v_cvt_f32_u32 v183, v183
    v_cvt_f32_u32 v184, v184
    v_cvt_f32_u32 v185, v185
    v_cvt_f32_u32 v186, v186
    v_cvt_f32_u32 v187, v187
    v_cvt_f32_u32 v188, v188
    v_mul_f32 v181, s40, v181
    v_mul_f32 v182, s40, v182
    v_mul_f32 v183, s40, v183
    v_mul_f32 v184, s40, v184
    v_mul_f32 v185, s40, v185
    v_mul_f32 v186, s40, v186
    v_mul_f32 v187, s40, v187
    v_mul_f32 v188, s40, v188
    v_sin_f32_e64 v190, -v181
    v_sin_f32_e64 v191, -v182
    v_sin_f32_e64 v192, -v183
    v_sin_f32_e64 v193, -v184
    v_sin_f32_e64 v194, -v185
    v_sin_f32_e64 v195, -v186
    v_sin_f32_e64 v196, -v187
    v_sin_f32_e64 v197, -v188
    s_nop 0
    v_cvt_pk_bf16_f32 v200, v190, v191
    v_cvt_pk_bf16_f32 v201, v192, v193
    v_cvt_pk_bf16_f32 v202, v194, v195
    v_cvt_pk_bf16_f32 v203, v196, v197
    ds_write_b128 v5, v[200:203] offset:3072
    s_branch P1_CDONE
P1_C4:
    s_cmp_lg_u32 s96, 4
    s_cbranch_scc1 P1_C5
    v_lshlrev_b32 v10, 2, v2
    v_mul_u32_u24 v11, v10, v3
    v_add_u32 v10, 16, v10
    v_mul_u32_u24 v12, v10, v3
    v_mov_b32 v180, v11
    v_and_b32 v181, 31, v180
    v_add_u32 v180, v180, v3
    v_and_b32 v182, 31, v180
    v_add_u32 v180, v180, v3
    v_and_b32 v183, 31, v180
    v_add_u32 v180, v180, v3
    v_and_b32 v184, 31, v180
    v_mov_b32 v180, v12
    v_and_b32 v185, 31, v180
    v_add_u32 v180, v180, v3
    v_and_b32 v186, 31, v180
    v_add_u32 v180, v180, v3
    v_and_b32 v187, 31, v180
    v_add_u32 v180, v180, v3
    v_and_b32 v188, 31, v180
    v_cvt_f32_u32 v181, v181
    v_cvt_f32_u32 v182, v182
    v_cvt_f32_u32 v183, v183
    v_cvt_f32_u32 v184, v184
    v_cvt_f32_u32 v185, v185
    v_cvt_f32_u32 v186, v186
    v_cvt_f32_u32 v187, v187
    v_cvt_f32_u32 v188, v188
    v_mul_f32 v181, s40, v181
    v_mul_f32 v182, s40, v182
    v_mul_f32 v183, s40, v183
    v_mul_f32 v184, s40, v184
    v_mul_f32 v185, s40, v185
    v_mul_f32 v186, s40, v186
    v_mul_f32 v187, s40, v187
    v_mul_f32 v188, s40, v188
    v_cos_f32 v190, v181
    v_cos_f32 v191, v182
    v_cos_f32 v192, v183
    v_cos_f32 v193, v184
    v_cos_f32 v194, v185
    v_cos_f32 v195, v186
    v_cos_f32 v196, v187
    v_cos_f32 v197, v188
    s_nop 0
    v_cvt_pk_bf16_f32 v200, v190, v191
    v_cvt_pk_bf16_f32 v201, v192, v193
    v_cvt_pk_bf16_f32 v202, v194, v195
    v_cvt_pk_bf16_f32 v203, v196, v197
    ds_write_b128 v5, v[200:203] offset:4096
    s_branch P1_CDONE
P1_C5:
    s_cmp_lg_u32 s96, 5
    s_cbranch_scc1 P1_C6
    v_lshlrev_b32 v10, 2, v2
    v_mul_u32_u24 v11, v10, v3
    v_add_u32 v10, 16, v10
    v_mul_u32_u24 v12, v10, v3
    v_mov_b32 v180, v11
    v_and_b32 v181, 31, v180
    v_add_u32 v180, v180, v3
    v_and_b32 v182, 31, v180
    v_add_u32 v180, v180, v3
    v_and_b32 v183, 31, v180
    v_add_u32 v180, v180, v3
    v_and_b32 v184, 31, v180
    v_mov_b32 v180, v12
    v_and_b32 v185, 31, v180
    v_add_u32 v180, v180, v3
    v_and_b32 v186, 31, v180
    v_add_u32 v180, v180, v3
    v_and_b32 v187, 31, v180
    v_add_u32 v180, v180, v3
    v_and_b32 v188, 31, v180
    v_cvt_f32_u32 v181, v181
    v_cvt_f32_u32 v182, v182
    v_cvt_f32_u32 v183, v183
    v_cvt_f32_u32 v184, v184
    v_cvt_f32_u32 v185, v185
    v_cvt_f32_u32 v186, v186
    v_cvt_f32_u32 v187, v187
    v_cvt_f32_u32 v188, v188
    v_mul_f32 v181, s40, v181
    v_mul_f32 v182, s40, v182
    v_mul_f32 v183, s40, v183
    v_mul_f32 v184, s40, v184
    v_mul_f32 v185, s40, v185
    v_mul_f32 v186, s40, v186
    v_mul_f32 v187, s40, v187
    v_mul_f32 v188, s40, v188
    v_sin_f32_e64 v190, -v181
    v_sin_f32_e64 v191, -v182
    v_sin_f32_e64 v192, -v183
    v_sin_f32_e64 v193, -v184
    v_sin_f32_e64 v194, -v185
    v_sin_f32_e64 v195, -v186
    v_sin_f32_e64 v196, -v187
    v_sin_f32_e64 v197, -v188
    s_nop 0
    v_cvt_pk_bf16_f32 v200, v190, v191
    v_cvt_pk_bf16_f32 v201, v192, v193
    v_cvt_pk_bf16_f32 v202, v194, v195
    v_cvt_pk_bf16_f32 v203, v196, v197
    ds_write_b128 v5, v[200:203] offset:5120
    s_branch P1_CDONE
P1_C6:
    s_cmp_lg_u32 s96, 6
    s_cbranch_scc1 P1_C7
    v_add_u32 v10, 0, v3
    v_lshlrev_b32 v11, 2, v2
    v_add_u32 v11, 0, v11
    v_mul_u32_u24 v11, v11, v10
    v_mov_b32 v181, v11
    v_add_u32 v182, v181, v10
    v_add_u32 v183, v182, v10
    v_add_u32 v184, v183, v10
    v_cvt_f32_u32 v181, v181
    v_cvt_f32_u32 v182, v182
    v_cvt_f32_u32 v183, v183
    v_cvt_f32_u32 v184, v184
    v_mul_f32 v181, s41, v181
    v_mul_f32 v182, s41, v182
    v_mul_f32 v183, s41, v183
    v_mul_f32 v184, s41, v184
    v_cos_f32 v192, v181
    v_cos_f32 v193, v182
    v_cos_f32 v194, v183
    v_cos_f32 v195, v184
    v_sin_f32_e64 v196, -v181
    v_sin_f32_e64 v197, -v182
    v_sin_f32_e64 v198, -v183
    v_sin_f32_e64 v199, -v184
    s_nop 0
    ds_write_b128 v5, v[192:195] offset:6144
    ds_write_b128 v5, v[196:199] offset:10240
    v_add_u32 v10, 16, v3
    v_lshlrev_b32 v11, 2, v2
    v_add_u32 v11, 0, v11
    v_mul_u32_u24 v11, v11, v10
    v_mov_b32 v181, v11
    v_add_u32 v182, v181, v10
    v_add_u32 v183, v182, v10
    v_add_u32 v184, v183, v10
    v_cvt_f32_u32 v181, v181
    v_cvt_f32_u32 v182, v182
    v_cvt_f32_u32 v183, v183
    v_cvt_f32_u32 v184, v184
    v_mul_f32 v181, s41, v181
    v_mul_f32 v182, s41, v182
    v_mul_f32 v183, s41, v183
    v_mul_f32 v184, s41, v184
    v_cos_f32 v192, v181
    v_cos_f32 v193, v182
    v_cos_f32 v194, v183
    v_cos_f32 v195, v184
    v_sin_f32_e64 v196, -v181
    v_sin_f32_e64 v197, -v182
    v_sin_f32_e64 v198, -v183
    v_sin_f32_e64 v199, -v184
    s_nop 0
    ds_write_b128 v5, v[192:195] offset:7168
    ds_write_b128 v5, v[196:199] offset:11264
    s_branch P1_CDONE
P1_C7:
    s_cmp_lg_u32 s96, 7
    s_cbranch_scc1 P1_C8
    v_add_u32 v10, 0, v3
    v_lshlrev_b32 v11, 2, v2
    v_add_u32 v11, 16, v11
    v_mul_u32_u24 v11, v11, v10
    v_mov_b32 v181, v11
    v_add_u32 v182, v181, v10
    v_add_u32 v183, v182, v10
    v_add_u32 v184, v183, v10
    v_cvt_f32_u32 v181, v181
    v_cvt_f32_u32 v182, v182
    v_cvt_f32_u32 v183, v183
    v_cvt_f32_u32 v184, v184
    v_mul_f32 v181, s41, v181
    v_mul_f32 v182, s41, v182
    v_mul_f32 v183, s41, v183
    v_mul_f32 v184, s41, v184
    v_cos_f32 v192, v181
    v_cos_f32 v193, v182
    v_cos_f32 v194, v183
    v_cos_f32 v195, v184
    v_sin_f32_e64 v196, -v181
    v_sin_f32_e64 v197, -v182
    v_sin_f32_e64 v198, -v183
    v_sin_f32_e64 v199, -v184
    s_nop 0
    ds_write_b128 v5, v[192:195] offset:8192
    ds_write_b128 v5, v[196:199] offset:12288
    v_add_u32 v10, 16, v3
    v_lshlrev_b32 v11, 2, v2
    v_add_u32 v11, 16, v11
    v_mul_u32_u24 v11, v11, v10
    v_mov_b32 v181, v11
    v_add_u32 v182, v181, v10
    v_add_u32 v183, v182, v10
    v_add_u32 v184, v183, v10
    v_cvt_f32_u32 v181, v181
    v_cvt_f32_u32 v182, v182
    v_cvt_f32_u32 v183, v183
    v_cvt_f32_u32 v184, v184
    v_mul_f32 v181, s41, v181
    v_mul_f32 v182, s41, v182
    v_mul_f32 v183, s41, v183
    v_mul_f32 v184, s41, v184
    v_cos_f32 v192, v181
    v_cos_f32 v193, v182
    v_cos_f32 v194, v183
    v_cos_f32 v195, v184
    v_sin_f32_e64 v196, -v181
    v_sin_f32_e64 v197, -v182
    v_sin_f32_e64 v198, -v183
    v_sin_f32_e64 v199, -v184
    s_nop 0
    ds_write_b128 v5, v[192:195] offset:9216
    ds_write_b128 v5, v[196:199] offset:13312
    s_branch P1_CDONE
P1_C8:
P1_CDONE:
    v_mov_b32 v180, 0xbf803f80
    v_cmp_eq_u32 vcc, 0, v3
    s_waitcnt lgkmcnt(0)
    s_add_u32 s97, s97, 1
    s_barrier
    v_cndmask_b32 v76, 0, v180, vcc
    ds_read_b128 v[16:19], v5 offset:0
    ds_read_b128 v[20:23], v5 offset:1024
    ds_read_b128 v[24:27], v5 offset:2048
    ds_read_b128 v[28:31], v5 offset:3072
    ds_read_b128 v[64:67], v5 offset:4096
    ds_read_b128 v[68:71], v5 offset:5120
    ds_read_b128 v[32:35], v5 offset:6144
    ds_read_b128 v[48:51], v5 offset:10240
    ds_read_b128 v[36:39], v5 offset:7168
    ds_read_b128 v[52:55], v5 offset:11264
    ds_read_b128 v[40:43], v5 offset:8192
    ds_read_b128 v[56:59], v5 offset:12288
    ds_read_b128 v[44:47], v5 offset:9216
    ds_read_b128 v[60:63], v5 offset:13312
    v_mov_b32 v77, v76
    v_mov_b32 v78, v76
    v_mov_b32 v79, v76
    s_waitcnt vmcnt(0)
    s_lshl_b32 s36, s2, 3
    s_add_u32 s36, s36, s96
    s_cmp_ge_u32 s36, 1024
    s_cselect_b32 s48, s90, s88
    s_cselect_b32 s49, s91, s89
    s_and_b32 s36, s36, 1023
    s_mul_i32 s36, s36, 2688
    s_add_u32 s36, s36, 0
    s_mov_b32 s52, s48
    s_and_b32 s53, s49, 0xffff
    s_mov_b32 s54, 0x2a0000
    s_mov_b32 s55, 0x20000
    v_lshlrev_b32 v206, 7, v0
    s_mov_b64 exec, 0x1fffff
    buffer_load_dword v207, v206, s[52:55], s36 offen
    s_mov_b64 exec, -1
    s_mov_b32 s42, 0xffff0000
    v_lshlrev_b32 v88, 16, v80
    v_and_b32 v89, s42, v80
    v_lshlrev_b32 v90, 16, v81
    v_and_b32 v91, s42, v81
    v_lshlrev_b32 v92, 16, v82
    v_and_b32 v93, s42, v82
    v_lshlrev_b32 v94, 16, v83
    v_and_b32 v95, s42, v83
    v_lshlrev_b32 v96, 16, v84
    v_and_b32 v97, s42, v84
    v_lshlrev_b32 v98, 16, v85
    v_and_b32 v99, s42, v85
    v_lshlrev_b32 v100, 16, v86
    v_and_b32 v101, s42, v86
    v_lshlrev_b32 v102, 16, v87
    v_and_b32 v103, s42, v87
    v_pk_add_f32 v[180:181], v[88:89], v[90:91]
    v_pk_add_f32 v[182:183], v[92:93], v[94:95]
    v_pk_add_f32 v[184:185], v[96:97], v[98:99]
    v_pk_add_f32 v[186:187], v[100:101], v[102:103]
    v_pk_add_f32 v[180:181], v[180:181], v[182:183]
    v_pk_add_f32 v[184:185], v[184:185], v[186:187]
    v_pk_add_f32 v[180:181], v[180:181], v[184:185]
    v_add_f32 v180, v180, v181
    s_nop 1
    v_add_f32_dpp v180, v180, v180 row_shr:1 row_mask:0xf bank_mask:0xf bound_ctrl:0
    s_nop 1
    v_add_f32_dpp v180, v180, v180 row_shr:2 row_mask:0xf bank_mask:0xf bound_ctrl:0
    s_nop 1
    v_add_f32_dpp v180, v180, v180 row_shr:4 row_mask:0xf bank_mask:0xf bound_ctrl:0
    s_nop 1
    v_add_f32_dpp v180, v180, v180 row_shr:8 row_mask:0xf bank_mask:0xf bound_ctrl:0
    s_nop 1
    v_add_f32_dpp v180, v180, v180 row_bcast:15 row_mask:0xa bank_mask:0xf
    s_nop 1
    v_add_f32_dpp v180, v180, v180 row_bcast:31 row_mask:0xc bank_mask:0xf
    s_nop 1
    v_readlane_b32 s44, v180, 63
    s_nop 1
    v_mov_b32 v188, s44
    v_mul_f32 v188, s41, v188
    v_sub_f32 v190, 0, v188
    v_mov_b32 v191, v190
    v_pk_add_f32 v[192:193], v[88:89], v[190:191]
    v_pk_mul_f32 v[180:181], v[192:193], v[192:193]
    v_pk_add_f32 v[194:195], v[90:91], v[190:191]
    v_pk_mul_f32 v[182:183], v[194:195], v[194:195]
    v_pk_add_f32 v[192:193], v[92:93], v[190:191]
    v_pk_fma_f32 v[180:181], v[192:193], v[192:193], v[180:181]
    v_pk_add_f32 v[194:195], v[94:95], v[190:191]
    v_pk_fma_f32 v[182:183], v[194:195], v[194:195], v[182:183]
    v_pk_add_f32 v[192:193], v[96:97], v[190:191]
    v_pk_fma_f32 v[180:181], v[192:193], v[192:193], v[180:181]
    v_pk_add_f32 v[194:195], v[98:99], v[190:191]
    v_pk_fma_f32 v[182:183], v[194:195], v[194:195], v[182:183]
    v_pk_add_f32 v[192:193], v[100:101], v[190:191]
    v_pk_fma_f32 v[180:181], v[192:193], v[192:193], v[180:181]
    v_pk_add_f32 v[194:195], v[102:103], v[190:191]
    v_pk_fma_f32 v[182:183], v[194:195], v[194:195], v[182:183]
    v_pk_add_f32 v[180:181], v[180:181], v[182:183]
    v_add_f32 v180, v180, v181
    s_nop 1
    v_add_f32_dpp v180, v180, v180 row_shr:1 row_mask:0xf bank_mask:0xf bound_ctrl:0
    s_nop 1
    v_add_f32_dpp v180, v180, v180 row_shr:2 row_mask:0xf bank_mask:0xf bound_ctrl:0
    s_nop 1
    v_add_f32_dpp v180, v180, v180 row_shr:4 row_mask:0xf bank_mask:0xf bound_ctrl:0
    s_nop 1
    v_add_f32_dpp v180, v180, v180 row_shr:8 row_mask:0xf bank_mask:0xf bound_ctrl:0
    s_nop 1
    v_add_f32_dpp v180, v180, v180 row_bcast:15 row_mask:0xa bank_mask:0xf
    s_nop 1
    v_add_f32_dpp v180, v180, v180 row_bcast:31 row_mask:0xc bank_mask:0xf
    s_nop 1
    v_readlane_b32 s45, v180, 63
    v_cvt_pk_bf16_f32 v189, v188, v188
    s_nop 0
    v_mov_b32 v180, s45
    v_mul_f32 v180, s41, v180
    v_cvt_pk_bf16_f32 v180, v180, v180
    v_lshlrev_b32 v180, 16, v180
    v_add_f32 v180, 0x3727c5ac, v180
    v_cvt_pk_bf16_f32 v180, v180, v180
    v_lshlrev_b32 v180, 16, v180
    v_sqrt_f32 v180, v180
    v_lshlrev_b32 v189, 16, v189
    v_cvt_pk_bf16_f32 v180, v180, v180
    v_lshlrev_b32 v180, 16, v180
    v_rcp_f32 v182, v180
    v_sub_f32 v190, 0, v189
    v_mov_b32 v191, v190
    v_mov_b32 v183, v182
    v_pk_add_f32 v[88:89], v[88:89], v[190:191]
    v_pk_add_f32 v[90:91], v[90:91], v[190:191]
    v_pk_add_f32 v[92:93], v[92:93], v[190:191]
    v_pk_add_f32 v[94:95], v[94:95], v[190:191]
    v_pk_add_f32 v[96:97], v[96:97], v[190:191]
    v_pk_add_f32 v[98:99], v[98:99], v[190:191]
    v_pk_add_f32 v[100:101], v[100:101], v[190:191]
    v_pk_add_f32 v[102:103], v[102:103], v[190:191]
    v_cvt_pk_bf16_f32 v80, v88, v89
    v_cvt_pk_bf16_f32 v81, v90, v91
    v_cvt_pk_bf16_f32 v82, v92, v93
    v_cvt_pk_bf16_f32 v83, v94, v95
    v_cvt_pk_bf16_f32 v84, v96, v97
    v_cvt_pk_bf16_f32 v85, v98, v99
    v_cvt_pk_bf16_f32 v86, v100, v101
    v_cvt_pk_bf16_f32 v87, v102, v103
    v_lshlrev_b32 v88, 16, v80
    v_and_b32 v89, s42, v80
    v_lshlrev_b32 v90, 16, v81
    v_and_b32 v91, s42, v81
    v_lshlrev_b32 v92, 16, v82
    v_and_b32 v93, s42, v82
    v_lshlrev_b32 v94, 16, v83
    v_and_b32 v95, s42, v83
    v_lshlrev_b32 v96, 16, v84
    v_and_b32 v97, s42, v84
    v_lshlrev_b32 v98, 16, v85
    v_and_b32 v99, s42, v85
    v_lshlrev_b32 v100, 16, v86
    v_and_b32 v101, s42, v86
    v_lshlrev_b32 v102, 16, v87
    v_and_b32 v103, s42, v87
    v_pk_mul_f32 v[88:89], v[88:89], v[182:183]
    v_pk_mul_f32 v[90:91], v[90:91], v[182:183]
    v_pk_mul_f32 v[92:93], v[92:93], v[182:183]
    v_pk_mul_f32 v[94:95], v[94:95], v[182:183]
    v_pk_mul_f32 v[96:97], v[96:97], v[182:183]
    v_pk_mul_f32 v[98:99], v[98:99], v[182:183]
    v_pk_mul_f32 v[100:101], v[100:101], v[182:183]
    v_pk_mul_f32 v[102:103], v[102:103], v[182:183]
    v_cvt_pk_bf16_f32 v80, v88, v89
    v_cvt_pk_bf16_f32 v81, v90, v91
    v_cvt_pk_bf16_f32 v82, v92, v93
    v_cvt_pk_bf16_f32 v83, v94, v95
    v_cvt_pk_bf16_f32 v84, v96, v97
    v_cvt_pk_bf16_f32 v85, v98, v99
    v_cvt_pk_bf16_f32 v86, v100, v101
    v_cvt_pk_bf16_f32 v87, v102, v103
    buffer_store_dwordx4 v[80:83], v4, s[16:19], 0 offen sc1
    buffer_store_dwordx4 v[84:87], v4, s[16:19], 0 offen offset:1024 sc1
    s_lshl_b32 s30, s96, 11
    s_add_u32 s30, s30, 98304
    v_add_u32 v5, s30, v4
    ds_write_b128 v5, v[80:83]
    ds_write_b128 v5, v[84:87] offset:1024
    v_lshrrev_b32 v6, 2, v0
    v_and_b32 v6, 3, v6
    v_lshlrev_b32 v7, 3, v2
    v_add_u32 v6, v6, v7
    v_lshlrev_b32 v6, 6, v6
    v_and_b32 v7, 3, v0
    v_lshlrev_b32 v7, 3, v7
    v_add3_u32 v6, v6, v7, s30
    ds_read_b64_tr_b16 v[104:105], v6 offset:0
    ds_read_b64_tr_b16 v[106:107], v6 offset:256
    ds_read_b64_tr_b16 v[108:109], v6 offset:32
    ds_read_b64_tr_b16 v[110:111], v6 offset:288
    v_mul_u32_u24 v7, 36, v3
    v_lshlrev_b32 v8, 2, v2
    v_add_u32 v7, v7, v8
    v_lshlrev_b32 v7, 1, v7
    s_mul_i32 s30, s96, 1160
    s_add_u32 s30, s30, 129024
    v_add_u32 v7, s30, v7
    s_waitcnt lgkmcnt(0)
    v_xor_b32 v72, s47, v68
    v_xor_b32 v73, s47, v69
    v_xor_b32 v74, s47, v70
    v_xor_b32 v75, s47, v71
    v_mfma_f32_16x16x32_bf16 v[112:115], v[104:107], v[16:19], 0
    v_mfma_f32_16x16x32_bf16 v[128:131], v[104:107], v[24:27], 0
    v_mfma_f32_16x16x32_bf16 v[116:119], v[104:107], v[20:23], 0
    v_mfma_f32_16x16x32_bf16 v[132:135], v[104:107], v[28:31], 0
    v_mfma_f32_16x16x32_bf16 v[120:123], v[108:111], v[16:19], 0
    v_mfma_f32_16x16x32_bf16 v[136:139], v[108:111], v[24:27], 0
    v_mfma_f32_16x16x32_bf16 v[124:127], v[108:111], v[20:23], 0
    v_mfma_f32_16x16x32_bf16 v[140:143], v[108:111], v[28:31], 0
    s_nop 2
    v_pk_mul_f32 v[180:181], v[128:129], v[48:49]
    v_pk_mul_f32 v[128:129], v[128:129], v[32:33]
    v_pk_fma_f32 v[128:129], v[112:113], v[48:49], v[128:129]
    v_pk_fma_f32 v[112:113], v[112:113], v[32:33], v[180:181] neg_lo:[0,0,1] neg_hi:[0,0,1]
    v_pk_mul_f32 v[180:181], v[130:131], v[50:51]
    v_pk_mul_f32 v[130:131], v[130:131], v[34:35]
    v_pk_fma_f32 v[130:131], v[114:115], v[50:51], v[130:131]
    v_pk_fma_f32 v[114:115], v[114:115], v[34:35], v[180:181] neg_lo:[0,0,1] neg_hi:[0,0,1]
    v_pk_mul_f32 v[180:181], v[132:133], v[52:53]
    v_pk_mul_f32 v[132:133], v[132:133], v[36:37]
    v_pk_fma_f32 v[132:133], v[116:117], v[52:53], v[132:133]
    v_pk_fma_f32 v[116:117], v[116:117], v[36:37], v[180:181] neg_lo:[0,0,1] neg_hi:[0,0,1]
    v_pk_mul_f32 v[180:181], v[134:135], v[54:55]
    v_pk_mul_f32 v[134:135], v[134:135], v[38:39]
    v_pk_fma_f32 v[134:135], v[118:119], v[54:55], v[134:135]
    v_pk_fma_f32 v[118:119], v[118:119], v[38:39], v[180:181] neg_lo:[0,0,1] neg_hi:[0,0,1]
    v_pk_mul_f32 v[180:181], v[136:137], v[56:57]
    v_pk_mul_f32 v[136:137], v[136:137], v[40:41]
    v_pk_fma_f32 v[136:137], v[120:121], v[56:57], v[136:137]
    v_pk_fma_f32 v[120:121], v[120:121], v[40:41], v[180:181] neg_lo:[0,0,1] neg_hi:[0,0,1]
    v_pk_mul_f32 v[180:181], v[138:139], v[58:59]
    v_pk_mul_f32 v[138:139], v[138:139], v[42:43]
    v_pk_fma_f32 v[138:139], v[122:123], v[58:59], v[138:139]
    v_pk_fma_f32 v[122:123], v[122:123], v[42:43], v[180:181] neg_lo:[0,0,1] neg_hi:[0,0,1]
    s_nop 3
    v_pk_mul_f32 v[180:181], v[140:141], v[60:61]
    v_pk_mul_f32 v[140:141], v[140:141], v[44:45]
    v_pk_fma_f32 v[140:141], v[124:125], v[60:61], v[140:141]
    v_pk_fma_f32 v[124:125], v[124:125], v[44:45], v[180:181] neg_lo:[0,0,1] neg_hi:[0,0,1]
    v_pk_mul_f32 v[180:181], v[142:143], v[62:63]
    v_pk_mul_f32 v[142:143], v[142:143], v[46:47]
    v_pk_fma_f32 v[142:143], v[126:127], v[62:63], v[142:143]
    v_pk_fma_f32 v[126:127], v[126:127], v[46:47], v[180:181] neg_lo:[0,0,1] neg_hi:[0,0,1]
    v_cvt_pk_bf16_f32 v144, v112, v113
    v_cvt_pk_bf16_f32 v152, v128, v129
    v_cvt_pk_bf16_f32 v145, v114, v115
    v_cvt_pk_bf16_f32 v153, v130, v131
    v_cvt_pk_bf16_f32 v146, v120, v121
    v_cvt_pk_bf16_f32 v154, v136, v137
    v_cvt_pk_bf16_f32 v147, v122, v123
    v_cvt_pk_bf16_f32 v155, v138, v139
    v_cvt_pk_bf16_f32 v148, v116, v117
    v_cvt_pk_bf16_f32 v156, v132, v133
    v_cvt_pk_bf16_f32 v149, v118, v119
    v_cvt_pk_bf16_f32 v157, v134, v135
    v_cvt_pk_bf16_f32 v150, v124, v125
    v_cvt_pk_bf16_f32 v158, v140, v141
    v_cvt_pk_bf16_f32 v151, v126, v127
    v_cvt_pk_bf16_f32 v159, v142, v143
    s_nop 1
    v_mfma_f32_16x16x32_bf16 v[160:163], v[144:147], v[64:67], 0
    v_mfma_f32_16x16x32_bf16 v[168:171], v[144:147], v[68:71], 0
    v_mfma_f32_16x16x32_bf16 v[164:167], v[148:151], v[64:67], 0
    v_mfma_f32_16x16x32_bf16 v[172:175], v[148:151], v[68:71], 0
    v_mfma_f32_16x16x32_bf16 v[176:179], v[144:147], v[76:79], 0
    v_mfma_f32_16x16x32_bf16 v[160:163], v[152:155], v[72:75], v[160:163]
    v_mfma_f32_16x16x32_bf16 v[168:171], v[152:155], v[64:67], v[168:171]
    v_mfma_f32_16x16x32_bf16 v[164:167], v[156:159], v[72:75], v[164:167]
    v_mfma_f32_16x16x32_bf16 v[172:175], v[156:159], v[64:67], v[172:175]
    s_lshl_b32 s30, s96, 2
    v_add_u32 v8, s30, v2
    v_lshrrev_b32 v9, 1, v8
    v_mul_u32_u24 v9, 72, v9
    v_and_b32 v10, 1, v8
    v_lshlrev_b32 v10, 5, v10
    v_add_u32 v9, v9, v10
    v_and_b32 v10, 3, v0
    v_lshlrev_b32 v10, 3, v10
    v_add_u32 v9, v9, v10
    v_lshrrev_b32 v10, 2, v0
    v_and_b32 v10, 3, v10
    v_mul_u32_u24 v10, 1160, v10
    v_add_u32 v9, v9, v10
    v_add_u32 v9, 129024, v9
    v_lshrrev_b32 v10, 1, v8
    v_lshlrev_b32 v10, 5, v10
    v_and_b32 v11, 1, v8
    v_lshlrev_b32 v11, 4, v11
    v_add3_u32 v8, v10, v11, v3
    v_lshlrev_b32 v8, 4, v8
    v_cvt_pk_bf16_f32 v180, v160, v161
    v_cvt_pk_bf16_f32 v181, v162, v163
    v_cvt_pk_bf16_f32 v182, v164, v165
    v_cvt_pk_bf16_f32 v183, v166, v167
    v_cvt_pk_bf16_f32 v184, v168, v169
    v_cvt_pk_bf16_f32 v185, v170, v171
    v_cvt_pk_bf16_f32 v186, v172, v173
    v_cvt_pk_bf16_f32 v187, v174, v175
    v_cvt_pk_bf16_f32 v188, v176, v176
    ds_write_b64 v7, v[180:181] offset:0
    ds_write_b64 v7, v[182:183] offset:32
    ds_write_b64 v7, v[184:185] offset:9280
    ds_write_b64 v7, v[186:187] offset:9312
    v_cmp_eq_u32 vcc, 0, v0
    s_and_saveexec_b64 s[34:35], vcc
    v_mov_b32 v189, 0
    ds_write_b16 v7, v188 offset:1152
    ds_write_b16 v7, v189 offset:10432
    s_mov_b64 exec, s[34:35]
    s_mul_i32 s30, s29, 16640
    s_add_u32 s31, s30, 8320
    s_lshl_b32 s32, s29, 2
    s_add_u32 s33, s32, 128
    s_waitcnt vmcnt(0) lgkmcnt(0)
    s_barrier
    s_cmp_lg_u32 s96, s98
    s_cbranch_scc1 SIG_1
    v_mov_b32 v196, s97
    v_mov_b32 v197, s33
    s_mov_b64 exec, 1
    buffer_store_dword v196, v197, s[80:83], 0 offen sc0 sc1
    s_mov_b64 exec, -1
SIG_1:
    ds_read_b64_tr_b16 v[180:181], v9 offset:0
    ds_read_b64_tr_b16 v[182:183], v9 offset:4640
    ds_read_b64_tr_b16 v[184:185], v9 offset:9280
    ds_read_b64_tr_b16 v[186:187], v9 offset:13920
    s_waitcnt lgkmcnt(2)
    buffer_store_dwordx4 v[180:183], v8, s[20:23], s30 offen sc1
    s_waitcnt lgkmcnt(0)
    buffer_store_dwordx4 v[184:187], v8, s[20:23], s31 offen sc1
    s_cmp_lg_u32 s96, 0
    s_cbranch_scc1 P1_NOSP
    v_cmp_gt_u32 vcc, 8, v0
    s_and_saveexec_b64 s[34:35], vcc
    v_mul_u32_u24 v9, 1160, v0
    v_add_u32 v9, 130176, v9
    ds_read_u16 v188, v9
    v_lshlrev_b32 v8, 1, v0
    v_add_u32 v8, 0x2000, v8
    v_mov_b32 v189, 0
    s_waitcnt lgkmcnt(0)
    buffer_store_short v188, v8, s[20:23], s30 offen sc1
    buffer_store_short v189, v8, s[20:23], s31 offen sc1
    s_mov_b64 exec, s[34:35]
P1_NOSP:
    s_waitcnt lgkmcnt(0)
    s_add_u32 s59, s32, 1152
    s_cmp_ge_u32 s2, 224
    s_cbranch_scc1 ROLE_FFT
    s_and_b32 s36, s2, 7
    s_lshr_b32 s37, s2, 3
    s_and_b32 s38, s36, 1
    s_lshl_b32 s38, s38, 2
    s_and_b32 s39, s37, 3
    s_add_u32 s29, s38, s39
    s_lshr_b32 s38, s36, 1
    s_mul_i32 s38, s38, 7
    s_lshr_b32 s39, s37, 2
    s_add_u32 s30, s38, s39
    v_lshrrev_b32 v40, 4, v0
    s_and_b32 s36, s96, 1
    s_lshl_b32 s36, s36, 2
    v_or_b32 v41, s36, v40
    v_lshlrev_b32 v41, 1, v41
    v_and_b32 v42, 15, v0
    v_xor_b32 v41, v41, v42
    v_lshlrev_b32 v41, 4, v41
    s_lshl_b32 s36, s96, 3
    v_add_u32 v43, s36, v40
    v_mul_u32_u24 v43, 7168, v43
    v_add_u32 v2, v43, v41
    v_add_u32 v3, 0x6c00, v2
    v_lshrrev_b32 v41, 3, v0
    s_lshl_b32 s36, s96, 5
    v_add_u32 v41, s36, v41
    v_lshlrev_b32 v41, 11, v41
    v_and_b32 v42, 7, v0
    v_xor_b32 v42, v42, v40
    v_lshlrev_b32 v42, 4, v42
    v_add_u32 v4, v41, v42
    v_xor_b32 v5, 64, v4
    v_add_u32 v6, 0x7800, v4
    v_add_u32 v7, 0xb400, v5
    v_add_u32 v5, 0x3c00, v5
    s_lshl_b32 s34, s96, 11
    s_lshl_b32 s35, s96, 12
    s_mov_b32 s32, 0xe0000
    s_mov_b32 s33, 0
    s_lshl_b32 s36, s29, 19
    s_lshl_b32 s37, s30, 8
    s_add_u32 s40, s88, s37
    s_addc_u32 s41, s89, 0
    s_sub_u32 s38, 0x700000, s37
    s_mov_b32 s16, s40
    s_and_b32 s17, s41, 0xffff
    s_mov_b32 s18, s38
    s_mov_b32 s19, 0x20000
    s_add_u32 s40, s90, s37
    s_addc_u32 s41, s91, 0
    s_mov_b32 s20, s40
    s_and_b32 s21, s41, 0xffff
    s_mov_b32 s22, s38
    s_mov_b32 s23, 0x20000
    s_cmp_eq_u32 s96, s98
    s_cbranch_scc1 G_W01_SKIP
    s_mov_b32 s39, 0
    s_add_u32 m0, s34, 0x0
    s_nop 0
    buffer_load_dwordx4 v2, s[16:19], s39 offen offset:0 lds
    buffer_load_dwordx4 v3, s[16:19], s39 offen offset:1024 lds
    s_add_u32 m0, s34, 0x4000
    s_nop 0
    buffer_load_dwordx4 v2, s[20:23], s39 offen offset:0 lds
    buffer_load_dwordx4 v3, s[20:23], s39 offen offset:1024 lds
    s_add_u32 s39, s39, 0x70000
    s_add_u32 m0, s34, 0x10000
    s_nop 0
    buffer_load_dwordx4 v2, s[16:19], s39 offen offset:0 lds
    buffer_load_dwordx4 v3, s[16:19], s39 offen offset:1024 lds
    s_add_u32 m0, s34, 0x14000
    s_nop 0
    buffer_load_dwordx4 v2, s[20:23], s39 offen offset:0 lds
    buffer_load_dwordx4 v3, s[20:23], s39 offen offset:1024 lds
    s_add_u32 s39, s39, 0x70000
G_W01_SKIP:
    s_add_u32 s40, s86, s36
    s_addc_u32 s41, s87, 0
    s_add_u32 s40, s40, 0x0
    s_addc_u32 s41, s41, 0
    s_mov_b32 s12, s40
    s_and_b32 s13, s41, 0xffff
    s_mov_b32 s14, 0x80000
    s_mov_b32 s15, 0x20000
    s_mul_i32 s38, s29, 0x1c0000
    s_add_u32 s38, s38, s37
    s_add_u32 s40, s86, s38
    s_addc_u32 s41, s87, 0
    s_add_u32 s40, s40, 0x1000000
    s_addc_u32 s41, s41, 0
    s_mov_b32 s24, s40
    s_and_b32 s25, s41, 0xffff
    s_mov_b32 s26, 0x1be500
    s_mov_b32 s27, 0x20000
    v_lshrrev_b32 v41, 2, v0
    v_and_b32 v41, 3, v41
    v_lshlrev_b32 v42, 3, v40
    v_add_u32 v42, v42, v41
    v_lshlrev_b32 v42, 8, v42
    v_and_b32 v43, 1, v40
    v_lshlrev_b32 v43, 2, v43
    v_or_b32 v43, v43, v41
    v_and_b32 v44, 3, v0
    v_lshlrev_b32 v44, 3, v44
    v_add_u32 v42, v42, v44
    s_and_b32 s36, s96, 3
    s_lshl_b32 s36, s36, 1
    v_xor_b32 v44, s36, v43
    v_lshlrev_b32 v44, 5, v44
    v_add_u32 v8, v42, v44
    s_add_u32 s36, s36, 1
    v_xor_b32 v44, s36, v43
    v_lshlrev_b32 v44, 5, v44
    v_add_u32 v9, v42, v44
    v_and_b32 v41, 15, v0
    v_lshrrev_b32 v42, 1, v41
    v_xor_b32 v42, v42, v40
    v_lshlrev_b32 v42, 4, v42
    s_lshr_b32 s36, s96, 2
    s_lshl_b32 s36, s36, 14
    v_lshlrev_b32 v41, 7, v41
    v_add_u32 v41, s36, v41
    v_add_u32 v14, v41, v42
    v_xor_b32 v15, 64, v14
    v_add_u32 v10, 0x10000, v8
    v_add_u32 v16, 0x10000, v14
    v_add_u32 v11, 0x10000, v9
    v_add_u32 v17, 0x10000, v15
    v_add_u32 v12, 0x20000, v8
    v_add_u32 v18, 0x20000, v14
    v_add_u32 v13, 0x20000, v9
    v_add_u32 v19, 0x20000, v15
    v_and_b32 v41, 15, v0
    s_lshr_b32 s36, s96, 2
    s_lshl_b32 s36, s36, 7
    v_add_u32 v41, s36, v41
    v_mul_u32_u24 v41, 7168, v41
    v_and_b32 v42, 1, v40
    v_lshlrev_b32 v42, 5, v42
    v_lshrrev_b32 v43, 1, v40
    v_lshlrev_b32 v43, 4, v43
    v_add3_u32 v41, v41, v42, v43
    s_and_b32 s36, s96, 3
    s_lshl_b32 s36, s36, 6
    v_add_u32 v1, s36, v41
    s_mov_b32 s40, 0xbfb8aa3b
    s_mov_b32 s41, 0xbfb8aa3b
    s_mov_b32 s42, 1.0
    s_mov_b32 s43, 1.0
    s_mov_b32 s44, 0
    s_lshl_b32 s45, s29, 7
    s_add_u32 s45, s45, 128
    s_waitcnt vmcnt(8)
    s_cmp_lg_u32 s96, s98
    s_cbranch_scc1 POLL_2_END
    v_lshlrev_b32 v31, 2, v0
    v_add_u32 v31, s45, v31
    s_mov_b32 exec_lo, 0xffffffff
    s_mov_b32 exec_hi, 0
    s_mov_b32 s46, 0x20000
POLL_2_0:
    buffer_load_dword v30, v31, s[80:83], 0 offen sc0 sc1
    s_waitcnt vmcnt(0)
    v_cmp_ne_u32 vcc, s97, v30
    s_nop 4
    s_cbranch_vccz POLL_2_0_OK
    s_sleep 1
    s_sub_u32 s46, s46, 1
    s_cmp_lg_u32 s46, 0
    s_cbranch_scc1 POLL_2_0
POLL_2_0_OK:
    s_mov_b64 exec, -1
POLL_2_END:
    s_cmp_lg_u32 s96, s98
    s_cbranch_scc1 G_W01_DONE
    s_mov_b32 s39, 0
    s_add_u32 m0, s34, 0x0
    s_nop 0
    buffer_load_dwordx4 v2, s[16:19], s39 offen offset:0 lds
    buffer_load_dwordx4 v3, s[16:19], s39 offen offset:1024 lds
    s_add_u32 m0, s34, 0x4000
    s_nop 0
    buffer_load_dwordx4 v2, s[20:23], s39 offen offset:0 lds
    buffer_load_dwordx4 v3, s[20:23], s39 offen offset:1024 lds
    s_add_u32 s39, s39, 0x70000
    s_add_u32 m0, s34, 0x10000
    s_nop 0
    buffer_load_dwordx4 v2, s[16:19], s39 offen offset:0 lds
    buffer_load_dwordx4 v3, s[16:19], s39 offen offset:1024 lds
    s_add_u32 m0, s34, 0x14000
    s_nop 0
    buffer_load_dwordx4 v2, s[20:23], s39 offen offset:0 lds
    buffer_load_dwordx4 v3, s[20:23], s39 offen offset:1024 lds
    s_add_u32 s39, s39, 0x70000
G_W01_DONE:
    s_barrier
    s_cmp_lg_u32 s96, s98
    s_cbranch_scc1 SIG_3
    v_mov_b32 v30, s97
    v_mov_b32 v31, s59
    s_mov_b64 exec, 1
    buffer_store_dword v30, v31, s[80:83], 0 offen sc0 sc1
    s_mov_b64 exec, -1
SIG_3:
    s_lshl_b32 s46, s2, 3
    s_add_u32 s46, s46, s96
    s_cmp_ge_u32 s46, 896
    s_cselect_b32 s48, s90, s88
    s_cselect_b32 s49, s91, s89
    s_cselect_b32 s47, 896, 0
    s_sub_u32 s47, s46, s47
    s_mul_i32 s47, s47, 1280
    s_add_u32 s47, s47, 2752512
    s_mov_b32 s52, s48
    s_and_b32 s53, s49, 0xffff
    s_mov_b32 s54, 0x700000
    s_mov_b32 s55, 0x20000
    s_mov_b32 s48, s92
    s_and_b32 s49, s93, 0xffff
    s_mov_b32 s50, 0x700000
    s_mov_b32 s51, 0x20000
    s_lshl_b32 s46, s46, 10
    v_lshlrev_b32 v28, 7, v0
    s_add_u32 m0, s35, 0x8000
    s_nop 0
    buffer_load_dwordx4 v4, s[12:15], s33 offen offset:0 sc1 lds
    buffer_load_dwordx4 v5, s[12:15], s33 offen offset:1024 sc1 lds
    buffer_load_dwordx4 v6, s[12:15], s33 offen offset:2048 sc1 lds
    buffer_load_dwordx4 v7, s[12:15], s33 offen offset:3072 sc1 lds
    s_add_u32 s33, s33, 128
    s_setprio 3
    s_waitcnt vmcnt(0)
    s_barrier
    ds_read_b64_tr_b16 v[32:33], v8 offset:0
    ds_read_b64_tr_b16 v[34:35], v8 offset:1024
    ds_read_b64_tr_b16 v[36:37], v9 offset:0
    ds_read_b64_tr_b16 v[38:39], v9 offset:1024
    ds_read_b64_tr_b16 v[40:41], v8 offset:16384
    ds_read_b64_tr_b16 v[42:43], v8 offset:17408
    ds_read_b64_tr_b16 v[44:45], v9 offset:16384
    ds_read_b64_tr_b16 v[46:47], v9 offset:17408
    ds_read_b128 v[48:51], v14 offset:32768
    ds_read_b128 v[52:55], v14 offset:34816
    ds_read_b128 v[56:59], v14 offset:36864
    ds_read_b128 v[60:63], v14 offset:38912
    ds_read_b128 v[64:67], v14 offset:40960
    ds_read_b128 v[68:71], v14 offset:43008
    ds_read_b128 v[72:75], v14 offset:45056
    ds_read_b128 v[76:79], v14 offset:47104
    s_waitcnt lgkmcnt(0)
    v_mfma_f32_16x16x32_bf16 v[128:131], v[32:35], v[48:51], 0
    s_add_u32 m0, s35, 0x18000
    ds_read_b64_tr_b16 v[80:81], v8 offset:8192
    v_mfma_f32_16x16x32_bf16 v[132:135], v[32:35], v[52:55], 0
    ds_read_b64_tr_b16 v[82:83], v8 offset:9216
    v_mfma_f32_16x16x32_bf16 v[136:139], v[32:35], v[56:59], 0
    buffer_load_dwordx4 v4, s[12:15], s33 offen offset:0 sc1 lds
    ds_read_b64_tr_b16 v[84:85], v9 offset:8192
    v_mfma_f32_16x16x32_bf16 v[140:143], v[32:35], v[60:63], 0
    ds_read_b64_tr_b16 v[86:87], v9 offset:9216
    v_mfma_f32_16x16x32_bf16 v[144:147], v[32:35], v[64:67], 0
    buffer_load_dwordx4 v5, s[12:15], s33 offen offset:1024 sc1 lds
    ds_read_b64_tr_b16 v[88:89], v8 offset:24576
    v_mfma_f32_16x16x32_bf16 v[148:151], v[32:35], v[68:71], 0
    v_mfma_f32_16x16x32_bf16 v[152:155], v[32:35], v[72:75], 0
    buffer_load_dwordx4 v6, s[12:15], s33 offen offset:2048 sc1 lds
    ds_read_b64_tr_b16 v[90:91], v8 offset:25600
    v_mfma_f32_16x16x32_bf16 v[156:159], v[32:35], v[76:79], 0
    ds_read_b64_tr_b16 v[92:93], v9 offset:24576
    v_mfma_f32_16x16x32_bf16 v[160:163], v[36:39], v[48:51], 0
    buffer_load_dwordx4 v7, s[12:15], s33 offen offset:3072 sc1 lds
    ds_read_b64_tr_b16 v[94:95], v9 offset:25600
    v_mfma_f32_16x16x32_bf16 v[164:167], v[36:39], v[52:55], 0
    ds_read_b128 v[96:99], v15 offset:32768
    v_mfma_f32_16x16x32_bf16 v[168:171], v[36:39], v[56:59], 0
    s_add_u32 s33, s33, 128
    ds_read_b128 v[100:103], v15 offset:34816
    v_mfma_f32_16x16x32_bf16 v[172:175], v[36:39], v[60:63], 0
    v_mfma_f32_16x16x32_bf16 v[176:179], v[36:39], v[64:67], 0
    s_add_u32 m0, s34, 0x20000
    ds_read_b128 v[104:107], v15 offset:36864
    v_mfma_f32_16x16x32_bf16 v[180:183], v[36:39], v[68:71], 0
    ds_read_b128 v[108:111], v15 offset:38912
    v_mfma_f32_16x16x32_bf16 v[184:187], v[36:39], v[72:75], 0
    buffer_load_dwordx4 v2, s[16:19], s32 offen offset:0 lds
    ds_read_b128 v[112:115], v15 offset:40960
    v_mfma_f32_16x16x32_bf16 v[188:191], v[36:39], v[76:79], 0
    s_setprio 0
    ds_read_b128 v[116:119], v15 offset:43008
    v_mfma_f32_16x16x32_bf16 v[192:195], v[40:43], v[48:51], 0
    buffer_load_dwordx4 v3, s[16:19], s32 offen offset:1024 lds
    ds_read_b128 v[120:123], v15 offset:45056
    v_mfma_f32_16x16x32_bf16 v[196:199], v[40:43], v[52:55], 0
    v_mfma_f32_16x16x32_bf16 v[200:203], v[40:43], v[56:59], 0
    s_add_u32 m0, s34, 0x24000
    ds_read_b128 v[124:127], v15 offset:47104
    v_mfma_f32_16x16x32_bf16 v[204:207], v[40:43], v[60:63], 0
    v_mfma_f32_16x16x32_bf16 v[208:211], v[40:43], v[64:67], 0
    buffer_load_dwordx4 v2, s[20:23], s32 offen offset:0 lds
    v_mfma_f32_16x16x32_bf16 v[212:215], v[40:43], v[68:71], 0
    v_mfma_f32_16x16x32_bf16 v[216:219], v[40:43], v[72:75], 0
    buffer_load_dwordx4 v3, s[20:23], s32 offen offset:1024 lds
    v_mfma_f32_16x16x32_bf16 v[220:223], v[40:43], v[76:79], 0
    v_mfma_f32_16x16x32_bf16 v[224:227], v[44:47], v[48:51], 0
    s_add_u32 s32, s32, 0x70000
    v_mfma_f32_16x16x32_bf16 v[228:231], v[44:47], v[52:55], 0
    v_mfma_f32_16x16x32_bf16 v[232:235], v[44:47], v[56:59], 0
    s_mov_b64 exec, 0x3ff
    buffer_load_dword v29, v28, s[52:55], s47 offen
    s_mov_b64 exec, -1
    v_mfma_f32_16x16x32_bf16 v[236:239], v[44:47], v[60:63], 0
    v_mfma_f32_16x16x32_bf16 v[240:243], v[44:47], v[64:67], 0
    s_add_u32 s47, s47, 1146880
    v_mfma_f32_16x16x32_bf16 v[244:247], v[44:47], v[68:71], 0
    v_mfma_f32_16x16x32_bf16 v[248:251], v[44:47], v[72:75], 0
    v_mfma_f32_16x16x32_bf16 v[252:255], v[44:47], v[76:79], 0
    s_waitcnt lgkmcnt(0)
    s_setprio 3
    s_waitcnt vmcnt(5)
    s_barrier
    v_mfma_f32_16x16x32_bf16 v[128:131], v[80:83], v[96:99], v[128:131]
    s_add_u32 m0, s35, 0x0
    v_mfma_f32_16x16x32_bf16 v[132:135], v[80:83], v[100:103], v[132:135]
    ds_read_b64_tr_b16 v[32:33], v10 offset:0
    v_mfma_f32_16x16x32_bf16 v[136:139], v[80:83], v[104:107], v[136:139]
    ds_read_b64_tr_b16 v[34:35], v10 offset:1024
    v_mfma_f32_16x16x32_bf16 v[140:143], v[80:83], v[108:111], v[140:143]
    ds_read_b64_tr_b16 v[36:37], v11 offset:0
    v_mfma_f32_16x16x32_bf16 v[144:147], v[80:83], v[112:115], v[144:147]
    buffer_load_dwordx4 v4, s[12:15], s33 offen offset:0 sc1 lds
    ds_read_b64_tr_b16 v[38:39], v11 offset:1024
    v_mfma_f32_16x16x32_bf16 v[148:151], v[80:83], v[116:119], v[148:151]
    ds_read_b64_tr_b16 v[40:41], v10 offset:16384
    v_mfma_f32_16x16x32_bf16 v[152:155], v[80:83], v[120:123], v[152:155]
    v_mfma_f32_16x16x32_bf16 v[156:159], v[80:83], v[124:127], v[156:159]
    ds_read_b64_tr_b16 v[42:43], v10 offset:17408
    v_mfma_f32_16x16x32_bf16 v[160:163], v[84:87], v[96:99], v[160:163]
    buffer_load_dwordx4 v5, s[12:15], s33 offen offset:1024 sc1 lds
    ds_read_b64_tr_b16 v[44:45], v11 offset:16384
    v_mfma_f32_16x16x32_bf16 v[164:167], v[84:87], v[100:103], v[164:167]
    ds_read_b64_tr_b16 v[46:47], v11 offset:17408
    v_mfma_f32_16x16x32_bf16 v[168:171], v[84:87], v[104:107], v[168:171]
    ds_read_b128 v[48:51], v16 offset:32768
    v_mfma_f32_16x16x32_bf16 v[172:175], v[84:87], v[108:111], v[172:175]
    ds_read_b128 v[52:55], v16 offset:34816
    v_mfma_f32_16x16x32_bf16 v[176:179], v[84:87], v[112:115], v[176:179]
    buffer_load_dwordx4 v6, s[12:15], s33 offen offset:2048 sc1 lds
    v_mfma_f32_16x16x32_bf16 v[180:183], v[84:87], v[116:119], v[180:183]
    ds_read_b128 v[56:59], v16 offset:36864
    v_mfma_f32_16x16x32_bf16 v[184:187], v[84:87], v[120:123], v[184:187]
    ds_read_b128 v[60:63], v16 offset:38912
    v_mfma_f32_16x16x32_bf16 v[188:191], v[84:87], v[124:127], v[188:191]
    s_setprio 2
    ds_read_b128 v[64:67], v16 offset:40960
    v_mfma_f32_16x16x32_bf16 v[192:195], v[88:91], v[96:99], v[192:195]
    buffer_load_dwordx4 v7, s[12:15], s33 offen offset:3072 sc1 lds
    ds_read_b128 v[68:71], v16 offset:43008
    v_mfma_f32_16x16x32_bf16 v[196:199], v[88:91], v[100:103], v[196:199]
    ds_read_b128 v[72:75], v16 offset:45056
    v_mfma_f32_16x16x32_bf16 v[200:203], v[88:91], v[104:107], v[200:203]
    v_mfma_f32_16x16x32_bf16 v[204:207], v[88:91], v[108:111], v[204:207]
    ds_read_b128 v[76:79], v16 offset:47104
    v_mfma_f32_16x16x32_bf16 v[208:211], v[88:91], v[112:115], v[208:211]
    s_add_u32 s33, s33, 128
    v_mfma_f32_16x16x32_bf16 v[212:215], v[88:91], v[116:119], v[212:215]
    v_mfma_f32_16x16x32_bf16 v[216:219], v[88:91], v[120:123], v[216:219]
    v_mfma_f32_16x16x32_bf16 v[220:223], v[88:91], v[124:127], v[220:223]
    v_mfma_f32_16x16x32_bf16 v[224:227], v[92:95], v[96:99], v[224:227]
    v_mfma_f32_16x16x32_bf16 v[228:231], v[92:95], v[100:103], v[228:231]
    v_mfma_f32_16x16x32_bf16 v[232:235], v[92:95], v[104:107], v[232:235]
    s_add_u32 m0, s34, 0x8000
    v_mfma_f32_16x16x32_bf16 v[236:239], v[92:95], v[108:111], v[236:239]
    v_mfma_f32_16x16x32_bf16 v[240:243], v[92:95], v[112:115], v[240:243]
    v_mfma_f32_16x16x32_bf16 v[244:247], v[92:95], v[116:119], v[244:247]
    v_mfma_f32_16x16x32_bf16 v[248:251], v[92:95], v[120:123], v[248:251]
    buffer_load_dwordx4 v2, s[16:19], s32 offen offset:0 lds
    v_mfma_f32_16x16x32_bf16 v[252:255], v[92:95], v[124:127], v[252:255]
    s_setprio 1
    s_waitcnt lgkmcnt(0)
    v_mfma_f32_16x16x32_bf16 v[128:131], v[32:35], v[48:51], v[128:131]
    ds_read_b64_tr_b16 v[80:81], v10 offset:8192
    v_mfma_f32_16x16x32_bf16 v[132:135], v[32:35], v[52:55], v[132:135]
    ds_read_b64_tr_b16 v[82:83], v10 offset:9216
    v_mfma_f32_16x16x32_bf16 v[136:139], v[32:35], v[56:59], v[136:139]
    ds_read_b64_tr_b16 v[84:85], v11 offset:8192
    v_mfma_f32_16x16x32_bf16 v[140:143], v[32:35], v[60:63], v[140:143]
    buffer_load_dwordx4 v3, s[16:19], s32 offen offset:1024 lds
    ds_read_b64_tr_b16 v[86:87], v11 offset:9216
    v_mfma_f32_16x16x32_bf16 v[144:147], v[32:35], v[64:67], v[144:147]
    ds_read_b64_tr_b16 v[88:89], v10 offset:24576
    v_mfma_f32_16x16x32_bf16 v[148:151], v[32:35], v[68:71], v[148:151]
    v_mfma_f32_16x16x32_bf16 v[152:155], v[32:35], v[72:75], v[152:155]
    ds_read_b64_tr_b16 v[90:91], v10 offset:25600
    v_mfma_f32_16x16x32_bf16 v[156:159], v[32:35], v[76:79], v[156:159]
    ds_read_b64_tr_b16 v[92:93], v11 offset:24576
    s_add_u32 m0, s34, 0xc000
    v_mfma_f32_16x16x32_bf16 v[160:163], v[36:39], v[48:51], v[160:163]
    ds_read_b64_tr_b16 v[94:95], v11 offset:25600
    v_mfma_f32_16x16x32_bf16 v[164:167], v[36:39], v[52:55], v[164:167]
    ds_read_b128 v[96:99], v17 offset:32768
    v_mfma_f32_16x16x32_bf16 v[168:171], v[36:39], v[56:59], v[168:171]
    ds_read_b128 v[100:103], v17 offset:34816
    v_mfma_f32_16x16x32_bf16 v[172:175], v[36:39], v[60:63], v[172:175]
    v_mfma_f32_16x16x32_bf16 v[176:179], v[36:39], v[64:67], v[176:179]
    buffer_load_dwordx4 v2, s[20:23], s32 offen offset:0 lds
    ds_read_b128 v[104:107], v17 offset:36864
    v_mfma_f32_16x16x32_bf16 v[180:183], v[36:39], v[68:71], v[180:183]
    ds_read_b128 v[108:111], v17 offset:38912
    v_mfma_f32_16x16x32_bf16 v[184:187], v[36:39], v[72:75], v[184:187]
    ds_read_b128 v[112:115], v17 offset:40960
    v_mfma_f32_16x16x32_bf16 v[188:191], v[36:39], v[76:79], v[188:191]
    s_setprio 0
    ds_read_b128 v[116:119], v17 offset:43008
    v_mfma_f32_16x16x32_bf16 v[192:195], v[40:43], v[48:51], v[192:195]
    buffer_load_dwordx4 v3, s[20:23], s32 offen offset:1024 lds
    ds_read_b128 v[120:123], v17 offset:45056
    v_mfma_f32_16x16x32_bf16 v[196:199], v[40:43], v[52:55], v[196:199]
    v_mfma_f32_16x16x32_bf16 v[200:203], v[40:43], v[56:59], v[200:203]
    ds_read_b128 v[124:127], v17 offset:47104
    v_mfma_f32_16x16x32_bf16 v[204:207], v[40:43], v[60:63], v[204:207]
    v_mfma_f32_16x16x32_bf16 v[208:211], v[40:43], v[64:67], v[208:211]
    v_mfma_f32_16x16x32_bf16 v[212:215], v[40:43], v[68:71], v[212:215]
    s_add_u32 s32, s32, 0x70000
    v_mfma_f32_16x16x32_bf16 v[216:219], v[40:43], v[72:75], v[216:219]
    v_mfma_f32_16x16x32_bf16 v[220:223], v[40:43], v[76:79], v[220:223]
    v_mfma_f32_16x16x32_bf16 v[224:227], v[44:47], v[48:51], v[224:227]
    v_mfma_f32_16x16x32_bf16 v[228:231], v[44:47], v[52:55], v[228:231]
    s_mov_b64 exec, 0x3ff
    buffer_load_dword v29, v28, s[52:55], s47 offen
    s_mov_b64 exec, -1
    v_mfma_f32_16x16x32_bf16 v[232:235], v[44:47], v[56:59], v[232:235]
    v_mfma_f32_16x16x32_bf16 v[236:239], v[44:47], v[60:63], v[236:239]
    v_mfma_f32_16x16x32_bf16 v[240:243], v[44:47], v[64:67], v[240:243]
    v_mfma_f32_16x16x32_bf16 v[244:247], v[44:47], v[68:71], v[244:247]
    v_mfma_f32_16x16x32_bf16 v[248:251], v[44:47], v[72:75], v[248:251]
    s_add_u32 s47, s47, 1146880
    v_mfma_f32_16x16x32_bf16 v[252:255], v[44:47], v[76:79], v[252:255]
    s_waitcnt lgkmcnt(0)
    s_setprio 3
    s_waitcnt vmcnt(5)
    s_barrier
    v_mfma_f32_16x16x32_bf16 v[128:131], v[80:83], v[96:99], v[128:131]
    s_add_u32 m0, s35, 0x10000
    v_mfma_f32_16x16x32_bf16 v[132:135], v[80:83], v[100:103], v[132:135]
    ds_read_b64_tr_b16 v[32:33], v12 offset:0
    v_mfma_f32_16x16x32_bf16 v[136:139], v[80:83], v[104:107], v[136:139]
    ds_read_b64_tr_b16 v[34:35], v12 offset:1024
    v_mfma_f32_16x16x32_bf16 v[140:143], v[80:83], v[108:111], v[140:143]
    ds_read_b64_tr_b16 v[36:37], v13 offset:0
    v_mfma_f32_16x16x32_bf16 v[144:147], v[80:83], v[112:115], v[144:147]
    buffer_load_dwordx4 v4, s[12:15], s33 offen offset:0 sc1 lds
    ds_read_b64_tr_b16 v[38:39], v13 offset:1024
    v_mfma_f32_16x16x32_bf16 v[148:151], v[80:83], v[116:119], v[148:151]
    ds_read_b64_tr_b16 v[40:41], v12 offset:16384
    v_mfma_f32_16x16x32_bf16 v[152:155], v[80:83], v[120:123], v[152:155]
    v_mfma_f32_16x16x32_bf16 v[156:159], v[80:83], v[124:127], v[156:159]
    ds_read_b64_tr_b16 v[42:43], v12 offset:17408
    v_mfma_f32_16x16x32_bf16 v[160:163], v[84:87], v[96:99], v[160:163]
    buffer_load_dwordx4 v5, s[12:15], s33 offen offset:1024 sc1 lds
    ds_read_b64_tr_b16 v[44:45], v13 offset:16384
    v_mfma_f32_16x16x32_bf16 v[164:167], v[84:87], v[100:103], v[164:167]
    ds_read_b64_tr_b16 v[46:47], v13 offset:17408
    v_mfma_f32_16x16x32_bf16 v[168:171], v[84:87], v[104:107], v[168:171]
    ds_read_b128 v[48:51], v14 offset:0
    v_mfma_f32_16x16x32_bf16 v[172:175], v[84:87], v[108:111], v[172:175]
    ds_read_b128 v[52:55], v14 offset:2048
    v_mfma_f32_16x16x32_bf16 v[176:179], v[84:87], v[112:115], v[176:179]
    buffer_load_dwordx4 v6, s[12:15], s33 offen offset:2048 sc1 lds
    v_mfma_f32_16x16x32_bf16 v[180:183], v[84:87], v[116:119], v[180:183]
    ds_read_b128 v[56:59], v14 offset:4096
    v_mfma_f32_16x16x32_bf16 v[184:187], v[84:87], v[120:123], v[184:187]
    ds_read_b128 v[60:63], v14 offset:6144
    v_mfma_f32_16x16x32_bf16 v[188:191], v[84:87], v[124:127], v[188:191]
    s_setprio 2
    ds_read_b128 v[64:67], v14 offset:8192
    v_mfma_f32_16x16x32_bf16 v[192:195], v[88:91], v[96:99], v[192:195]
    buffer_load_dwordx4 v7, s[12:15], s33 offen offset:3072 sc1 lds
    ds_read_b128 v[68:71], v14 offset:10240
    v_mfma_f32_16x16x32_bf16 v[196:199], v[88:91], v[100:103], v[196:199]
    ds_read_b128 v[72:75], v14 offset:12288
    v_mfma_f32_16x16x32_bf16 v[200:203], v[88:91], v[104:107], v[200:203]
    v_mfma_f32_16x16x32_bf16 v[204:207], v[88:91], v[108:111], v[204:207]
    ds_read_b128 v[76:79], v14 offset:14336
    v_mfma_f32_16x16x32_bf16 v[208:211], v[88:91], v[112:115], v[208:211]
    s_add_u32 s33, s33, 128
    v_mfma_f32_16x16x32_bf16 v[212:215], v[88:91], v[116:119], v[212:215]
    v_mfma_f32_16x16x32_bf16 v[216:219], v[88:91], v[120:123], v[216:219]
    v_mfma_f32_16x16x32_bf16 v[220:223], v[88:91], v[124:127], v[220:223]
    v_mfma_f32_16x16x32_bf16 v[224:227], v[92:95], v[96:99], v[224:227]
    v_mfma_f32_16x16x32_bf16 v[228:231], v[92:95], v[100:103], v[228:231]
    v_mfma_f32_16x16x32_bf16 v[232:235], v[92:95], v[104:107], v[232:235]
    s_add_u32 m0, s34, 0x18000
    v_mfma_f32_16x16x32_bf16 v[236:239], v[92:95], v[108:111], v[236:239]
    v_mfma_f32_16x16x32_bf16 v[240:243], v[92:95], v[112:115], v[240:243]
    v_mfma_f32_16x16x32_bf16 v[244:247], v[92:95], v[116:119], v[244:247]
    v_mfma_f32_16x16x32_bf16 v[248:251], v[92:95], v[120:123], v[248:251]
    buffer_load_dwordx4 v2, s[16:19], s32 offen offset:0 lds
    v_mfma_f32_16x16x32_bf16 v[252:255], v[92:95], v[124:127], v[252:255]
    s_setprio 1
    s_waitcnt lgkmcnt(0)
    v_mfma_f32_16x16x32_bf16 v[128:131], v[32:35], v[48:51], v[128:131]
    ds_read_b64_tr_b16 v[80:81], v12 offset:8192
    v_mfma_f32_16x16x32_bf16 v[132:135], v[32:35], v[52:55], v[132:135]
    ds_read_b64_tr_b16 v[82:83], v12 offset:9216
    v_mfma_f32_16x16x32_bf16 v[136:139], v[32:35], v[56:59], v[136:139]
    ds_read_b64_tr_b16 v[84:85], v13 offset:8192
    v_mfma_f32_16x16x32_bf16 v[140:143], v[32:35], v[60:63], v[140:143]
    buffer_load_dwordx4 v3, s[16:19], s32 offen offset:1024 lds
    ds_read_b64_tr_b16 v[86:87], v13 offset:9216
    v_mfma_f32_16x16x32_bf16 v[144:147], v[32:35], v[64:67], v[144:147]
    ds_read_b64_tr_b16 v[88:89], v12 offset:24576
    v_mfma_f32_16x16x32_bf16 v[148:151], v[32:35], v[68:71], v[148:151]
    v_mfma_f32_16x16x32_bf16 v[152:155], v[32:35], v[72:75], v[152:155]
    ds_read_b64_tr_b16 v[90:91], v12 offset:25600
    v_mfma_f32_16x16x32_bf16 v[156:159], v[32:35], v[76:79], v[156:159]
    ds_read_b64_tr_b16 v[92:93], v13 offset:24576
    s_add_u32 m0, s34, 0x1c000
    v_mfma_f32_16x16x32_bf16 v[160:163], v[36:39], v[48:51], v[160:163]
    ds_read_b64_tr_b16 v[94:95], v13 offset:25600
    v_mfma_f32_16x16x32_bf16 v[164:167], v[36:39], v[52:55], v[164:167]
    ds_read_b128 v[96:99], v15 offset:0
    v_mfma_f32_16x16x32_bf16 v[168:171], v[36:39], v[56:59], v[168:171]
    ds_read_b128 v[100:103], v15 offset:2048
    v_mfma_f32_16x16x32_bf16 v[172:175], v[36:39], v[60:63], v[172:175]
    v_mfma_f32_16x16x32_bf16 v[176:179], v[36:39], v[64:67], v[176:179]
    buffer_load_dwordx4 v2, s[20:23], s32 offen offset:0 lds
    ds_read_b128 v[104:107], v15 offset:4096
    v_mfma_f32_16x16x32_bf16 v[180:183], v[36:39], v[68:71], v[180:183]
    ds_read_b128 v[108:111], v15 offset:6144
    v_mfma_f32_16x16x32_bf16 v[184:187], v[36:39], v[72:75], v[184:187]
    ds_read_b128 v[112:115], v15 offset:8192
    v_mfma_f32_16x16x32_bf16 v[188:191], v[36:39], v[76:79], v[188:191]
    s_setprio 0
    ds_read_b128 v[116:119], v15 offset:10240
    v_mfma_f32_16x16x32_bf16 v[192:195], v[40:43], v[48:51], v[192:195]
    buffer_load_dwordx4 v3, s[20:23], s32 offen offset:1024 lds
    ds_read_b128 v[120:123], v15 offset:12288
    v_mfma_f32_16x16x32_bf16 v[196:199], v[40:43], v[52:55], v[196:199]
    v_mfma_f32_16x16x32_bf16 v[200:203], v[40:43], v[56:59], v[200:203]
    ds_read_b128 v[124:127], v15 offset:14336
    v_mfma_f32_16x16x32_bf16 v[204:207], v[40:43], v[60:63], v[204:207]
    v_mfma_f32_16x16x32_bf16 v[208:211], v[40:43], v[64:67], v[208:211]
    v_mfma_f32_16x16x32_bf16 v[212:215], v[40:43], v[68:71], v[212:215]
    s_add_u32 s32, s32, 0x70000
    v_mfma_f32_16x16x32_bf16 v[216:219], v[40:43], v[72:75], v[216:219]
    v_mfma_f32_16x16x32_bf16 v[220:223], v[40:43], v[76:79], v[220:223]
    v_mfma_f32_16x16x32_bf16 v[224:227], v[44:47], v[48:51], v[224:227]
    v_mfma_f32_16x16x32_bf16 v[228:231], v[44:47], v[52:55], v[228:231]
    s_mov_b64 exec, 0x3ff
    buffer_load_dword v29, v28, s[52:55], s47 offen
    s_mov_b64 exec, -1
    v_mfma_f32_16x16x32_bf16 v[232:235], v[44:47], v[56:59], v[232:235]
    v_mfma_f32_16x16x32_bf16 v[236:239], v[44:47], v[60:63], v[236:239]
    v_mfma_f32_16x16x32_bf16 v[240:243], v[44:47], v[64:67], v[240:243]
    v_mfma_f32_16x16x32_bf16 v[244:247], v[44:47], v[68:71], v[244:247]
    v_mfma_f32_16x16x32_bf16 v[248:251], v[44:47], v[72:75], v[248:251]
    s_add_u32 s47, s47, 1146880
    v_mfma_f32_16x16x32_bf16 v[252:255], v[44:47], v[76:79], v[252:255]
    s_waitcnt lgkmcnt(0)
    s_setprio 3
    s_waitcnt vmcnt(5)
    s_barrier
    v_mfma_f32_16x16x32_bf16 v[128:131], v[80:83], v[96:99], v[128:131]
    s_add_u32 m0, s35, 0x20000
    v_mfma_f32_16x16x32_bf16 v[132:135], v[80:83], v[100:103], v[132:135]
    ds_read_b64_tr_b16 v[32:33], v8 offset:32768
    v_mfma_f32_16x16x32_bf16 v[136:139], v[80:83], v[104:107], v[136:139]
    ds_read_b64_tr_b16 v[34:35], v8 offset:33792
    v_mfma_f32_16x16x32_bf16 v[140:143], v[80:83], v[108:111], v[140:143]
    ds_read_b64_tr_b16 v[36:37], v9 offset:32768
    v_mfma_f32_16x16x32_bf16 v[144:147], v[80:83], v[112:115], v[144:147]
    buffer_load_dwordx4 v4, s[12:15], s33 offen offset:0 sc1 lds
    ds_read_b64_tr_b16 v[38:39], v9 offset:33792
    v_mfma_f32_16x16x32_bf16 v[148:151], v[80:83], v[116:119], v[148:151]
    ds_read_b64_tr_b16 v[40:41], v8 offset:49152
    v_mfma_f32_16x16x32_bf16 v[152:155], v[80:83], v[120:123], v[152:155]
    v_mfma_f32_16x16x32_bf16 v[156:159], v[80:83], v[124:127], v[156:159]
    ds_read_b64_tr_b16 v[42:43], v8 offset:50176
    v_mfma_f32_16x16x32_bf16 v[160:163], v[84:87], v[96:99], v[160:163]
    buffer_load_dwordx4 v5, s[12:15], s33 offen offset:1024 sc1 lds
    ds_read_b64_tr_b16 v[44:45], v9 offset:49152
    v_mfma_f32_16x16x32_bf16 v[164:167], v[84:87], v[100:103], v[164:167]
    ds_read_b64_tr_b16 v[46:47], v9 offset:50176
    v_mfma_f32_16x16x32_bf16 v[168:171], v[84:87], v[104:107], v[168:171]
    ds_read_b128 v[48:51], v16 offset:0
    v_mfma_f32_16x16x32_bf16 v[172:175], v[84:87], v[108:111], v[172:175]
    ds_read_b128 v[52:55], v16 offset:2048
    v_mfma_f32_16x16x32_bf16 v[176:179], v[84:87], v[112:115], v[176:179]
    buffer_load_dwordx4 v6, s[12:15], s33 offen offset:2048 sc1 lds
    v_mfma_f32_16x16x32_bf16 v[180:183], v[84:87], v[116:119], v[180:183]
    ds_read_b128 v[56:59], v16 offset:4096
    v_mfma_f32_16x16x32_bf16 v[184:187], v[84:87], v[120:123], v[184:187]
    ds_read_b128 v[60:63], v16 offset:6144
    v_mfma_f32_16x16x32_bf16 v[188:191], v[84:87], v[124:127], v[188:191]
    s_setprio 2
    ds_read_b128 v[64:67], v16 offset:8192
    v_mfma_f32_16x16x32_bf16 v[192:195], v[88:91], v[96:99], v[192:195]
    buffer_load_dwordx4 v7, s[12:15], s33 offen offset:3072 sc1 lds
    ds_read_b128 v[68:71], v16 offset:10240
    v_mfma_f32_16x16x32_bf16 v[196:199], v[88:91], v[100:103], v[196:199]
    ds_read_b128 v[72:75], v16 offset:12288
    v_mfma_f32_16x16x32_bf16 v[200:203], v[88:91], v[104:107], v[200:203]
    v_mfma_f32_16x16x32_bf16 v[204:207], v[88:91], v[108:111], v[204:207]
    ds_read_b128 v[76:79], v16 offset:14336
    v_mfma_f32_16x16x32_bf16 v[208:211], v[88:91], v[112:115], v[208:211]
    s_add_u32 s33, s33, 128
    v_mfma_f32_16x16x32_bf16 v[212:215], v[88:91], v[116:119], v[212:215]
    v_mfma_f32_16x16x32_bf16 v[216:219], v[88:91], v[120:123], v[216:219]
    v_mfma_f32_16x16x32_bf16 v[220:223], v[88:91], v[124:127], v[220:223]
    v_mfma_f32_16x16x32_bf16 v[224:227], v[92:95], v[96:99], v[224:227]
    v_mfma_f32_16x16x32_bf16 v[228:231], v[92:95], v[100:103], v[228:231]
    v_mfma_f32_16x16x32_bf16 v[232:235], v[92:95], v[104:107], v[232:235]
    s_add_u32 m0, s34, 0x0
    v_mfma_f32_16x16x32_bf16 v[236:239], v[92:95], v[108:111], v[236:239]
    v_mfma_f32_16x16x32_bf16 v[240:243], v[92:95], v[112:115], v[240:243]
    v_mfma_f32_16x16x32_bf16 v[244:247], v[92:95], v[116:119], v[244:247]
    v_mfma_f32_16x16x32_bf16 v[248:251], v[92:95], v[120:123], v[248:251]
    buffer_load_dwordx4 v2, s[16:19], s32 offen offset:0 lds
    v_mfma_f32_16x16x32_bf16 v[252:255], v[92:95], v[124:127], v[252:255]
    s_setprio 1
    s_waitcnt lgkmcnt(0)
    v_mfma_f32_16x16x32_bf16 v[128:131], v[32:35], v[48:51], v[128:131]
    ds_read_b64_tr_b16 v[80:81], v8 offset:40960
    v_mfma_f32_16x16x32_bf16 v[132:135], v[32:35], v[52:55], v[132:135]
    ds_read_b64_tr_b16 v[82:83], v8 offset:41984
    v_mfma_f32_16x16x32_bf16 v[136:139], v[32:35], v[56:59], v[136:139]
    ds_read_b64_tr_b16 v[84:85], v9 offset:40960
    v_mfma_f32_16x16x32_bf16 v[140:143], v[32:35], v[60:63], v[140:143]
    buffer_load_dwordx4 v3, s[16:19], s32 offen offset:1024 lds
    ds_read_b64_tr_b16 v[86:87], v9 offset:41984
    v_mfma_f32_16x16x32_bf16 v[144:147], v[32:35], v[64:67], v[144:147]
    ds_read_b64_tr_b16 v[88:89], v8 offset:57344
    v_mfma_f32_16x16x32_bf16 v[148:151], v[32:35], v[68:71], v[148:151]
    v_mfma_f32_16x16x32_bf16 v[152:155], v[32:35], v[72:75], v[152:155]
    ds_read_b64_tr_b16 v[90:91], v8 offset:58368
    v_mfma_f32_16x16x32_bf16 v[156:159], v[32:35], v[76:79], v[156:159]
    ds_read_b64_tr_b16 v[92:93], v9 offset:57344
    s_add_u32 m0, s34, 0x4000
    v_mfma_f32_16x16x32_bf16 v[160:163], v[36:39], v[48:51], v[160:163]
    ds_read_b64_tr_b16 v[94:95], v9 offset:58368
    v_mfma_f32_16x16x32_bf16 v[164:167], v[36:39], v[52:55], v[164:167]
    ds_read_b128 v[96:99], v17 offset:0
    v_mfma_f32_16x16x32_bf16 v[168:171], v[36:39], v[56:59], v[168:171]
    ds_read_b128 v[100:103], v17 offset:2048
    v_mfma_f32_16x16x32_bf16 v[172:175], v[36:39], v[60:63], v[172:175]
    v_mfma_f32_16x16x32_bf16 v[176:179], v[36:39], v[64:67], v[176:179]
    buffer_load_dwordx4 v2, s[20:23], s32 offen offset:0 lds
    ds_read_b128 v[104:107], v17 offset:4096
    v_mfma_f32_16x16x32_bf16 v[180:183], v[36:39], v[68:71], v[180:183]
    ds_read_b128 v[108:111], v17 offset:6144
    v_mfma_f32_16x16x32_bf16 v[184:187], v[36:39], v[72:75], v[184:187]
    ds_read_b128 v[112:115], v17 offset:8192
    v_mfma_f32_16x16x32_bf16 v[188:191], v[36:39], v[76:79], v[188:191]
    s_setprio 0
    ds_read_b128 v[116:119], v17 offset:10240
    v_mfma_f32_16x16x32_bf16 v[192:195], v[40:43], v[48:51], v[192:195]
    buffer_load_dwordx4 v3, s[20:23], s32 offen offset:1024 lds
    ds_read_b128 v[120:123], v17 offset:12288
    v_mfma_f32_16x16x32_bf16 v[196:199], v[40:43], v[52:55], v[196:199]
    v_mfma_f32_16x16x32_bf16 v[200:203], v[40:43], v[56:59], v[200:203]
    ds_read_b128 v[124:127], v17 offset:14336
    v_mfma_f32_16x16x32_bf16 v[204:207], v[40:43], v[60:63], v[204:207]
    v_mfma_f32_16x16x32_bf16 v[208:211], v[40:43], v[64:67], v[208:211]
    v_mfma_f32_16x16x32_bf16 v[212:215], v[40:43], v[68:71], v[212:215]
    s_add_u32 s32, s32, 0x70000
    v_mfma_f32_16x16x32_bf16 v[216:219], v[40:43], v[72:75], v[216:219]
    v_mfma_f32_16x16x32_bf16 v[220:223], v[40:43], v[76:79], v[220:223]
    v_mfma_f32_16x16x32_bf16 v[224:227], v[44:47], v[48:51], v[224:227]
    v_mfma_f32_16x16x32_bf16 v[228:231], v[44:47], v[52:55], v[228:231]
    s_mov_b64 exec, 0x3ff
    buffer_load_dword v29, v28, s[52:55], s47 offen
    s_mov_b64 exec, -1
    v_mfma_f32_16x16x32_bf16 v[232:235], v[44:47], v[56:59], v[232:235]
    v_mfma_f32_16x16x32_bf16 v[236:239], v[44:47], v[60:63], v[236:239]
    v_mfma_f32_16x16x32_bf16 v[240:243], v[44:47], v[64:67], v[240:243]
    v_mfma_f32_16x16x32_bf16 v[244:247], v[44:47], v[68:71], v[244:247]
    v_mfma_f32_16x16x32_bf16 v[248:251], v[44:47], v[72:75], v[248:251]
    s_add_u32 s47, s47, 1146880
    v_mfma_f32_16x16x32_bf16 v[252:255], v[44:47], v[76:79], v[252:255]
    s_waitcnt lgkmcnt(0)
    s_setprio 3
    s_waitcnt vmcnt(5)
    s_barrier
    v_mfma_f32_16x16x32_bf16 v[128:131], v[80:83], v[96:99], v[128:131]
    s_add_u32 m0, s35, 0x8000
    v_mfma_f32_16x16x32_bf16 v[132:135], v[80:83], v[100:103], v[132:135]
    ds_read_b64_tr_b16 v[32:33], v10 offset:32768
    v_mfma_f32_16x16x32_bf16 v[136:139], v[80:83], v[104:107], v[136:139]
    ds_read_b64_tr_b16 v[34:35], v10 offset:33792
    v_mfma_f32_16x16x32_bf16 v[140:143], v[80:83], v[108:111], v[140:143]
    ds_read_b64_tr_b16 v[36:37], v11 offset:32768
    v_mfma_f32_16x16x32_bf16 v[144:147], v[80:83], v[112:115], v[144:147]
    buffer_load_dwordx4 v4, s[12:15], s33 offen offset:0 sc1 lds
    ds_read_b64_tr_b16 v[38:39], v11 offset:33792
    v_mfma_f32_16x16x32_bf16 v[148:151], v[80:83], v[116:119], v[148:151]
    ds_read_b64_tr_b16 v[40:41], v10 offset:49152
    v_mfma_f32_16x16x32_bf16 v[152:155], v[80:83], v[120:123], v[152:155]
    v_mfma_f32_16x16x32_bf16 v[156:159], v[80:83], v[124:127], v[156:159]
    ds_read_b64_tr_b16 v[42:43], v10 offset:50176
    v_mfma_f32_16x16x32_bf16 v[160:163], v[84:87], v[96:99], v[160:163]
    buffer_load_dwordx4 v5, s[12:15], s33 offen offset:1024 sc1 lds
    ds_read_b64_tr_b16 v[44:45], v11 offset:49152
    v_mfma_f32_16x16x32_bf16 v[164:167], v[84:87], v[100:103], v[164:167]
    ds_read_b64_tr_b16 v[46:47], v11 offset:50176
    v_mfma_f32_16x16x32_bf16 v[168:171], v[84:87], v[104:107], v[168:171]
    ds_read_b128 v[48:51], v18 offset:0
    v_mfma_f32_16x16x32_bf16 v[172:175], v[84:87], v[108:111], v[172:175]
    ds_read_b128 v[52:55], v18 offset:2048
    v_mfma_f32_16x16x32_bf16 v[176:179], v[84:87], v[112:115], v[176:179]
    buffer_load_dwordx4 v6, s[12:15], s33 offen offset:2048 sc1 lds
    v_mfma_f32_16x16x32_bf16 v[180:183], v[84:87], v[116:119], v[180:183]
    ds_read_b128 v[56:59], v18 offset:4096
    v_mfma_f32_16x16x32_bf16 v[184:187], v[84:87], v[120:123], v[184:187]
    ds_read_b128 v[60:63], v18 offset:6144
    v_mfma_f32_16x16x32_bf16 v[188:191], v[84:87], v[124:127], v[188:191]
    s_setprio 2
    ds_read_b128 v[64:67], v18 offset:8192
    v_mfma_f32_16x16x32_bf16 v[192:195], v[88:91], v[96:99], v[192:195]
    buffer_load_dwordx4 v7, s[12:15], s33 offen offset:3072 sc1 lds
    ds_read_b128 v[68:71], v18 offset:10240
    v_mfma_f32_16x16x32_bf16 v[196:199], v[88:91], v[100:103], v[196:199]
    ds_read_b128 v[72:75], v18 offset:12288
    v_mfma_f32_16x16x32_bf16 v[200:203], v[88:91], v[104:107], v[200:203]
    v_mfma_f32_16x16x32_bf16 v[204:207], v[88:91], v[108:111], v[204:207]
    ds_read_b128 v[76:79], v18 offset:14336
    v_mfma_f32_16x16x32_bf16 v[208:211], v[88:91], v[112:115], v[208:211]
    s_add_u32 s33, s33, 128
    v_mfma_f32_16x16x32_bf16 v[212:215], v[88:91], v[116:119], v[212:215]
    v_mfma_f32_16x16x32_bf16 v[216:219], v[88:91], v[120:123], v[216:219]
    v_mfma_f32_16x16x32_bf16 v[220:223], v[88:91], v[124:127], v[220:223]
    v_mfma_f32_16x16x32_bf16 v[224:227], v[92:95], v[96:99], v[224:227]
    v_mfma_f32_16x16x32_bf16 v[228:231], v[92:95], v[100:103], v[228:231]
    v_mfma_f32_16x16x32_bf16 v[232:235], v[92:95], v[104:107], v[232:235]
    s_add_u32 m0, s34, 0x10000
    v_mfma_f32_16x16x32_bf16 v[236:239], v[92:95], v[108:111], v[236:239]
    v_mfma_f32_16x16x32_bf16 v[240:243], v[92:95], v[112:115], v[240:243]
    v_mfma_f32_16x16x32_bf16 v[244:247], v[92:95], v[116:119], v[244:247]
    v_mfma_f32_16x16x32_bf16 v[248:251], v[92:95], v[120:123], v[248:251]
    buffer_load_dwordx4 v2, s[16:19], s32 offen offset:0 lds
    v_mfma_f32_16x16x32_bf16 v[252:255], v[92:95], v[124:127], v[252:255]
    s_setprio 1
    s_waitcnt lgkmcnt(0)
    v_mfma_f32_16x16x32_bf16 v[128:131], v[32:35], v[48:51], v[128:131]
    ds_read_b64_tr_b16 v[80:81], v10 offset:40960
    v_mfma_f32_16x16x32_bf16 v[132:135], v[32:35], v[52:55], v[132:135]
    ds_read_b64_tr_b16 v[82:83], v10 offset:41984
    v_mfma_f32_16x16x32_bf16 v[136:139], v[32:35], v[56:59], v[136:139]
    ds_read_b64_tr_b16 v[84:85], v11 offset:40960
    v_mfma_f32_16x16x32_bf16 v[140:143], v[32:35], v[60:63], v[140:143]
    buffer_load_dwordx4 v3, s[16:19], s32 offen offset:1024 lds
    ds_read_b64_tr_b16 v[86:87], v11 offset:41984
    v_mfma_f32_16x16x32_bf16 v[144:147], v[32:35], v[64:67], v[144:147]
    ds_read_b64_tr_b16 v[88:89], v10 offset:57344
    v_mfma_f32_16x16x32_bf16 v[148:151], v[32:35], v[68:71], v[148:151]
    v_mfma_f32_16x16x32_bf16 v[152:155], v[32:35], v[72:75], v[152:155]
    ds_read_b64_tr_b16 v[90:91], v10 offset:58368
    v_mfma_f32_16x16x32_bf16 v[156:159], v[32:35], v[76:79], v[156:159]
    ds_read_b64_tr_b16 v[92:93], v11 offset:57344
    s_add_u32 m0, s34, 0x14000
    v_mfma_f32_16x16x32_bf16 v[160:163], v[36:39], v[48:51], v[160:163]
    ds_read_b64_tr_b16 v[94:95], v11 offset:58368
    v_mfma_f32_16x16x32_bf16 v[164:167], v[36:39], v[52:55], v[164:167]
    ds_read_b128 v[96:99], v19 offset:0
    v_mfma_f32_16x16x32_bf16 v[168:171], v[36:39], v[56:59], v[168:171]
    ds_read_b128 v[100:103], v19 offset:2048
    v_mfma_f32_16x16x32_bf16 v[172:175], v[36:39], v[60:63], v[172:175]
    v_mfma_f32_16x16x32_bf16 v[176:179], v[36:39], v[64:67], v[176:179]
    buffer_load_dwordx4 v2, s[20:23], s32 offen offset:0 lds
    ds_read_b128 v[104:107], v19 offset:4096
    v_mfma_f32_16x16x32_bf16 v[180:183], v[36:39], v[68:71], v[180:183]
    ds_read_b128 v[108:111], v19 offset:6144
    v_mfma_f32_16x16x32_bf16 v[184:187], v[36:39], v[72:75], v[184:187]
    ds_read_b128 v[112:115], v19 offset:8192
    v_mfma_f32_16x16x32_bf16 v[188:191], v[36:39], v[76:79], v[188:191]
    s_setprio 0
    ds_read_b128 v[116:119], v19 offset:10240
    v_mfma_f32_16x16x32_bf16 v[192:195], v[40:43], v[48:51], v[192:195]
    buffer_load_dwordx4 v3, s[20:23], s32 offen offset:1024 lds
    ds_read_b128 v[120:123], v19 offset:12288
    v_mfma_f32_16x16x32_bf16 v[196:199], v[40:43], v[52:55], v[196:199]
    v_mfma_f32_16x16x32_bf16 v[200:203], v[40:43], v[56:59], v[200:203]
    ds_read_b128 v[124:127], v19 offset:14336
    v_mfma_f32_16x16x32_bf16 v[204:207], v[40:43], v[60:63], v[204:207]
    v_mfma_f32_16x16x32_bf16 v[208:211], v[40:43], v[64:67], v[208:211]
    v_mfma_f32_16x16x32_bf16 v[212:215], v[40:43], v[68:71], v[212:215]
    s_add_u32 s32, s32, 0x70000
    v_mfma_f32_16x16x32_bf16 v[216:219], v[40:43], v[72:75], v[216:219]
    v_mfma_f32_16x16x32_bf16 v[220:223], v[40:43], v[76:79], v[220:223]
    v_mfma_f32_16x16x32_bf16 v[224:227], v[44:47], v[48:51], v[224:227]
    v_mfma_f32_16x16x32_bf16 v[228:231], v[44:47], v[52:55], v[228:231]
    v_mfma_f32_16x16x32_bf16 v[232:235], v[44:47], v[56:59], v[232:235]
    v_mfma_f32_16x16x32_bf16 v[236:239], v[44:47], v[60:63], v[236:239]
    v_mfma_f32_16x16x32_bf16 v[240:243], v[44:47], v[64:67], v[240:243]
    v_mfma_f32_16x16x32_bf16 v[244:247], v[44:47], v[68:71], v[244:247]
    v_mfma_f32_16x16x32_bf16 v[248:251], v[44:47], v[72:75], v[248:251]
    v_mfma_f32_16x16x32_bf16 v[252:255], v[44:47], v[76:79], v[252:255]
    s_waitcnt lgkmcnt(0)
    s_setprio 3
    s_waitcnt vmcnt(4)
    s_barrier
    v_mfma_f32_16x16x32_bf16 v[128:131], v[80:83], v[96:99], v[128:131]
    s_add_u32 m0, s35, 0x18000
    v_mfma_f32_16x16x32_bf16 v[132:135], v[80:83], v[100:103], v[132:135]
    ds_read_b64_tr_b16 v[32:33], v8 offset:0
    v_mfma_f32_16x16x32_bf16 v[136:139], v[80:83], v[104:107], v[136:139]
    ds_read_b64_tr_b16 v[34:35], v8 offset:1024
    v_mfma_f32_16x16x32_bf16 v[140:143], v[80:83], v[108:111], v[140:143]
    ds_read_b64_tr_b16 v[36:37], v9 offset:0
    v_mfma_f32_16x16x32_bf16 v[144:147], v[80:83], v[112:115], v[144:147]
    buffer_load_dwordx4 v4, s[12:15], s33 offen offset:0 sc1 lds
    ds_read_b64_tr_b16 v[38:39], v9 offset:1024
    v_mfma_f32_16x16x32_bf16 v[148:151], v[80:83], v[116:119], v[148:151]
    ds_read_b64_tr_b16 v[40:41], v8 offset:16384
    v_mfma_f32_16x16x32_bf16 v[152:155], v[80:83], v[120:123], v[152:155]
    v_mfma_f32_16x16x32_bf16 v[156:159], v[80:83], v[124:127], v[156:159]
    ds_read_b64_tr_b16 v[42:43], v8 offset:17408
    v_mfma_f32_16x16x32_bf16 v[160:163], v[84:87], v[96:99], v[160:163]
    buffer_load_dwordx4 v5, s[12:15], s33 offen offset:1024 sc1 lds
    ds_read_b64_tr_b16 v[44:45], v9 offset:16384
    v_mfma_f32_16x16x32_bf16 v[164:167], v[84:87], v[100:103], v[164:167]
    ds_read_b64_tr_b16 v[46:47], v9 offset:17408
    v_mfma_f32_16x16x32_bf16 v[168:171], v[84:87], v[104:107], v[168:171]
    ds_read_b128 v[48:51], v14 offset:32768
    v_mfma_f32_16x16x32_bf16 v[172:175], v[84:87], v[108:111], v[172:175]
    ds_read_b128 v[52:55], v14 offset:34816
    v_mfma_f32_16x16x32_bf16 v[176:179], v[84:87], v[112:115], v[176:179]
    buffer_load_dwordx4 v6, s[12:15], s33 offen offset:2048 sc1 lds
    v_mfma_f32_16x16x32_bf16 v[180:183], v[84:87], v[116:119], v[180:183]
    ds_read_b128 v[56:59], v14 offset:36864
    v_mfma_f32_16x16x32_bf16 v[184:187], v[84:87], v[120:123], v[184:187]
    ds_read_b128 v[60:63], v14 offset:38912
    v_mfma_f32_16x16x32_bf16 v[188:191], v[84:87], v[124:127], v[188:191]
    s_setprio 2
    ds_read_b128 v[64:67], v14 offset:40960
    v_mfma_f32_16x16x32_bf16 v[192:195], v[88:91], v[96:99], v[192:195]
    buffer_load_dwordx4 v7, s[12:15], s33 offen offset:3072 sc1 lds
    ds_read_b128 v[68:71], v14 offset:43008
    v_mfma_f32_16x16x32_bf16 v[196:199], v[88:91], v[100:103], v[196:199]
    ds_read_b128 v[72:75], v14 offset:45056
    v_mfma_f32_16x16x32_bf16 v[200:203], v[88:91], v[104:107], v[200:203]
    v_mfma_f32_16x16x32_bf16 v[204:207], v[88:91], v[108:111], v[204:207]
    ds_read_b128 v[76:79], v14 offset:47104
    v_mfma_f32_16x16x32_bf16 v[208:211], v[88:91], v[112:115], v[208:211]
    s_add_u32 s33, s33, 128
    v_mfma_f32_16x16x32_bf16 v[212:215], v[88:91], v[116:119], v[212:215]
    v_mfma_f32_16x16x32_bf16 v[216:219], v[88:91], v[120:123], v[216:219]
    v_mfma_f32_16x16x32_bf16 v[220:223], v[88:91], v[124:127], v[220:223]
    v_mfma_f32_16x16x32_bf16 v[224:227], v[92:95], v[96:99], v[224:227]
    v_mfma_f32_16x16x32_bf16 v[228:231], v[92:95], v[100:103], v[228:231]
    v_mfma_f32_16x16x32_bf16 v[232:235], v[92:95], v[104:107], v[232:235]
    s_add_u32 m0, s34, 0x20000
    v_mfma_f32_16x16x32_bf16 v[236:239], v[92:95], v[108:111], v[236:239]
    v_mfma_f32_16x16x32_bf16 v[240:243], v[92:95], v[112:115], v[240:243]
    v_mfma_f32_16x16x32_bf16 v[244:247], v[92:95], v[116:119], v[244:247]
    v_mfma_f32_16x16x32_bf16 v[248:251], v[92:95], v[120:123], v[248:251]
    buffer_load_dwordx4 v2, s[16:19], s32 offen offset:0 lds
    v_mfma_f32_16x16x32_bf16 v[252:255], v[92:95], v[124:127], v[252:255]
    s_setprio 1
    s_waitcnt lgkmcnt(0)
    v_mfma_f32_16x16x32_bf16 v[128:131], v[32:35], v[48:51], v[128:131]
    ds_read_b64_tr_b16 v[80:81], v8 offset:8192
    v_mfma_f32_16x16x32_bf16 v[132:135], v[32:35], v[52:55], v[132:135]
    ds_read_b64_tr_b16 v[82:83], v8 offset:9216
    v_mfma_f32_16x16x32_bf16 v[136:139], v[32:35], v[56:59], v[136:139]
    ds_read_b64_tr_b16 v[84:85], v9 offset:8192
    v_mfma_f32_16x16x32_bf16 v[140:143], v[32:35], v[60:63], v[140:143]
    buffer_load_dwordx4 v3, s[16:19], s32 offen offset:1024 lds
    ds_read_b64_tr_b16 v[86:87], v9 offset:9216
    v_mfma_f32_16x16x32_bf16 v[144:147], v[32:35], v[64:67], v[144:147]
    ds_read_b64_tr_b16 v[88:89], v8 offset:24576
    v_mfma_f32_16x16x32_bf16 v[148:151], v[32:35], v[68:71], v[148:151]
    v_mfma_f32_16x16x32_bf16 v[152:155], v[32:35], v[72:75], v[152:155]
    ds_read_b64_tr_b16 v[90:91], v8 offset:25600
    v_mfma_f32_16x16x32_bf16 v[156:159], v[32:35], v[76:79], v[156:159]
    ds_read_b64_tr_b16 v[92:93], v9 offset:24576
    s_add_u32 m0, s34, 0x24000
    v_mfma_f32_16x16x32_bf16 v[160:163], v[36:39], v[48:51], v[160:163]
    ds_read_b64_tr_b16 v[94:95], v9 offset:25600
    v_mfma_f32_16x16x32_bf16 v[164:167], v[36:39], v[52:55], v[164:167]
    ds_read_b128 v[96:99], v15 offset:32768
    v_mfma_f32_16x16x32_bf16 v[168:171], v[36:39], v[56:59], v[168:171]
    ds_read_b128 v[100:103], v15 offset:34816
    v_mfma_f32_16x16x32_bf16 v[172:175], v[36:39], v[60:63], v[172:175]
    v_mfma_f32_16x16x32_bf16 v[176:179], v[36:39], v[64:67], v[176:179]
    buffer_load_dwordx4 v2, s[20:23], s32 offen offset:0 lds
    ds_read_b128 v[104:107], v15 offset:36864
    v_mfma_f32_16x16x32_bf16 v[180:183], v[36:39], v[68:71], v[180:183]
    ds_read_b128 v[108:111], v15 offset:38912
    v_mfma_f32_16x16x32_bf16 v[184:187], v[36:39], v[72:75], v[184:187]
    ds_read_b128 v[112:115], v15 offset:40960
    v_mfma_f32_16x16x32_bf16 v[188:191], v[36:39], v[76:79], v[188:191]
    s_setprio 0
    ds_read_b128 v[116:119], v15 offset:43008
    v_mfma_f32_16x16x32_bf16 v[192:195], v[40:43], v[48:51], v[192:195]
    buffer_load_dwordx4 v3, s[20:23], s32 offen offset:1024 lds
    ds_read_b128 v[120:123], v15 offset:45056
    v_mfma_f32_16x16x32_bf16 v[196:199], v[40:43], v[52:55], v[196:199]
    v_mfma_f32_16x16x32_bf16 v[200:203], v[40:43], v[56:59], v[200:203]
    ds_read_b128 v[124:127], v15 offset:47104
    v_mfma_f32_16x16x32_bf16 v[204:207], v[40:43], v[60:63], v[204:207]
    v_mfma_f32_16x16x32_bf16 v[208:211], v[40:43], v[64:67], v[208:211]
    v_mfma_f32_16x16x32_bf16 v[212:215], v[40:43], v[68:71], v[212:215]
    s_add_u32 s32, s32, 0x70000
    v_mfma_f32_16x16x32_bf16 v[216:219], v[40:43], v[72:75], v[216:219]
    v_mfma_f32_16x16x32_bf16 v[220:223], v[40:43], v[76:79], v[220:223]
    v_mfma_f32_16x16x32_bf16 v[224:227], v[44:47], v[48:51], v[224:227]
    v_mfma_f32_16x16x32_bf16 v[228:231], v[44:47], v[52:55], v[228:231]
    v_mfma_f32_16x16x32_bf16 v[232:235], v[44:47], v[56:59], v[232:235]
    v_mfma_f32_16x16x32_bf16 v[236:239], v[44:47], v[60:63], v[236:239]
    v_mfma_f32_16x16x32_bf16 v[240:243], v[44:47], v[64:67], v[240:243]
    v_mfma_f32_16x16x32_bf16 v[244:247], v[44:47], v[68:71], v[244:247]
    v_mfma_f32_16x16x32_bf16 v[248:251], v[44:47], v[72:75], v[248:251]
    v_mfma_f32_16x16x32_bf16 v[252:255], v[44:47], v[76:79], v[252:255]
    s_waitcnt lgkmcnt(0)
    s_setprio 3
    s_waitcnt vmcnt(4)
    s_barrier
    v_mfma_f32_16x16x32_bf16 v[128:131], v[80:83], v[96:99], v[128:131]
    s_add_u32 m0, s35, 0x0
    v_mfma_f32_16x16x32_bf16 v[132:135], v[80:83], v[100:103], v[132:135]
    ds_read_b64_tr_b16 v[32:33], v10 offset:0
    v_mfma_f32_16x16x32_bf16 v[136:139], v[80:83], v[104:107], v[136:139]
    ds_read_b64_tr_b16 v[34:35], v10 offset:1024
    v_mfma_f32_16x16x32_bf16 v[140:143], v[80:83], v[108:111], v[140:143]
    ds_read_b64_tr_b16 v[36:37], v11 offset:0
    v_mfma_f32_16x16x32_bf16 v[144:147], v[80:83], v[112:115], v[144:147]
    buffer_load_dwordx4 v4, s[12:15], s33 offen offset:0 sc1 lds
    ds_read_b64_tr_b16 v[38:39], v11 offset:1024
    v_mfma_f32_16x16x32_bf16 v[148:151], v[80:83], v[116:119], v[148:151]
    ds_read_b64_tr_b16 v[40:41], v10 offset:16384
    v_mfma_f32_16x16x32_bf16 v[152:155], v[80:83], v[120:123], v[152:155]
    v_mfma_f32_16x16x32_bf16 v[156:159], v[80:83], v[124:127], v[156:159]
    ds_read_b64_tr_b16 v[42:43], v10 offset:17408
    v_mfma_f32_16x16x32_bf16 v[160:163], v[84:87], v[96:99], v[160:163]
    buffer_load_dwordx4 v5, s[12:15], s33 offen offset:1024 sc1 lds
    ds_read_b64_tr_b16 v[44:45], v11 offset:16384
    v_mfma_f32_16x16x32_bf16 v[164:167], v[84:87], v[100:103], v[164:167]
    ds_read_b64_tr_b16 v[46:47], v11 offset:17408
    v_mfma_f32_16x16x32_bf16 v[168:171], v[84:87], v[104:107], v[168:171]
    ds_read_b128 v[48:51], v16 offset:32768
    v_mfma_f32_16x16x32_bf16 v[172:175], v[84:87], v[108:111], v[172:175]
    ds_read_b128 v[52:55], v16 offset:34816
    v_mfma_f32_16x16x32_bf16 v[176:179], v[84:87], v[112:115], v[176:179]
    buffer_load_dwordx4 v6, s[12:15], s33 offen offset:2048 sc1 lds
    v_mfma_f32_16x16x32_bf16 v[180:183], v[84:87], v[116:119], v[180:183]
    ds_read_b128 v[56:59], v16 offset:36864
    v_mfma_f32_16x16x32_bf16 v[184:187], v[84:87], v[120:123], v[184:187]
    ds_read_b128 v[60:63], v16 offset:38912
    v_mfma_f32_16x16x32_bf16 v[188:191], v[84:87], v[124:127], v[188:191]
    s_setprio 2
    ds_read_b128 v[64:67], v16 offset:40960
    v_mfma_f32_16x16x32_bf16 v[192:195], v[88:91], v[96:99], v[192:195]
    buffer_load_dwordx4 v7, s[12:15], s33 offen offset:3072 sc1 lds
    ds_read_b128 v[68:71], v16 offset:43008
    v_mfma_f32_16x16x32_bf16 v[196:199], v[88:91], v[100:103], v[196:199]
    ds_read_b128 v[72:75], v16 offset:45056
    v_mfma_f32_16x16x32_bf16 v[200:203], v[88:91], v[104:107], v[200:203]
    v_mfma_f32_16x16x32_bf16 v[204:207], v[88:91], v[108:111], v[204:207]
    ds_read_b128 v[76:79], v16 offset:47104
    v_mfma_f32_16x16x32_bf16 v[208:211], v[88:91], v[112:115], v[208:211]
    s_add_u32 s33, s33, 128
    v_mfma_f32_16x16x32_bf16 v[212:215], v[88:91], v[116:119], v[212:215]
    v_mfma_f32_16x16x32_bf16 v[216:219], v[88:91], v[120:123], v[216:219]
    v_mfma_f32_16x16x32_bf16 v[220:223], v[88:91], v[124:127], v[220:223]
    v_mfma_f32_16x16x32_bf16 v[224:227], v[92:95], v[96:99], v[224:227]
    v_mfma_f32_16x16x32_bf16 v[228:231], v[92:95], v[100:103], v[228:231]
    v_mfma_f32_16x16x32_bf16 v[232:235], v[92:95], v[104:107], v[232:235]
    s_add_u32 m0, s34, 0x8000
    v_mfma_f32_16x16x32_bf16 v[236:239], v[92:95], v[108:111], v[236:239]
    v_mfma_f32_16x16x32_bf16 v[240:243], v[92:95], v[112:115], v[240:243]
    v_mfma_f32_16x16x32_bf16 v[244:247], v[92:95], v[116:119], v[244:247]
    v_mfma_f32_16x16x32_bf16 v[248:251], v[92:95], v[120:123], v[248:251]
    buffer_load_dwordx4 v2, s[16:19], s32 offen offset:0 lds
    v_mfma_f32_16x16x32_bf16 v[252:255], v[92:95], v[124:127], v[252:255]
    s_setprio 1
    s_waitcnt lgkmcnt(0)
    v_mfma_f32_16x16x32_bf16 v[128:131], v[32:35], v[48:51], v[128:131]
    ds_read_b64_tr_b16 v[80:81], v10 offset:8192
    v_mfma_f32_16x16x32_bf16 v[132:135], v[32:35], v[52:55], v[132:135]
    ds_read_b64_tr_b16 v[82:83], v10 offset:9216
    v_mfma_f32_16x16x32_bf16 v[136:139], v[32:35], v[56:59], v[136:139]
    ds_read_b64_tr_b16 v[84:85], v11 offset:8192
    v_mfma_f32_16x16x32_bf16 v[140:143], v[32:35], v[60:63], v[140:143]
    buffer_load_dwordx4 v3, s[16:19], s32 offen offset:1024 lds
    ds_read_b64_tr_b16 v[86:87], v11 offset:9216
    v_mfma_f32_16x16x32_bf16 v[144:147], v[32:35], v[64:67], v[144:147]
    ds_read_b64_tr_b16 v[88:89], v10 offset:24576
    v_mfma_f32_16x16x32_bf16 v[148:151], v[32:35], v[68:71], v[148:151]
    v_mfma_f32_16x16x32_bf16 v[152:155], v[32:35], v[72:75], v[152:155]
    ds_read_b64_tr_b16 v[90:91], v10 offset:25600
    v_mfma_f32_16x16x32_bf16 v[156:159], v[32:35], v[76:79], v[156:159]
    ds_read_b64_tr_b16 v[92:93], v11 offset:24576
    s_add_u32 m0, s34, 0xc000
    v_mfma_f32_16x16x32_bf16 v[160:163], v[36:39], v[48:51], v[160:163]
    ds_read_b64_tr_b16 v[94:95], v11 offset:25600
    v_mfma_f32_16x16x32_bf16 v[164:167], v[36:39], v[52:55], v[164:167]
    ds_read_b128 v[96:99], v17 offset:32768
    v_mfma_f32_16x16x32_bf16 v[168:171], v[36:39], v[56:59], v[168:171]
    ds_read_b128 v[100:103], v17 offset:34816
    v_mfma_f32_16x16x32_bf16 v[172:175], v[36:39], v[60:63], v[172:175]
    v_mfma_f32_16x16x32_bf16 v[176:179], v[36:39], v[64:67], v[176:179]
    buffer_load_dwordx4 v2, s[20:23], s32 offen offset:0 lds
    ds_read_b128 v[104:107], v17 offset:36864
    v_mfma_f32_16x16x32_bf16 v[180:183], v[36:39], v[68:71], v[180:183]
    ds_read_b128 v[108:111], v17 offset:38912
    v_mfma_f32_16x16x32_bf16 v[184:187], v[36:39], v[72:75], v[184:187]
    ds_read_b128 v[112:115], v17 offset:40960
    v_mfma_f32_16x16x32_bf16 v[188:191], v[36:39], v[76:79], v[188:191]
    s_setprio 0
    ds_read_b128 v[116:119], v17 offset:43008
    v_mfma_f32_16x16x32_bf16 v[192:195], v[40:43], v[48:51], v[192:195]
    buffer_load_dwordx4 v3, s[20:23], s32 offen offset:1024 lds
    ds_read_b128 v[120:123], v17 offset:45056
    v_mfma_f32_16x16x32_bf16 v[196:199], v[40:43], v[52:55], v[196:199]
    v_mfma_f32_16x16x32_bf16 v[200:203], v[40:43], v[56:59], v[200:203]
    ds_read_b128 v[124:127], v17 offset:47104
    v_mfma_f32_16x16x32_bf16 v[204:207], v[40:43], v[60:63], v[204:207]
    v_mfma_f32_16x16x32_bf16 v[208:211], v[40:43], v[64:67], v[208:211]
    v_mfma_f32_16x16x32_bf16 v[212:215], v[40:43], v[68:71], v[212:215]
    s_add_u32 s32, s32, 0x70000
    v_mfma_f32_16x16x32_bf16 v[216:219], v[40:43], v[72:75], v[216:219]
    v_mfma_f32_16x16x32_bf16 v[220:223], v[40:43], v[76:79], v[220:223]
    v_mfma_f32_16x16x32_bf16 v[224:227], v[44:47], v[48:51], v[224:227]
    v_mfma_f32_16x16x32_bf16 v[228:231], v[44:47], v[52:55], v[228:231]
    v_mfma_f32_16x16x32_bf16 v[232:235], v[44:47], v[56:59], v[232:235]
    v_mfma_f32_16x16x32_bf16 v[236:239], v[44:47], v[60:63], v[236:239]
    v_mfma_f32_16x16x32_bf16 v[240:243], v[44:47], v[64:67], v[240:243]
    v_mfma_f32_16x16x32_bf16 v[244:247], v[44:47], v[68:71], v[244:247]
    v_mfma_f32_16x16x32_bf16 v[248:251], v[44:47], v[72:75], v[248:251]
    v_mfma_f32_16x16x32_bf16 v[252:255], v[44:47], v[76:79], v[252:255]
    s_waitcnt lgkmcnt(0)
    s_setprio 3
    s_waitcnt vmcnt(4)
    s_barrier
    v_mfma_f32_16x16x32_bf16 v[128:131], v[80:83], v[96:99], v[128:131]
    s_add_u32 m0, s35, 0x10000
    v_mfma_f32_16x16x32_bf16 v[132:135], v[80:83], v[100:103], v[132:135]
    ds_read_b64_tr_b16 v[32:33], v12 offset:0
    v_mfma_f32_16x16x32_bf16 v[136:139], v[80:83], v[104:107], v[136:139]
    ds_read_b64_tr_b16 v[34:35], v12 offset:1024
    v_mfma_f32_16x16x32_bf16 v[140:143], v[80:83], v[108:111], v[140:143]
    ds_read_b64_tr_b16 v[36:37], v13 offset:0
    v_mfma_f32_16x16x32_bf16 v[144:147], v[80:83], v[112:115], v[144:147]
    buffer_load_dwordx4 v4, s[12:15], s33 offen offset:0 sc1 lds
    ds_read_b64_tr_b16 v[38:39], v13 offset:1024
    v_mfma_f32_16x16x32_bf16 v[148:151], v[80:83], v[116:119], v[148:151]
    ds_read_b64_tr_b16 v[40:41], v12 offset:16384
    v_mfma_f32_16x16x32_bf16 v[152:155], v[80:83], v[120:123], v[152:155]
    v_mfma_f32_16x16x32_bf16 v[156:159], v[80:83], v[124:127], v[156:159]
    ds_read_b64_tr_b16 v[42:43], v12 offset:17408
    v_mfma_f32_16x16x32_bf16 v[160:163], v[84:87], v[96:99], v[160:163]
    buffer_load_dwordx4 v5, s[12:15], s33 offen offset:1024 sc1 lds
    ds_read_b64_tr_b16 v[44:45], v13 offset:16384
    v_mfma_f32_16x16x32_bf16 v[164:167], v[84:87], v[100:103], v[164:167]
    ds_read_b64_tr_b16 v[46:47], v13 offset:17408
    v_mfma_f32_16x16x32_bf16 v[168:171], v[84:87], v[104:107], v[168:171]
    ds_read_b128 v[48:51], v14 offset:0
    v_mfma_f32_16x16x32_bf16 v[172:175], v[84:87], v[108:111], v[172:175]
    ds_read_b128 v[52:55], v14 offset:2048
    v_mfma_f32_16x16x32_bf16 v[176:179], v[84:87], v[112:115], v[176:179]
    buffer_load_dwordx4 v6, s[12:15], s33 offen offset:2048 sc1 lds
    v_mfma_f32_16x16x32_bf16 v[180:183], v[84:87], v[116:119], v[180:183]
    ds_read_b128 v[56:59], v14 offset:4096
    v_mfma_f32_16x16x32_bf16 v[184:187], v[84:87], v[120:123], v[184:187]
    ds_read_b128 v[60:63], v14 offset:6144
    v_mfma_f32_16x16x32_bf16 v[188:191], v[84:87], v[124:127], v[188:191]
    s_setprio 2
    ds_read_b128 v[64:67], v14 offset:8192
    v_mfma_f32_16x16x32_bf16 v[192:195], v[88:91], v[96:99], v[192:195]
    buffer_load_dwordx4 v7, s[12:15], s33 offen offset:3072 sc1 lds
    ds_read_b128 v[68:71], v14 offset:10240
    v_mfma_f32_16x16x32_bf16 v[196:199], v[88:91], v[100:103], v[196:199]
    ds_read_b128 v[72:75], v14 offset:12288
    v_mfma_f32_16x16x32_bf16 v[200:203], v[88:91], v[104:107], v[200:203]
    v_mfma_f32_16x16x32_bf16 v[204:207], v[88:91], v[108:111], v[204:207]
    ds_read_b128 v[76:79], v14 offset:14336
    v_mfma_f32_16x16x32_bf16 v[208:211], v[88:91], v[112:115], v[208:211]
    s_add_u32 s33, s33, 128
    v_mfma_f32_16x16x32_bf16 v[212:215], v[88:91], v[116:119], v[212:215]
    v_mfma_f32_16x16x32_bf16 v[216:219], v[88:91], v[120:123], v[216:219]
    v_mfma_f32_16x16x32_bf16 v[220:223], v[88:91], v[124:127], v[220:223]
    v_mfma_f32_16x16x32_bf16 v[224:227], v[92:95], v[96:99], v[224:227]
    v_mfma_f32_16x16x32_bf16 v[228:231], v[92:95], v[100:103], v[228:231]
    v_mfma_f32_16x16x32_bf16 v[232:235], v[92:95], v[104:107], v[232:235]
    s_add_u32 m0, s34, 0x18000
    v_mfma_f32_16x16x32_bf16 v[236:239], v[92:95], v[108:111], v[236:239]
    v_mfma_f32_16x16x32_bf16 v[240:243], v[92:95], v[112:115], v[240:243]
    v_mfma_f32_16x16x32_bf16 v[244:247], v[92:95], v[116:119], v[244:247]
    v_mfma_f32_16x16x32_bf16 v[248:251], v[92:95], v[120:123], v[248:251]
    buffer_load_dwordx4 v2, s[16:19], s32 offen offset:0 lds
    v_mfma_f32_16x16x32_bf16 v[252:255], v[92:95], v[124:127], v[252:255]
    s_setprio 1
    s_waitcnt lgkmcnt(0)
    v_mfma_f32_16x16x32_bf16 v[128:131], v[32:35], v[48:51], v[128:131]
    ds_read_b64_tr_b16 v[80:81], v12 offset:8192
    v_mfma_f32_16x16x32_bf16 v[132:135], v[32:35], v[52:55], v[132:135]
    ds_read_b64_tr_b16 v[82:83], v12 offset:9216
    v_mfma_f32_16x16x32_bf16 v[136:139], v[32:35], v[56:59], v[136:139]
    ds_read_b64_tr_b16 v[84:85], v13 offset:8192
    v_mfma_f32_16x16x32_bf16 v[140:143], v[32:35], v[60:63], v[140:143]
    buffer_load_dwordx4 v3, s[16:19], s32 offen offset:1024 lds
    ds_read_b64_tr_b16 v[86:87], v13 offset:9216
    v_mfma_f32_16x16x32_bf16 v[144:147], v[32:35], v[64:67], v[144:147]
    ds_read_b64_tr_b16 v[88:89], v12 offset:24576
    v_mfma_f32_16x16x32_bf16 v[148:151], v[32:35], v[68:71], v[148:151]
    v_mfma_f32_16x16x32_bf16 v[152:155], v[32:35], v[72:75], v[152:155]
    ds_read_b64_tr_b16 v[90:91], v12 offset:25600
    v_mfma_f32_16x16x32_bf16 v[156:159], v[32:35], v[76:79], v[156:159]
    ds_read_b64_tr_b16 v[92:93], v13 offset:24576
    s_add_u32 m0, s34, 0x1c000
    v_mfma_f32_16x16x32_bf16 v[160:163], v[36:39], v[48:51], v[160:163]
    ds_read_b64_tr_b16 v[94:95], v13 offset:25600
    v_mfma_f32_16x16x32_bf16 v[164:167], v[36:39], v[52:55], v[164:167]
    ds_read_b128 v[96:99], v15 offset:0
    v_mfma_f32_16x16x32_bf16 v[168:171], v[36:39], v[56:59], v[168:171]
    ds_read_b128 v[100:103], v15 offset:2048
    v_mfma_f32_16x16x32_bf16 v[172:175], v[36:39], v[60:63], v[172:175]
    v_mfma_f32_16x16x32_bf16 v[176:179], v[36:39], v[64:67], v[176:179]
    buffer_load_dwordx4 v2, s[20:23], s32 offen offset:0 lds
    ds_read_b128 v[104:107], v15 offset:4096
    v_mfma_f32_16x16x32_bf16 v[180:183], v[36:39], v[68:71], v[180:183]
    ds_read_b128 v[108:111], v15 offset:6144
    v_mfma_f32_16x16x32_bf16 v[184:187], v[36:39], v[72:75], v[184:187]
    ds_read_b128 v[112:115], v15 offset:8192
    v_mfma_f32_16x16x32_bf16 v[188:191], v[36:39], v[76:79], v[188:191]
    s_setprio 0
    ds_read_b128 v[116:119], v15 offset:10240
    v_mfma_f32_16x16x32_bf16 v[192:195], v[40:43], v[48:51], v[192:195]
    buffer_load_dwordx4 v3, s[20:23], s32 offen offset:1024 lds
    ds_read_b128 v[120:123], v15 offset:12288
    v_mfma_f32_16x16x32_bf16 v[196:199], v[40:43], v[52:55], v[196:199]
    v_mfma_f32_16x16x32_bf16 v[200:203], v[40:43], v[56:59], v[200:203]
    ds_read_b128 v[124:127], v15 offset:14336
    v_mfma_f32_16x16x32_bf16 v[204:207], v[40:43], v[60:63], v[204:207]
    v_mfma_f32_16x16x32_bf16 v[208:211], v[40:43], v[64:67], v[208:211]
    v_mfma_f32_16x16x32_bf16 v[212:215], v[40:43], v[68:71], v[212:215]
    s_add_u32 s32, s32, 0x70000
    v_mfma_f32_16x16x32_bf16 v[216:219], v[40:43], v[72:75], v[216:219]
    v_mfma_f32_16x16x32_bf16 v[220:223], v[40:43], v[76:79], v[220:223]
    v_mfma_f32_16x16x32_bf16 v[224:227], v[44:47], v[48:51], v[224:227]
    v_mfma_f32_16x16x32_bf16 v[228:231], v[44:47], v[52:55], v[228:231]
    v_mfma_f32_16x16x32_bf16 v[232:235], v[44:47], v[56:59], v[232:235]
    v_mfma_f32_16x16x32_bf16 v[236:239], v[44:47], v[60:63], v[236:239]
    v_mfma_f32_16x16x32_bf16 v[240:243], v[44:47], v[64:67], v[240:243]
    v_mfma_f32_16x16x32_bf16 v[244:247], v[44:47], v[68:71], v[244:247]
    v_mfma_f32_16x16x32_bf16 v[248:251], v[44:47], v[72:75], v[248:251]
    v_mfma_f32_16x16x32_bf16 v[252:255], v[44:47], v[76:79], v[252:255]
    s_waitcnt lgkmcnt(0)
    s_setprio 3
    s_waitcnt vmcnt(4)
    s_barrier
    v_mfma_f32_16x16x32_bf16 v[128:131], v[80:83], v[96:99], v[128:131]
    s_add_u32 m0, s35, 0x20000
    v_mfma_f32_16x16x32_bf16 v[132:135], v[80:83], v[100:103], v[132:135]
    ds_read_b64_tr_b16 v[32:33], v8 offset:32768
    v_mfma_f32_16x16x32_bf16 v[136:139], v[80:83], v[104:107], v[136:139]
    ds_read_b64_tr_b16 v[34:35], v8 offset:33792
    v_mfma_f32_16x16x32_bf16 v[140:143], v[80:83], v[108:111], v[140:143]
    ds_read_b64_tr_b16 v[36:37], v9 offset:32768
    v_mfma_f32_16x16x32_bf16 v[144:147], v[80:83], v[112:115], v[144:147]
    buffer_load_dwordx4 v4, s[12:15], s33 offen offset:0 sc1 lds
    ds_read_b64_tr_b16 v[38:39], v9 offset:33792
    v_mfma_f32_16x16x32_bf16 v[148:151], v[80:83], v[116:119], v[148:151]
    ds_read_b64_tr_b16 v[40:41], v8 offset:49152
    v_mfma_f32_16x16x32_bf16 v[152:155], v[80:83], v[120:123], v[152:155]
    v_mfma_f32_16x16x32_bf16 v[156:159], v[80:83], v[124:127], v[156:159]
    ds_read_b64_tr_b16 v[42:43], v8 offset:50176
    v_mfma_f32_16x16x32_bf16 v[160:163], v[84:87], v[96:99], v[160:163]
    buffer_load_dwordx4 v5, s[12:15], s33 offen offset:1024 sc1 lds
    ds_read_b64_tr_b16 v[44:45], v9 offset:49152
    v_mfma_f32_16x16x32_bf16 v[164:167], v[84:87], v[100:103], v[164:167]
    ds_read_b64_tr_b16 v[46:47], v9 offset:50176
    v_mfma_f32_16x16x32_bf16 v[168:171], v[84:87], v[104:107], v[168:171]
    ds_read_b128 v[48:51], v16 offset:0
    v_mfma_f32_16x16x32_bf16 v[172:175], v[84:87], v[108:111], v[172:175]
    ds_read_b128 v[52:55], v16 offset:2048
    v_mfma_f32_16x16x32_bf16 v[176:179], v[84:87], v[112:115], v[176:179]
    buffer_load_dwordx4 v6, s[12:15], s33 offen offset:2048 sc1 lds
    v_mfma_f32_16x16x32_bf16 v[180:183], v[84:87], v[116:119], v[180:183]
    ds_read_b128 v[56:59], v16 offset:4096
    v_mfma_f32_16x16x32_bf16 v[184:187], v[84:87], v[120:123], v[184:187]
    ds_read_b128 v[60:63], v16 offset:6144
    v_mfma_f32_16x16x32_bf16 v[188:191], v[84:87], v[124:127], v[188:191]
    s_setprio 2
    ds_read_b128 v[64:67], v16 offset:8192
    v_mfma_f32_16x16x32_bf16 v[192:195], v[88:91], v[96:99], v[192:195]
    buffer_load_dwordx4 v7, s[12:15], s33 offen offset:3072 sc1 lds
    ds_read_b128 v[68:71], v16 offset:10240
    v_mfma_f32_16x16x32_bf16 v[196:199], v[88:91], v[100:103], v[196:199]
    ds_read_b128 v[72:75], v16 offset:12288
    v_mfma_f32_16x16x32_bf16 v[200:203], v[88:91], v[104:107], v[200:203]
    v_mfma_f32_16x16x32_bf16 v[204:207], v[88:91], v[108:111], v[204:207]
    ds_read_b128 v[76:79], v16 offset:14336
    v_mfma_f32_16x16x32_bf16 v[208:211], v[88:91], v[112:115], v[208:211]
    s_add_u32 s33, s33, 128
    v_mfma_f32_16x16x32_bf16 v[212:215], v[88:91], v[116:119], v[212:215]
    v_mfma_f32_16x16x32_bf16 v[216:219], v[88:91], v[120:123], v[216:219]
    v_mfma_f32_16x16x32_bf16 v[220:223], v[88:91], v[124:127], v[220:223]
    v_mfma_f32_16x16x32_bf16 v[224:227], v[92:95], v[96:99], v[224:227]
    v_mfma_f32_16x16x32_bf16 v[228:231], v[92:95], v[100:103], v[228:231]
    v_mfma_f32_16x16x32_bf16 v[232:235], v[92:95], v[104:107], v[232:235]
    s_add_u32 m0, s34, 0x0
    v_mfma_f32_16x16x32_bf16 v[236:239], v[92:95], v[108:111], v[236:239]
    v_mfma_f32_16x16x32_bf16 v[240:243], v[92:95], v[112:115], v[240:243]
    v_mfma_f32_16x16x32_bf16 v[244:247], v[92:95], v[116:119], v[244:247]
    v_mfma_f32_16x16x32_bf16 v[248:251], v[92:95], v[120:123], v[248:251]
    buffer_load_dwordx4 v2, s[16:19], s32 offen offset:0 lds
    v_mfma_f32_16x16x32_bf16 v[252:255], v[92:95], v[124:127], v[252:255]
    s_setprio 1
    s_waitcnt lgkmcnt(0)
    v_mfma_f32_16x16x32_bf16 v[128:131], v[32:35], v[48:51], v[128:131]
    ds_read_b64_tr_b16 v[80:81], v8 offset:40960
    v_mfma_f32_16x16x32_bf16 v[132:135], v[32:35], v[52:55], v[132:135]
    ds_read_b64_tr_b16 v[82:83], v8 offset:41984
    v_mfma_f32_16x16x32_bf16 v[136:139], v[32:35], v[56:59], v[136:139]
    ds_read_b64_tr_b16 v[84:85], v9 offset:40960
    v_mfma_f32_16x16x32_bf16 v[140:143], v[32:35], v[60:63], v[140:143]
    buffer_load_dwordx4 v3, s[16:19], s32 offen offset:1024 lds
    ds_read_b64_tr_b16 v[86:87], v9 offset:41984
    v_mfma_f32_16x16x32_bf16 v[144:147], v[32:35], v[64:67], v[144:147]
    ds_read_b64_tr_b16 v[88:89], v8 offset:57344
    v_mfma_f32_16x16x32_bf16 v[148:151], v[32:35], v[68:71], v[148:151]
    v_mfma_f32_16x16x32_bf16 v[152:155], v[32:35], v[72:75], v[152:155]
    ds_read_b64_tr_b16 v[90:91], v8 offset:58368
    v_mfma_f32_16x16x32_bf16 v[156:159], v[32:35], v[76:79], v[156:159]
    ds_read_b64_tr_b16 v[92:93], v9 offset:57344
    s_add_u32 m0, s34, 0x4000
    v_mfma_f32_16x16x32_bf16 v[160:163], v[36:39], v[48:51], v[160:163]
    ds_read_b64_tr_b16 v[94:95], v9 offset:58368
    v_mfma_f32_16x16x32_bf16 v[164:167], v[36:39], v[52:55], v[164:167]
    ds_read_b128 v[96:99], v17 offset:0
    v_mfma_f32_16x16x32_bf16 v[168:171], v[36:39], v[56:59], v[168:171]
    ds_read_b128 v[100:103], v17 offset:2048
    v_mfma_f32_16x16x32_bf16 v[172:175], v[36:39], v[60:63], v[172:175]
    v_mfma_f32_16x16x32_bf16 v[176:179], v[36:39], v[64:67], v[176:179]
    buffer_load_dwordx4 v2, s[20:23], s32 offen offset:0 lds
    ds_read_b128 v[104:107], v17 offset:4096
    v_mfma_f32_16x16x32_bf16 v[180:183], v[36:39], v[68:71], v[180:183]
    ds_read_b128 v[108:111], v17 offset:6144
    v_mfma_f32_16x16x32_bf16 v[184:187], v[36:39], v[72:75], v[184:187]
    ds_read_b128 v[112:115], v17 offset:8192
    v_mfma_f32_16x16x32_bf16 v[188:191], v[36:39], v[76:79], v[188:191]
    s_setprio 0
    ds_read_b128 v[116:119], v17 offset:10240
    v_mfma_f32_16x16x32_bf16 v[192:195], v[40:43], v[48:51], v[192:195]
    buffer_load_dwordx4 v3, s[20:23], s32 offen offset:1024 lds
    ds_read_b128 v[120:123], v17 offset:12288
    v_mfma_f32_16x16x32_bf16 v[196:199], v[40:43], v[52:55], v[196:199]
    v_mfma_f32_16x16x32_bf16 v[200:203], v[40:43], v[56:59], v[200:203]
    ds_read_b128 v[124:127], v17 offset:14336
    v_mfma_f32_16x16x32_bf16 v[204:207], v[40:43], v[60:63], v[204:207]
    v_mfma_f32_16x16x32_bf16 v[208:211], v[40:43], v[64:67], v[208:211]
    v_mfma_f32_16x16x32_bf16 v[212:215], v[40:43], v[68:71], v[212:215]
    s_add_u32 s32, s32, 0x70000
    v_mfma_f32_16x16x32_bf16 v[216:219], v[40:43], v[72:75], v[216:219]
    v_mfma_f32_16x16x32_bf16 v[220:223], v[40:43], v[76:79], v[220:223]
    v_mfma_f32_16x16x32_bf16 v[224:227], v[44:47], v[48:51], v[224:227]
    v_mfma_f32_16x16x32_bf16 v[228:231], v[44:47], v[52:55], v[228:231]
    s_mov_b64 exec, 0xff
    buffer_load_dword v29, v28, s[48:51], s46 offen
    s_mov_b64 exec, -1
    v_mfma_f32_16x16x32_bf16 v[232:235], v[44:47], v[56:59], v[232:235]
    v_mfma_f32_16x16x32_bf16 v[236:239], v[44:47], v[60:63], v[236:239]
    v_mfma_f32_16x16x32_bf16 v[240:243], v[44:47], v[64:67], v[240:243]
    v_mfma_f32_16x16x32_bf16 v[244:247], v[44:47], v[68:71], v[244:247]
    v_mfma_f32_16x16x32_bf16 v[248:251], v[44:47], v[72:75], v[248:251]
    s_add_u32 s46, s46, 1835008
    v_mfma_f32_16x16x32_bf16 v[252:255], v[44:47], v[76:79], v[252:255]
    s_waitcnt lgkmcnt(0)
    s_setprio 3
    s_waitcnt vmcnt(5)
    s_barrier
    v_mfma_f32_16x16x32_bf16 v[128:131], v[80:83], v[96:99], v[128:131]
    s_add_u32 m0, s35, 0x8000
    v_mfma_f32_16x16x32_bf16 v[132:135], v[80:83], v[100:103], v[132:135]
    ds_read_b64_tr_b16 v[32:33], v10 offset:32768
    v_mfma_f32_16x16x32_bf16 v[136:139], v[80:83], v[104:107], v[136:139]
    ds_read_b64_tr_b16 v[34:35], v10 offset:33792
    v_mfma_f32_16x16x32_bf16 v[140:143], v[80:83], v[108:111], v[140:143]
    ds_read_b64_tr_b16 v[36:37], v11 offset:32768
    v_mfma_f32_16x16x32_bf16 v[144:147], v[80:83], v[112:115], v[144:147]
    buffer_load_dwordx4 v4, s[12:15], s33 offen offset:0 sc1 lds
    ds_read_b64_tr_b16 v[38:39], v11 offset:33792
    v_mfma_f32_16x16x32_bf16 v[148:151], v[80:83], v[116:119], v[148:151]
    ds_read_b64_tr_b16 v[40:41], v10 offset:49152
    v_mfma_f32_16x16x32_bf16 v[152:155], v[80:83], v[120:123], v[152:155]
    v_mfma_f32_16x16x32_bf16 v[156:159], v[80:83], v[124:127], v[156:159]
    ds_read_b64_tr_b16 v[42:43], v10 offset:50176
    v_mfma_f32_16x16x32_bf16 v[160:163], v[84:87], v[96:99], v[160:163]
    buffer_load_dwordx4 v5, s[12:15], s33 offen offset:1024 sc1 lds
    ds_read_b64_tr_b16 v[44:45], v11 offset:49152
    v_mfma_f32_16x16x32_bf16 v[164:167], v[84:87], v[100:103], v[164:167]
    ds_read_b64_tr_b16 v[46:47], v11 offset:50176
    v_mfma_f32_16x16x32_bf16 v[168:171], v[84:87], v[104:107], v[168:171]
    ds_read_b128 v[48:51], v18 offset:0
    v_mfma_f32_16x16x32_bf16 v[172:175], v[84:87], v[108:111], v[172:175]
    ds_read_b128 v[52:55], v18 offset:2048
    v_mfma_f32_16x16x32_bf16 v[176:179], v[84:87], v[112:115], v[176:179]
    buffer_load_dwordx4 v6, s[12:15], s33 offen offset:2048 sc1 lds
    v_mfma_f32_16x16x32_bf16 v[180:183], v[84:87], v[116:119], v[180:183]
    ds_read_b128 v[56:59], v18 offset:4096
    v_mfma_f32_16x16x32_bf16 v[184:187], v[84:87], v[120:123], v[184:187]
    ds_read_b128 v[60:63], v18 offset:6144
    v_mfma_f32_16x16x32_bf16 v[188:191], v[84:87], v[124:127], v[188:191]
    s_setprio 2
    ds_read_b128 v[64:67], v18 offset:8192
    v_mfma_f32_16x16x32_bf16 v[192:195], v[88:91], v[96:99], v[192:195]
    buffer_load_dwordx4 v7, s[12:15], s33 offen offset:3072 sc1 lds
    ds_read_b128 v[68:71], v18 offset:10240
    v_mfma_f32_16x16x32_bf16 v[196:199], v[88:91], v[100:103], v[196:199]
    ds_read_b128 v[72:75], v18 offset:12288
    v_mfma_f32_16x16x32_bf16 v[200:203], v[88:91], v[104:107], v[200:203]
    v_mfma_f32_16x16x32_bf16 v[204:207], v[88:91], v[108:111], v[204:207]
    ds_read_b128 v[76:79], v18 offset:14336
    v_mfma_f32_16x16x32_bf16 v[208:211], v[88:91], v[112:115], v[208:211]
    s_add_u32 s33, s33, 128
    v_mfma_f32_16x16x32_bf16 v[212:215], v[88:91], v[116:119], v[212:215]
    v_mfma_f32_16x16x32_bf16 v[216:219], v[88:91], v[120:123], v[216:219]
    v_mfma_f32_16x16x32_bf16 v[220:223], v[88:91], v[124:127], v[220:223]
    v_mfma_f32_16x16x32_bf16 v[224:227], v[92:95], v[96:99], v[224:227]
    v_mfma_f32_16x16x32_bf16 v[228:231], v[92:95], v[100:103], v[228:231]
    v_mfma_f32_16x16x32_bf16 v[232:235], v[92:95], v[104:107], v[232:235]
    s_add_u32 m0, s34, 0x10000
    v_mfma_f32_16x16x32_bf16 v[236:239], v[92:95], v[108:111], v[236:239]
    v_mfma_f32_16x16x32_bf16 v[240:243], v[92:95], v[112:115], v[240:243]
    v_mfma_f32_16x16x32_bf16 v[244:247], v[92:95], v[116:119], v[244:247]
    v_mfma_f32_16x16x32_bf16 v[248:251], v[92:95], v[120:123], v[248:251]
    buffer_load_dwordx4 v2, s[16:19], s32 offen offset:0 lds
    v_mfma_f32_16x16x32_bf16 v[252:255], v[92:95], v[124:127], v[252:255]
    s_setprio 1
    s_waitcnt lgkmcnt(0)
    v_mfma_f32_16x16x32_bf16 v[128:131], v[32:35], v[48:51], v[128:131]
    ds_read_b64_tr_b16 v[80:81], v10 offset:40960
    v_mfma_f32_16x16x32_bf16 v[132:135], v[32:35], v[52:55], v[132:135]
    ds_read_b64_tr_b16 v[82:83], v10 offset:41984
    v_mfma_f32_16x16x32_bf16 v[136:139], v[32:35], v[56:59], v[136:139]
    ds_read_b64_tr_b16 v[84:85], v11 offset:40960
    v_mfma_f32_16x16x32_bf16 v[140:143], v[32:35], v[60:63], v[140:143]
    buffer_load_dwordx4 v3, s[16:19], s32 offen offset:1024 lds
    ds_read_b64_tr_b16 v[86:87], v11 offset:41984
    v_mfma_f32_16x16x32_bf16 v[144:147], v[32:35], v[64:67], v[144:147]
    ds_read_b64_tr_b16 v[88:89], v10 offset:57344
    v_mfma_f32_16x16x32_bf16 v[148:151], v[32:35], v[68:71], v[148:151]
    v_mfma_f32_16x16x32_bf16 v[152:155], v[32:35], v[72:75], v[152:155]
    ds_read_b64_tr_b16 v[90:91], v10 offset:58368
    v_mfma_f32_16x16x32_bf16 v[156:159], v[32:35], v[76:79], v[156:159]
    ds_read_b64_tr_b16 v[92:93], v11 offset:57344
    s_add_u32 m0, s34, 0x14000
    v_mfma_f32_16x16x32_bf16 v[160:163], v[36:39], v[48:51], v[160:163]
    ds_read_b64_tr_b16 v[94:95], v11 offset:58368
    v_mfma_f32_16x16x32_bf16 v[164:167], v[36:39], v[52:55], v[164:167]
    ds_read_b128 v[96:99], v19 offset:0
    v_mfma_f32_16x16x32_bf16 v[168:171], v[36:39], v[56:59], v[168:171]
    ds_read_b128 v[100:103], v19 offset:2048
    v_mfma_f32_16x16x32_bf16 v[172:175], v[36:39], v[60:63], v[172:175]
    v_mfma_f32_16x16x32_bf16 v[176:179], v[36:39], v[64:67], v[176:179]
    buffer_load_dwordx4 v2, s[20:23], s32 offen offset:0 lds
    ds_read_b128 v[104:107], v19 offset:4096
    v_mfma_f32_16x16x32_bf16 v[180:183], v[36:39], v[68:71], v[180:183]
    ds_read_b128 v[108:111], v19 offset:6144
    v_mfma_f32_16x16x32_bf16 v[184:187], v[36:39], v[72:75], v[184:187]
    ds_read_b128 v[112:115], v19 offset:8192
    v_mfma_f32_16x16x32_bf16 v[188:191], v[36:39], v[76:79], v[188:191]
    s_setprio 0
    ds_read_b128 v[116:119], v19 offset:10240
    v_mfma_f32_16x16x32_bf16 v[192:195], v[40:43], v[48:51], v[192:195]
    buffer_load_dwordx4 v3, s[20:23], s32 offen offset:1024 lds
    ds_read_b128 v[120:123], v19 offset:12288
    v_mfma_f32_16x16x32_bf16 v[196:199], v[40:43], v[52:55], v[196:199]
    v_mfma_f32_16x16x32_bf16 v[200:203], v[40:43], v[56:59], v[200:203]
    ds_read_b128 v[124:127], v19 offset:14336
    v_mfma_f32_16x16x32_bf16 v[204:207], v[40:43], v[60:63], v[204:207]
    v_mfma_f32_16x16x32_bf16 v[208:211], v[40:43], v[64:67], v[208:211]
    v_mfma_f32_16x16x32_bf16 v[212:215], v[40:43], v[68:71], v[212:215]
    s_add_u32 s32, s32, 0x70000
    v_mfma_f32_16x16x32_bf16 v[216:219], v[40:43], v[72:75], v[216:219]
    v_mfma_f32_16x16x32_bf16 v[220:223], v[40:43], v[76:79], v[220:223]
    v_mfma_f32_16x16x32_bf16 v[224:227], v[44:47], v[48:51], v[224:227]
    v_mfma_f32_16x16x32_bf16 v[228:231], v[44:47], v[52:55], v[228:231]
    s_mov_b64 exec, 0xff
    buffer_load_dword v29, v28, s[48:51], s46 offen
    s_mov_b64 exec, -1
    v_mfma_f32_16x16x32_bf16 v[232:235], v[44:47], v[56:59], v[232:235]
    v_mfma_f32_16x16x32_bf16 v[236:239], v[44:47], v[60:63], v[236:239]
    v_mfma_f32_16x16x32_bf16 v[240:243], v[44:47], v[64:67], v[240:243]
    v_mfma_f32_16x16x32_bf16 v[244:247], v[44:47], v[68:71], v[244:247]
    v_mfma_f32_16x16x32_bf16 v[248:251], v[44:47], v[72:75], v[248:251]
    s_add_u32 s46, s46, 1835008
    v_mfma_f32_16x16x32_bf16 v[252:255], v[44:47], v[76:79], v[252:255]
    s_waitcnt lgkmcnt(0)
    s_setprio 3
    s_waitcnt vmcnt(5)
    s_barrier
    v_mfma_f32_16x16x32_bf16 v[128:131], v[80:83], v[96:99], v[128:131]
    s_add_u32 m0, s35, 0x18000
    v_mfma_f32_16x16x32_bf16 v[132:135], v[80:83], v[100:103], v[132:135]
    ds_read_b64_tr_b16 v[32:33], v8 offset:0
    v_mfma_f32_16x16x32_bf16 v[136:139], v[80:83], v[104:107], v[136:139]
    ds_read_b64_tr_b16 v[34:35], v8 offset:1024
    v_mfma_f32_16x16x32_bf16 v[140:143], v[80:83], v[108:111], v[140:143]
    ds_read_b64_tr_b16 v[36:37], v9 offset:0
    v_mfma_f32_16x16x32_bf16 v[144:147], v[80:83], v[112:115], v[144:147]
    buffer_load_dwordx4 v4, s[12:15], s33 offen offset:0 sc1 lds
    ds_read_b64_tr_b16 v[38:39], v9 offset:1024
    v_mfma_f32_16x16x32_bf16 v[148:151], v[80:83], v[116:119], v[148:151]
    ds_read_b64_tr_b16 v[40:41], v8 offset:16384
    v_mfma_f32_16x16x32_bf16 v[152:155], v[80:83], v[120:123], v[152:155]
    v_mfma_f32_16x16x32_bf16 v[156:159], v[80:83], v[124:127], v[156:159]
    ds_read_b64_tr_b16 v[42:43], v8 offset:17408
    v_mfma_f32_16x16x32_bf16 v[160:163], v[84:87], v[96:99], v[160:163]
    buffer_load_dwordx4 v5, s[12:15], s33 offen offset:1024 sc1 lds
    ds_read_b64_tr_b16 v[44:45], v9 offset:16384
    v_mfma_f32_16x16x32_bf16 v[164:167], v[84:87], v[100:103], v[164:167]
    ds_read_b64_tr_b16 v[46:47], v9 offset:17408
    v_mfma_f32_16x16x32_bf16 v[168:171], v[84:87], v[104:107], v[168:171]
    ds_read_b128 v[48:51], v14 offset:32768
    v_mfma_f32_16x16x32_bf16 v[172:175], v[84:87], v[108:111], v[172:175]
    ds_read_b128 v[52:55], v14 offset:34816
    v_mfma_f32_16x16x32_bf16 v[176:179], v[84:87], v[112:115], v[176:179]
    buffer_load_dwordx4 v6, s[12:15], s33 offen offset:2048 sc1 lds
    v_mfma_f32_16x16x32_bf16 v[180:183], v[84:87], v[116:119], v[180:183]
    ds_read_b128 v[56:59], v14 offset:36864
    v_mfma_f32_16x16x32_bf16 v[184:187], v[84:87], v[120:123], v[184:187]
    ds_read_b128 v[60:63], v14 offset:38912
    v_mfma_f32_16x16x32_bf16 v[188:191], v[84:87], v[124:127], v[188:191]
    s_setprio 2
    ds_read_b128 v[64:67], v14 offset:40960
    v_mfma_f32_16x16x32_bf16 v[192:195], v[88:91], v[96:99], v[192:195]
    buffer_load_dwordx4 v7, s[12:15], s33 offen offset:3072 sc1 lds
    ds_read_b128 v[68:71], v14 offset:43008
    v_mfma_f32_16x16x32_bf16 v[196:199], v[88:91], v[100:103], v[196:199]
    ds_read_b128 v[72:75], v14 offset:45056
    v_mfma_f32_16x16x32_bf16 v[200:203], v[88:91], v[104:107], v[200:203]
    v_mfma_f32_16x16x32_bf16 v[204:207], v[88:91], v[108:111], v[204:207]
    ds_read_b128 v[76:79], v14 offset:47104
    v_mfma_f32_16x16x32_bf16 v[208:211], v[88:91], v[112:115], v[208:211]
    s_add_u32 s33, s33, 128
    v_mfma_f32_16x16x32_bf16 v[212:215], v[88:91], v[116:119], v[212:215]
    v_mfma_f32_16x16x32_bf16 v[216:219], v[88:91], v[120:123], v[216:219]
    v_mfma_f32_16x16x32_bf16 v[220:223], v[88:91], v[124:127], v[220:223]
    v_mfma_f32_16x16x32_bf16 v[224:227], v[92:95], v[96:99], v[224:227]
    v_mfma_f32_16x16x32_bf16 v[228:231], v[92:95], v[100:103], v[228:231]
    v_mfma_f32_16x16x32_bf16 v[232:235], v[92:95], v[104:107], v[232:235]
    s_add_u32 m0, s34, 0x20000
    v_mfma_f32_16x16x32_bf16 v[236:239], v[92:95], v[108:111], v[236:239]
    v_mfma_f32_16x16x32_bf16 v[240:243], v[92:95], v[112:115], v[240:243]
    v_mfma_f32_16x16x32_bf16 v[244:247], v[92:95], v[116:119], v[244:247]
    v_mfma_f32_16x16x32_bf16 v[248:251], v[92:95], v[120:123], v[248:251]
    buffer_load_dwordx4 v2, s[16:19], s32 offen offset:0 lds
    v_mfma_f32_16x16x32_bf16 v[252:255], v[92:95], v[124:127], v[252:255]
    s_setprio 1
    s_waitcnt lgkmcnt(0)
    v_mfma_f32_16x16x32_bf16 v[128:131], v[32:35], v[48:51], v[128:131]
    ds_read_b64_tr_b16 v[80:81], v8 offset:8192
    v_mfma_f32_16x16x32_bf16 v[132:135], v[32:35], v[52:55], v[132:135]
    ds_read_b64_tr_b16 v[82:83], v8 offset:9216
    v_mfma_f32_16x16x32_bf16 v[136:139], v[32:35], v[56:59], v[136:139]
    ds_read_b64_tr_b16 v[84:85], v9 offset:8192
    v_mfma_f32_16x16x32_bf16 v[140:143], v[32:35], v[60:63], v[140:143]
    buffer_load_dwordx4 v3, s[16:19], s32 offen offset:1024 lds
    ds_read_b64_tr_b16 v[86:87], v9 offset:9216
    v_mfma_f32_16x16x32_bf16 v[144:147], v[32:35], v[64:67], v[144:147]
    ds_read_b64_tr_b16 v[88:89], v8 offset:24576
    v_mfma_f32_16x16x32_bf16 v[148:151], v[32:35], v[68:71], v[148:151]
    v_mfma_f32_16x16x32_bf16 v[152:155], v[32:35], v[72:75], v[152:155]
    ds_read_b64_tr_b16 v[90:91], v8 offset:25600
    v_mfma_f32_16x16x32_bf16 v[156:159], v[32:35], v[76:79], v[156:159]
    ds_read_b64_tr_b16 v[92:93], v9 offset:24576
    s_add_u32 m0, s34, 0x24000
    v_mfma_f32_16x16x32_bf16 v[160:163], v[36:39], v[48:51], v[160:163]
    ds_read_b64_tr_b16 v[94:95], v9 offset:25600
    v_mfma_f32_16x16x32_bf16 v[164:167], v[36:39], v[52:55], v[164:167]
    ds_read_b128 v[96:99], v15 offset:32768
    v_mfma_f32_16x16x32_bf16 v[168:171], v[36:39], v[56:59], v[168:171]
    ds_read_b128 v[100:103], v15 offset:34816
    v_mfma_f32_16x16x32_bf16 v[172:175], v[36:39], v[60:63], v[172:175]
    v_mfma_f32_16x16x32_bf16 v[176:179], v[36:39], v[64:67], v[176:179]
    buffer_load_dwordx4 v2, s[20:23], s32 offen offset:0 lds
    ds_read_b128 v[104:107], v15 offset:36864
    v_mfma_f32_16x16x32_bf16 v[180:183], v[36:39], v[68:71], v[180:183]
    ds_read_b128 v[108:111], v15 offset:38912
    v_mfma_f32_16x16x32_bf16 v[184:187], v[36:39], v[72:75], v[184:187]
    ds_read_b128 v[112:115], v15 offset:40960
    v_mfma_f32_16x16x32_bf16 v[188:191], v[36:39], v[76:79], v[188:191]
    s_setprio 0
    ds_read_b128 v[116:119], v15 offset:43008
    v_mfma_f32_16x16x32_bf16 v[192:195], v[40:43], v[48:51], v[192:195]
    buffer_load_dwordx4 v3, s[20:23], s32 offen offset:1024 lds
    ds_read_b128 v[120:123], v15 offset:45056
    v_mfma_f32_16x16x32_bf16 v[196:199], v[40:43], v[52:55], v[196:199]
    v_mfma_f32_16x16x32_bf16 v[200:203], v[40:43], v[56:59], v[200:203]
    ds_read_b128 v[124:127], v15 offset:47104
    v_mfma_f32_16x16x32_bf16 v[204:207], v[40:43], v[60:63], v[204:207]
    v_mfma_f32_16x16x32_bf16 v[208:211], v[40:43], v[64:67], v[208:211]
    v_mfma_f32_16x16x32_bf16 v[212:215], v[40:43], v[68:71], v[212:215]
    s_add_u32 s32, s32, 0x70000
    v_mfma_f32_16x16x32_bf16 v[216:219], v[40:43], v[72:75], v[216:219]
    v_mfma_f32_16x16x32_bf16 v[220:223], v[40:43], v[76:79], v[220:223]
    v_mfma_f32_16x16x32_bf16 v[224:227], v[44:47], v[48:51], v[224:227]
    v_mfma_f32_16x16x32_bf16 v[228:231], v[44:47], v[52:55], v[228:231]
    s_mov_b64 exec, 0xff
    buffer_load_dword v29, v28, s[48:51], s46 offen
    s_mov_b64 exec, -1
    v_mfma_f32_16x16x32_bf16 v[232:235], v[44:47], v[56:59], v[232:235]
    v_mfma_f32_16x16x32_bf16 v[236:239], v[44:47], v[60:63], v[236:239]
    v_mfma_f32_16x16x32_bf16 v[240:243], v[44:47], v[64:67], v[240:243]
    v_mfma_f32_16x16x32_bf16 v[244:247], v[44:47], v[68:71], v[244:247]
    v_mfma_f32_16x16x32_bf16 v[248:251], v[44:47], v[72:75], v[248:251]
    s_add_u32 s46, s46, 1835008
    v_mfma_f32_16x16x32_bf16 v[252:255], v[44:47], v[76:79], v[252:255]
    s_waitcnt lgkmcnt(0)
    s_setprio 3
    s_waitcnt vmcnt(5)
    s_barrier
    v_mfma_f32_16x16x32_bf16 v[128:131], v[80:83], v[96:99], v[128:131]
    s_add_u32 m0, s35, 0x0
    v_mfma_f32_16x16x32_bf16 v[132:135], v[80:83], v[100:103], v[132:135]
    ds_read_b64_tr_b16 v[32:33], v10 offset:0
    v_mfma_f32_16x16x32_bf16 v[136:139], v[80:83], v[104:107], v[136:139]
    ds_read_b64_tr_b16 v[34:35], v10 offset:1024
    v_mfma_f32_16x16x32_bf16 v[140:143], v[80:83], v[108:111], v[140:143]
    ds_read_b64_tr_b16 v[36:37], v11 offset:0
    v_mfma_f32_16x16x32_bf16 v[144:147], v[80:83], v[112:115], v[144:147]
    buffer_load_dwordx4 v4, s[12:15], s33 offen offset:0 sc1 lds
    ds_read_b64_tr_b16 v[38:39], v11 offset:1024
    v_mfma_f32_16x16x32_bf16 v[148:151], v[80:83], v[116:119], v[148:151]
    ds_read_b64_tr_b16 v[40:41], v10 offset:16384
    v_mfma_f32_16x16x32_bf16 v[152:155], v[80:83], v[120:123], v[152:155]
    v_mfma_f32_16x16x32_bf16 v[156:159], v[80:83], v[124:127], v[156:159]
    ds_read_b64_tr_b16 v[42:43], v10 offset:17408
    v_mfma_f32_16x16x32_bf16 v[160:163], v[84:87], v[96:99], v[160:163]
    buffer_load_dwordx4 v5, s[12:15], s33 offen offset:1024 sc1 lds
    ds_read_b64_tr_b16 v[44:45], v11 offset:16384
    v_mfma_f32_16x16x32_bf16 v[164:167], v[84:87], v[100:103], v[164:167]
    ds_read_b64_tr_b16 v[46:47], v11 offset:17408
    v_mfma_f32_16x16x32_bf16 v[168:171], v[84:87], v[104:107], v[168:171]
    ds_read_b128 v[48:51], v16 offset:32768
    v_mfma_f32_16x16x32_bf16 v[172:175], v[84:87], v[108:111], v[172:175]
    ds_read_b128 v[52:55], v16 offset:34816
    v_mfma_f32_16x16x32_bf16 v[176:179], v[84:87], v[112:115], v[176:179]
    buffer_load_dwordx4 v6, s[12:15], s33 offen offset:2048 sc1 lds
    v_mfma_f32_16x16x32_bf16 v[180:183], v[84:87], v[116:119], v[180:183]
    ds_read_b128 v[56:59], v16 offset:36864
    v_mfma_f32_16x16x32_bf16 v[184:187], v[84:87], v[120:123], v[184:187]
    ds_read_b128 v[60:63], v16 offset:38912
    v_mfma_f32_16x16x32_bf16 v[188:191], v[84:87], v[124:127], v[188:191]
    s_setprio 2
    ds_read_b128 v[64:67], v16 offset:40960
    v_mfma_f32_16x16x32_bf16 v[192:195], v[88:91], v[96:99], v[192:195]
    buffer_load_dwordx4 v7, s[12:15], s33 offen offset:3072 sc1 lds
    ds_read_b128 v[68:71], v16 offset:43008
    v_mfma_f32_16x16x32_bf16 v[196:199], v[88:91], v[100:103], v[196:199]
    ds_read_b128 v[72:75], v16 offset:45056
    v_mfma_f32_16x16x32_bf16 v[200:203], v[88:91], v[104:107], v[200:203]
    v_mfma_f32_16x16x32_bf16 v[204:207], v[88:91], v[108:111], v[204:207]
    ds_read_b128 v[76:79], v16 offset:47104
    v_mfma_f32_16x16x32_bf16 v[208:211], v[88:91], v[112:115], v[208:211]
    s_add_u32 s33, s33, 128
    v_mfma_f32_16x16x32_bf16 v[212:215], v[88:91], v[116:119], v[212:215]
    v_mfma_f32_16x16x32_bf16 v[216:219], v[88:91], v[120:123], v[216:219]
    v_mfma_f32_16x16x32_bf16 v[220:223], v[88:91], v[124:127], v[220:223]
    v_mfma_f32_16x16x32_bf16 v[224:227], v[92:95], v[96:99], v[224:227]
    v_mfma_f32_16x16x32_bf16 v[228:231], v[92:95], v[100:103], v[228:231]
    v_mfma_f32_16x16x32_bf16 v[232:235], v[92:95], v[104:107], v[232:235]
    s_add_u32 m0, s34, 0x8000
    v_mfma_f32_16x16x32_bf16 v[236:239], v[92:95], v[108:111], v[236:239]
    v_mfma_f32_16x16x32_bf16 v[240:243], v[92:95], v[112:115], v[240:243]
    v_mfma_f32_16x16x32_bf16 v[244:247], v[92:95], v[116:119], v[244:247]
    v_mfma_f32_16x16x32_bf16 v[248:251], v[92:95], v[120:123], v[248:251]
    buffer_load_dwordx4 v2, s[16:19], s32 offen offset:0 lds
    v_mfma_f32_16x16x32_bf16 v[252:255], v[92:95], v[124:127], v[252:255]
    s_setprio 1
    s_waitcnt lgkmcnt(0)
    v_mfma_f32_16x16x32_bf16 v[128:131], v[32:35], v[48:51], v[128:131]
    ds_read_b64_tr_b16 v[80:81], v10 offset:8192
    v_mfma_f32_16x16x32_bf16 v[132:135], v[32:35], v[52:55], v[132:135]
    ds_read_b64_tr_b16 v[82:83], v10 offset:9216
    v_mfma_f32_16x16x32_bf16 v[136:139], v[32:35], v[56:59], v[136:139]
    ds_read_b64_tr_b16 v[84:85], v11 offset:8192
    v_mfma_f32_16x16x32_bf16 v[140:143], v[32:35], v[60:63], v[140:143]
    buffer_load_dwordx4 v3, s[16:19], s32 offen offset:1024 lds
    ds_read_b64_tr_b16 v[86:87], v11 offset:9216
    v_mfma_f32_16x16x32_bf16 v[144:147], v[32:35], v[64:67], v[144:147]
    ds_read_b64_tr_b16 v[88:89], v10 offset:24576
    v_mfma_f32_16x16x32_bf16 v[148:151], v[32:35], v[68:71], v[148:151]
    v_mfma_f32_16x16x32_bf16 v[152:155], v[32:35], v[72:75], v[152:155]
    ds_read_b64_tr_b16 v[90:91], v10 offset:25600
    v_mfma_f32_16x16x32_bf16 v[156:159], v[32:35], v[76:79], v[156:159]
    ds_read_b64_tr_b16 v[92:93], v11 offset:24576
    s_add_u32 m0, s34, 0xc000
    v_mfma_f32_16x16x32_bf16 v[160:163], v[36:39], v[48:51], v[160:163]
    ds_read_b64_tr_b16 v[94:95], v11 offset:25600
    v_mfma_f32_16x16x32_bf16 v[164:167], v[36:39], v[52:55], v[164:167]
    ds_read_b128 v[96:99], v17 offset:32768
    v_mfma_f32_16x16x32_bf16 v[168:171], v[36:39], v[56:59], v[168:171]
    ds_read_b128 v[100:103], v17 offset:34816
    v_mfma_f32_16x16x32_bf16 v[172:175], v[36:39], v[60:63], v[172:175]
    v_mfma_f32_16x16x32_bf16 v[176:179], v[36:39], v[64:67], v[176:179]
    buffer_load_dwordx4 v2, s[20:23], s32 offen offset:0 lds
    ds_read_b128 v[104:107], v17 offset:36864
    v_mfma_f32_16x16x32_bf16 v[180:183], v[36:39], v[68:71], v[180:183]
    ds_read_b128 v[108:111], v17 offset:38912
    v_mfma_f32_16x16x32_bf16 v[184:187], v[36:39], v[72:75], v[184:187]
    ds_read_b128 v[112:115], v17 offset:40960
    v_mfma_f32_16x16x32_bf16 v[188:191], v[36:39], v[76:79], v[188:191]
    s_setprio 0
    ds_read_b128 v[116:119], v17 offset:43008
    v_mfma_f32_16x16x32_bf16 v[192:195], v[40:43], v[48:51], v[192:195]
    buffer_load_dwordx4 v3, s[20:23], s32 offen offset:1024 lds
    ds_read_b128 v[120:123], v17 offset:45056
    v_mfma_f32_16x16x32_bf16 v[196:199], v[40:43], v[52:55], v[196:199]
    v_mfma_f32_16x16x32_bf16 v[200:203], v[40:43], v[56:59], v[200:203]
    ds_read_b128 v[124:127], v17 offset:47104
    v_mfma_f32_16x16x32_bf16 v[204:207], v[40:43], v[60:63], v[204:207]
    v_mfma_f32_16x16x32_bf16 v[208:211], v[40:43], v[64:67], v[208:211]
    v_mfma_f32_16x16x32_bf16 v[212:215], v[40:43], v[68:71], v[212:215]
    s_add_u32 s32, s32, 0x70000
    v_mfma_f32_16x16x32_bf16 v[216:219], v[40:43], v[72:75], v[216:219]
    v_mfma_f32_16x16x32_bf16 v[220:223], v[40:43], v[76:79], v[220:223]
    v_mfma_f32_16x16x32_bf16 v[224:227], v[44:47], v[48:51], v[224:227]
    v_mfma_f32_16x16x32_bf16 v[228:231], v[44:47], v[52:55], v[228:231]
    s_mov_b64 exec, 0xff
    buffer_load_dword v29, v28, s[48:51], s46 offen
    s_mov_b64 exec, -1
    v_mfma_f32_16x16x32_bf16 v[232:235], v[44:47], v[56:59], v[232:235]
    v_mfma_f32_16x16x32_bf16 v[236:239], v[44:47], v[60:63], v[236:239]
    v_mfma_f32_16x16x32_bf16 v[240:243], v[44:47], v[64:67], v[240:243]
    v_mfma_f32_16x16x32_bf16 v[244:247], v[44:47], v[68:71], v[244:247]
    v_mfma_f32_16x16x32_bf16 v[248:251], v[44:47], v[72:75], v[248:251]
    s_add_u32 s46, s46, 1835008
    v_mfma_f32_16x16x32_bf16 v[252:255], v[44:47], v[76:79], v[252:255]
    s_waitcnt lgkmcnt(0)
    s_setprio 3
    s_waitcnt vmcnt(5)
    s_barrier
    v_mfma_f32_16x16x32_bf16 v[128:131], v[80:83], v[96:99], v[128:131]
    s_add_u32 m0, s35, 0x10000
    v_mfma_f32_16x16x32_bf16 v[132:135], v[80:83], v[100:103], v[132:135]
    ds_read_b64_tr_b16 v[32:33], v12 offset:0
    v_mfma_f32_16x16x32_bf16 v[136:139], v[80:83], v[104:107], v[136:139]
    ds_read_b64_tr_b16 v[34:35], v12 offset:1024
    v_mfma_f32_16x16x32_bf16 v[140:143], v[80:83], v[108:111], v[140:143]
    ds_read_b64_tr_b16 v[36:37], v13 offset:0
    v_mfma_f32_16x16x32_bf16 v[144:147], v[80:83], v[112:115], v[144:147]
    buffer_load_dwordx4 v4, s[12:15], s33 offen offset:0 sc1 lds
    ds_read_b64_tr_b16 v[38:39], v13 offset:1024
    v_mfma_f32_16x16x32_bf16 v[148:151], v[80:83], v[116:119], v[148:151]
    ds_read_b64_tr_b16 v[40:41], v12 offset:16384
    v_mfma_f32_16x16x32_bf16 v[152:155], v[80:83], v[120:123], v[152:155]
    v_mfma_f32_16x16x32_bf16 v[156:159], v[80:83], v[124:127], v[156:159]
    ds_read_b64_tr_b16 v[42:43], v12 offset:17408
    v_mfma_f32_16x16x32_bf16 v[160:163], v[84:87], v[96:99], v[160:163]
    buffer_load_dwordx4 v5, s[12:15], s33 offen offset:1024 sc1 lds
    ds_read_b64_tr_b16 v[44:45], v13 offset:16384
    v_mfma_f32_16x16x32_bf16 v[164:167], v[84:87], v[100:103], v[164:167]
    ds_read_b64_tr_b16 v[46:47], v13 offset:17408
    v_mfma_f32_16x16x32_bf16 v[168:171], v[84:87], v[104:107], v[168:171]
    ds_read_b128 v[48:51], v14 offset:0
    v_mfma_f32_16x16x32_bf16 v[172:175], v[84:87], v[108:111], v[172:175]
    ds_read_b128 v[52:55], v14 offset:2048
    v_mfma_f32_16x16x32_bf16 v[176:179], v[84:87], v[112:115], v[176:179]
    buffer_load_dwordx4 v6, s[12:15], s33 offen offset:2048 sc1 lds
    v_mfma_f32_16x16x32_bf16 v[180:183], v[84:87], v[116:119], v[180:183]
    ds_read_b128 v[56:59], v14 offset:4096
    v_mfma_f32_16x16x32_bf16 v[184:187], v[84:87], v[120:123], v[184:187]
    ds_read_b128 v[60:63], v14 offset:6144
    v_mfma_f32_16x16x32_bf16 v[188:191], v[84:87], v[124:127], v[188:191]
    s_setprio 2
    ds_read_b128 v[64:67], v14 offset:8192
    v_mfma_f32_16x16x32_bf16 v[192:195], v[88:91], v[96:99], v[192:195]
    buffer_load_dwordx4 v7, s[12:15], s33 offen offset:3072 sc1 lds
    ds_read_b128 v[68:71], v14 offset:10240
    v_mfma_f32_16x16x32_bf16 v[196:199], v[88:91], v[100:103], v[196:199]
    ds_read_b128 v[72:75], v14 offset:12288
    v_mfma_f32_16x16x32_bf16 v[200:203], v[88:91], v[104:107], v[200:203]
    v_mfma_f32_16x16x32_bf16 v[204:207], v[88:91], v[108:111], v[204:207]
    ds_read_b128 v[76:79], v14 offset:14336
    v_mfma_f32_16x16x32_bf16 v[208:211], v[88:91], v[112:115], v[208:211]
    s_add_u32 s33, s33, 128
    v_mfma_f32_16x16x32_bf16 v[212:215], v[88:91], v[116:119], v[212:215]
    v_mfma_f32_16x16x32_bf16 v[216:219], v[88:91], v[120:123], v[216:219]
    v_mfma_f32_16x16x32_bf16 v[220:223], v[88:91], v[124:127], v[220:223]
    v_mfma_f32_16x16x32_bf16 v[224:227], v[92:95], v[96:99], v[224:227]
    v_mfma_f32_16x16x32_bf16 v[228:231], v[92:95], v[100:103], v[228:231]
    v_mfma_f32_16x16x32_bf16 v[232:235], v[92:95], v[104:107], v[232:235]
    s_add_u32 m0, s34, 0x18000
    v_mfma_f32_16x16x32_bf16 v[236:239], v[92:95], v[108:111], v[236:239]
    v_mfma_f32_16x16x32_bf16 v[240:243], v[92:95], v[112:115], v[240:243]
    v_mfma_f32_16x16x32_bf16 v[244:247], v[92:95], v[116:119], v[244:247]
    v_mfma_f32_16x16x32_bf16 v[248:251], v[92:95], v[120:123], v[248:251]
    buffer_load_dwordx4 v2, s[16:19], s32 offen offset:0 lds
    v_mfma_f32_16x16x32_bf16 v[252:255], v[92:95], v[124:127], v[252:255]
    s_setprio 1
    s_waitcnt lgkmcnt(0)
    v_mfma_f32_16x16x32_bf16 v[128:131], v[32:35], v[48:51], v[128:131]
    ds_read_b64_tr_b16 v[80:81], v12 offset:8192
    v_mfma_f32_16x16x32_bf16 v[132:135], v[32:35], v[52:55], v[132:135]
    ds_read_b64_tr_b16 v[82:83], v12 offset:9216
    v_mfma_f32_16x16x32_bf16 v[136:139], v[32:35], v[56:59], v[136:139]
    ds_read_b64_tr_b16 v[84:85], v13 offset:8192
    v_mfma_f32_16x16x32_bf16 v[140:143], v[32:35], v[60:63], v[140:143]
    buffer_load_dwordx4 v3, s[16:19], s32 offen offset:1024 lds
    ds_read_b64_tr_b16 v[86:87], v13 offset:9216
    v_mfma_f32_16x16x32_bf16 v[144:147], v[32:35], v[64:67], v[144:147]
    ds_read_b64_tr_b16 v[88:89], v12 offset:24576
    v_mfma_f32_16x16x32_bf16 v[148:151], v[32:35], v[68:71], v[148:151]
    v_mfma_f32_16x16x32_bf16 v[152:155], v[32:35], v[72:75], v[152:155]
    ds_read_b64_tr_b16 v[90:91], v12 offset:25600
    v_mfma_f32_16x16x32_bf16 v[156:159], v[32:35], v[76:79], v[156:159]
    ds_read_b64_tr_b16 v[92:93], v13 offset:24576
    s_add_u32 m0, s34, 0x1c000
    v_mfma_f32_16x16x32_bf16 v[160:163], v[36:39], v[48:51], v[160:163]
    ds_read_b64_tr_b16 v[94:95], v13 offset:25600
    v_mfma_f32_16x16x32_bf16 v[164:167], v[36:39], v[52:55], v[164:167]
    ds_read_b128 v[96:99], v15 offset:0
    v_mfma_f32_16x16x32_bf16 v[168:171], v[36:39], v[56:59], v[168:171]
    ds_read_b128 v[100:103], v15 offset:2048
    v_mfma_f32_16x16x32_bf16 v[172:175], v[36:39], v[60:63], v[172:175]
    v_mfma_f32_16x16x32_bf16 v[176:179], v[36:39], v[64:67], v[176:179]
    buffer_load_dwordx4 v2, s[20:23], s32 offen offset:0 lds
    ds_read_b128 v[104:107], v15 offset:4096
    v_mfma_f32_16x16x32_bf16 v[180:183], v[36:39], v[68:71], v[180:183]
    ds_read_b128 v[108:111], v15 offset:6144
    v_mfma_f32_16x16x32_bf16 v[184:187], v[36:39], v[72:75], v[184:187]
    ds_read_b128 v[112:115], v15 offset:8192
    v_mfma_f32_16x16x32_bf16 v[188:191], v[36:39], v[76:79], v[188:191]
    s_setprio 0
    ds_read_b128 v[116:119], v15 offset:10240
    v_mfma_f32_16x16x32_bf16 v[192:195], v[40:43], v[48:51], v[192:195]
    buffer_load_dwordx4 v3, s[20:23], s32 offen offset:1024 lds
    ds_read_b128 v[120:123], v15 offset:12288
    v_mfma_f32_16x16x32_bf16 v[196:199], v[40:43], v[52:55], v[196:199]
    v_mfma_f32_16x16x32_bf16 v[200:203], v[40:43], v[56:59], v[200:203]
    ds_read_b128 v[124:127], v15 offset:14336
    v_mfma_f32_16x16x32_bf16 v[204:207], v[40:43], v[60:63], v[204:207]
    v_mfma_f32_16x16x32_bf16 v[208:211], v[40:43], v[64:67], v[208:211]
    v_mfma_f32_16x16x32_bf16 v[212:215], v[40:43], v[68:71], v[212:215]
    s_add_u32 s32, s32, 0x70000
    v_mfma_f32_16x16x32_bf16 v[216:219], v[40:43], v[72:75], v[216:219]
    v_mfma_f32_16x16x32_bf16 v[220:223], v[40:43], v[76:79], v[220:223]
    v_mfma_f32_16x16x32_bf16 v[224:227], v[44:47], v[48:51], v[224:227]
    v_mfma_f32_16x16x32_bf16 v[228:231], v[44:47], v[52:55], v[228:231]
    v_mfma_f32_16x16x32_bf16 v[232:235], v[44:47], v[56:59], v[232:235]
    v_mfma_f32_16x16x32_bf16 v[236:239], v[44:47], v[60:63], v[236:239]
    v_mfma_f32_16x16x32_bf16 v[240:243], v[44:47], v[64:67], v[240:243]
    v_mfma_f32_16x16x32_bf16 v[244:247], v[44:47], v[68:71], v[244:247]
    v_mfma_f32_16x16x32_bf16 v[248:251], v[44:47], v[72:75], v[248:251]
    v_mfma_f32_16x16x32_bf16 v[252:255], v[44:47], v[76:79], v[252:255]
    s_waitcnt lgkmcnt(0)
    s_setprio 3
    s_waitcnt vmcnt(4)
    s_barrier
    v_mfma_f32_16x16x32_bf16 v[128:131], v[80:83], v[96:99], v[128:131]
    s_add_u32 m0, s35, 0x20000
    v_mfma_f32_16x16x32_bf16 v[132:135], v[80:83], v[100:103], v[132:135]
    ds_read_b64_tr_b16 v[32:33], v8 offset:32768
    v_mfma_f32_16x16x32_bf16 v[136:139], v[80:83], v[104:107], v[136:139]
    ds_read_b64_tr_b16 v[34:35], v8 offset:33792
    v_mfma_f32_16x16x32_bf16 v[140:143], v[80:83], v[108:111], v[140:143]
    ds_read_b64_tr_b16 v[36:37], v9 offset:32768
    v_mfma_f32_16x16x32_bf16 v[144:147], v[80:83], v[112:115], v[144:147]
    buffer_load_dwordx4 v4, s[12:15], s33 offen offset:0 sc1 lds
    ds_read_b64_tr_b16 v[38:39], v9 offset:33792
    v_mfma_f32_16x16x32_bf16 v[148:151], v[80:83], v[116:119], v[148:151]
    ds_read_b64_tr_b16 v[40:41], v8 offset:49152
    v_mfma_f32_16x16x32_bf16 v[152:155], v[80:83], v[120:123], v[152:155]
    v_mfma_f32_16x16x32_bf16 v[156:159], v[80:83], v[124:127], v[156:159]
    ds_read_b64_tr_b16 v[42:43], v8 offset:50176
    v_mfma_f32_16x16x32_bf16 v[160:163], v[84:87], v[96:99], v[160:163]
    buffer_load_dwordx4 v5, s[12:15], s33 offen offset:1024 sc1 lds
    ds_read_b64_tr_b16 v[44:45], v9 offset:49152
    v_mfma_f32_16x16x32_bf16 v[164:167], v[84:87], v[100:103], v[164:167]
    ds_read_b64_tr_b16 v[46:47], v9 offset:50176
    v_mfma_f32_16x16x32_bf16 v[168:171], v[84:87], v[104:107], v[168:171]
    ds_read_b128 v[48:51], v16 offset:0
    v_mfma_f32_16x16x32_bf16 v[172:175], v[84:87], v[108:111], v[172:175]
    ds_read_b128 v[52:55], v16 offset:2048
    v_mfma_f32_16x16x32_bf16 v[176:179], v[84:87], v[112:115], v[176:179]
    buffer_load_dwordx4 v6, s[12:15], s33 offen offset:2048 sc1 lds
    v_mfma_f32_16x16x32_bf16 v[180:183], v[84:87], v[116:119], v[180:183]
    ds_read_b128 v[56:59], v16 offset:4096
    v_mfma_f32_16x16x32_bf16 v[184:187], v[84:87], v[120:123], v[184:187]
    ds_read_b128 v[60:63], v16 offset:6144
    v_mfma_f32_16x16x32_bf16 v[188:191], v[84:87], v[124:127], v[188:191]
    s_setprio 2
    ds_read_b128 v[64:67], v16 offset:8192
    v_mfma_f32_16x16x32_bf16 v[192:195], v[88:91], v[96:99], v[192:195]
    buffer_load_dwordx4 v7, s[12:15], s33 offen offset:3072 sc1 lds
    ds_read_b128 v[68:71], v16 offset:10240
    v_mfma_f32_16x16x32_bf16 v[196:199], v[88:91], v[100:103], v[196:199]
    ds_read_b128 v[72:75], v16 offset:12288
    v_mfma_f32_16x16x32_bf16 v[200:203], v[88:91], v[104:107], v[200:203]
    v_mfma_f32_16x16x32_bf16 v[204:207], v[88:91], v[108:111], v[204:207]
    ds_read_b128 v[76:79], v16 offset:14336
    v_mfma_f32_16x16x32_bf16 v[208:211], v[88:91], v[112:115], v[208:211]
    s_add_u32 s33, s33, 128
    v_mfma_f32_16x16x32_bf16 v[212:215], v[88:91], v[116:119], v[212:215]
    v_mfma_f32_16x16x32_bf16 v[216:219], v[88:91], v[120:123], v[216:219]
    v_mfma_f32_16x16x32_bf16 v[220:223], v[88:91], v[124:127], v[220:223]
    v_mfma_f32_16x16x32_bf16 v[224:227], v[92:95], v[96:99], v[224:227]
    v_mfma_f32_16x16x32_bf16 v[228:231], v[92:95], v[100:103], v[228:231]
    v_mfma_f32_16x16x32_bf16 v[232:235], v[92:95], v[104:107], v[232:235]
    s_add_u32 m0, s34, 0x0
    v_mfma_f32_16x16x32_bf16 v[236:239], v[92:95], v[108:111], v[236:239]
    v_mfma_f32_16x16x32_bf16 v[240:243], v[92:95], v[112:115], v[240:243]
    v_mfma_f32_16x16x32_bf16 v[244:247], v[92:95], v[116:119], v[244:247]
    v_mfma_f32_16x16x32_bf16 v[248:251], v[92:95], v[120:123], v[248:251]
    buffer_load_dwordx4 v2, s[16:19], s32 offen offset:0 lds
    v_mfma_f32_16x16x32_bf16 v[252:255], v[92:95], v[124:127], v[252:255]
    s_setprio 1
    s_waitcnt lgkmcnt(0)
    v_mfma_f32_16x16x32_bf16 v[128:131], v[32:35], v[48:51], v[128:131]
    ds_read_b64_tr_b16 v[80:81], v8 offset:40960
    v_mfma_f32_16x16x32_bf16 v[132:135], v[32:35], v[52:55], v[132:135]
    ds_read_b64_tr_b16 v[82:83], v8 offset:41984
    v_mfma_f32_16x16x32_bf16 v[136:139], v[32:35], v[56:59], v[136:139]
    ds_read_b64_tr_b16 v[84:85], v9 offset:40960
    v_mfma_f32_16x16x32_bf16 v[140:143], v[32:35], v[60:63], v[140:143]
    buffer_load_dwordx4 v3, s[16:19], s32 offen offset:1024 lds
    ds_read_b64_tr_b16 v[86:87], v9 offset:41984
    v_mfma_f32_16x16x32_bf16 v[144:147], v[32:35], v[64:67], v[144:147]
    ds_read_b64_tr_b16 v[88:89], v8 offset:57344
    v_mfma_f32_16x16x32_bf16 v[148:151], v[32:35], v[68:71], v[148:151]
    v_mfma_f32_16x16x32_bf16 v[152:155], v[32:35], v[72:75], v[152:155]
    ds_read_b64_tr_b16 v[90:91], v8 offset:58368
    v_mfma_f32_16x16x32_bf16 v[156:159], v[32:35], v[76:79], v[156:159]
    ds_read_b64_tr_b16 v[92:93], v9 offset:57344
    s_add_u32 m0, s34, 0x4000
    v_mfma_f32_16x16x32_bf16 v[160:163], v[36:39], v[48:51], v[160:163]
    ds_read_b64_tr_b16 v[94:95], v9 offset:58368
    v_mfma_f32_16x16x32_bf16 v[164:167], v[36:39], v[52:55], v[164:167]
    ds_read_b128 v[96:99], v17 offset:0
    v_mfma_f32_16x16x32_bf16 v[168:171], v[36:39], v[56:59], v[168:171]
    ds_read_b128 v[100:103], v17 offset:2048
    v_mfma_f32_16x16x32_bf16 v[172:175], v[36:39], v[60:63], v[172:175]
    v_mfma_f32_16x16x32_bf16 v[176:179], v[36:39], v[64:67], v[176:179]
    buffer_load_dwordx4 v2, s[20:23], s32 offen offset:0 lds
    ds_read_b128 v[104:107], v17 offset:4096
    v_mfma_f32_16x16x32_bf16 v[180:183], v[36:39], v[68:71], v[180:183]
    ds_read_b128 v[108:111], v17 offset:6144
    v_mfma_f32_16x16x32_bf16 v[184:187], v[36:39], v[72:75], v[184:187]
    ds_read_b128 v[112:115], v17 offset:8192
    v_mfma_f32_16x16x32_bf16 v[188:191], v[36:39], v[76:79], v[188:191]
    s_setprio 0
    ds_read_b128 v[116:119], v17 offset:10240
    v_mfma_f32_16x16x32_bf16 v[192:195], v[40:43], v[48:51], v[192:195]
    buffer_load_dwordx4 v3, s[20:23], s32 offen offset:1024 lds
    ds_read_b128 v[120:123], v17 offset:12288
    v_mfma_f32_16x16x32_bf16 v[196:199], v[40:43], v[52:55], v[196:199]
    v_mfma_f32_16x16x32_bf16 v[200:203], v[40:43], v[56:59], v[200:203]
    ds_read_b128 v[124:127], v17 offset:14336
    v_mfma_f32_16x16x32_bf16 v[204:207], v[40:43], v[60:63], v[204:207]
    v_mfma_f32_16x16x32_bf16 v[208:211], v[40:43], v[64:67], v[208:211]
    v_mfma_f32_16x16x32_bf16 v[212:215], v[40:43], v[68:71], v[212:215]
    s_add_u32 s32, s32, 0x70000
    v_mfma_f32_16x16x32_bf16 v[216:219], v[40:43], v[72:75], v[216:219]
    v_mfma_f32_16x16x32_bf16 v[220:223], v[40:43], v[76:79], v[220:223]
    v_mfma_f32_16x16x32_bf16 v[224:227], v[44:47], v[48:51], v[224:227]
    v_mfma_f32_16x16x32_bf16 v[228:231], v[44:47], v[52:55], v[228:231]
    v_mfma_f32_16x16x32_bf16 v[232:235], v[44:47], v[56:59], v[232:235]
    v_mfma_f32_16x16x32_bf16 v[236:239], v[44:47], v[60:63], v[236:239]
    v_mfma_f32_16x16x32_bf16 v[240:243], v[44:47], v[64:67], v[240:243]
    v_mfma_f32_16x16x32_bf16 v[244:247], v[44:47], v[68:71], v[244:247]
    v_mfma_f32_16x16x32_bf16 v[248:251], v[44:47], v[72:75], v[248:251]
    v_mfma_f32_16x16x32_bf16 v[252:255], v[44:47], v[76:79], v[252:255]
    s_waitcnt lgkmcnt(0)
    s_setprio 3
    s_waitcnt vmcnt(4)
    s_barrier
    v_mfma_f32_16x16x32_bf16 v[128:131], v[80:83], v[96:99], v[128:131]
    s_add_u32 m0, s35, 0x8000
    v_mfma_f32_16x16x32_bf16 v[132:135], v[80:83], v[100:103], v[132:135]
    ds_read_b64_tr_b16 v[32:33], v10 offset:32768
    v_mfma_f32_16x16x32_bf16 v[136:139], v[80:83], v[104:107], v[136:139]
    ds_read_b64_tr_b16 v[34:35], v10 offset:33792
    v_mfma_f32_16x16x32_bf16 v[140:143], v[80:83], v[108:111], v[140:143]
    ds_read_b64_tr_b16 v[36:37], v11 offset:32768
    v_mfma_f32_16x16x32_bf16 v[144:147], v[80:83], v[112:115], v[144:147]
    buffer_load_dwordx4 v4, s[12:15], s33 offen offset:0 sc1 lds
    ds_read_b64_tr_b16 v[38:39], v11 offset:33792
    v_mfma_f32_16x16x32_bf16 v[148:151], v[80:83], v[116:119], v[148:151]
    ds_read_b64_tr_b16 v[40:41], v10 offset:49152
    v_mfma_f32_16x16x32_bf16 v[152:155], v[80:83], v[120:123], v[152:155]
    v_mfma_f32_16x16x32_bf16 v[156:159], v[80:83], v[124:127], v[156:159]
    ds_read_b64_tr_b16 v[42:43], v10 offset:50176
    v_mfma_f32_16x16x32_bf16 v[160:163], v[84:87], v[96:99], v[160:163]
    buffer_load_dwordx4 v5, s[12:15], s33 offen offset:1024 sc1 lds
    ds_read_b64_tr_b16 v[44:45], v11 offset:49152
    v_mfma_f32_16x16x32_bf16 v[164:167], v[84:87], v[100:103], v[164:167]
    ds_read_b64_tr_b16 v[46:47], v11 offset:50176
    v_mfma_f32_16x16x32_bf16 v[168:171], v[84:87], v[104:107], v[168:171]
    ds_read_b128 v[48:51], v18 offset:0
    v_mfma_f32_16x16x32_bf16 v[172:175], v[84:87], v[108:111], v[172:175]
    ds_read_b128 v[52:55], v18 offset:2048
    v_mfma_f32_16x16x32_bf16 v[176:179], v[84:87], v[112:115], v[176:179]
    buffer_load_dwordx4 v6, s[12:15], s33 offen offset:2048 sc1 lds
    v_mfma_f32_16x16x32_bf16 v[180:183], v[84:87], v[116:119], v[180:183]
    ds_read_b128 v[56:59], v18 offset:4096
    v_mfma_f32_16x16x32_bf16 v[184:187], v[84:87], v[120:123], v[184:187]
    ds_read_b128 v[60:63], v18 offset:6144
    v_mfma_f32_16x16x32_bf16 v[188:191], v[84:87], v[124:127], v[188:191]
    s_setprio 2
    ds_read_b128 v[64:67], v18 offset:8192
    v_mfma_f32_16x16x32_bf16 v[192:195], v[88:91], v[96:99], v[192:195]
    buffer_load_dwordx4 v7, s[12:15], s33 offen offset:3072 sc1 lds
    ds_read_b128 v[68:71], v18 offset:10240
    v_mfma_f32_16x16x32_bf16 v[196:199], v[88:91], v[100:103], v[196:199]
    ds_read_b128 v[72:75], v18 offset:12288
    v_mfma_f32_16x16x32_bf16 v[200:203], v[88:91], v[104:107], v[200:203]
    v_mfma_f32_16x16x32_bf16 v[204:207], v[88:91], v[108:111], v[204:207]
    ds_read_b128 v[76:79], v18 offset:14336
    v_mfma_f32_16x16x32_bf16 v[208:211], v[88:91], v[112:115], v[208:211]
    s_add_u32 s33, s33, 128
    v_mfma_f32_16x16x32_bf16 v[212:215], v[88:91], v[116:119], v[212:215]
    v_mfma_f32_16x16x32_bf16 v[216:219], v[88:91], v[120:123], v[216:219]
    v_mfma_f32_16x16x32_bf16 v[220:223], v[88:91], v[124:127], v[220:223]
    v_mfma_f32_16x16x32_bf16 v[224:227], v[92:95], v[96:99], v[224:227]
    v_mfma_f32_16x16x32_bf16 v[228:231], v[92:95], v[100:103], v[228:231]
    v_mfma_f32_16x16x32_bf16 v[232:235], v[92:95], v[104:107], v[232:235]
    v_mfma_f32_16x16x32_bf16 v[236:239], v[92:95], v[108:111], v[236:239]
    v_mfma_f32_16x16x32_bf16 v[240:243], v[92:95], v[112:115], v[240:243]
    v_mfma_f32_16x16x32_bf16 v[244:247], v[92:95], v[116:119], v[244:247]
    v_mfma_f32_16x16x32_bf16 v[248:251], v[92:95], v[120:123], v[248:251]
    v_mfma_f32_16x16x32_bf16 v[252:255], v[92:95], v[124:127], v[252:255]
    s_setprio 1
    s_waitcnt lgkmcnt(0)
    v_mfma_f32_16x16x32_bf16 v[128:131], v[32:35], v[48:51], v[128:131]
    ds_read_b64_tr_b16 v[80:81], v10 offset:40960
    v_mfma_f32_16x16x32_bf16 v[132:135], v[32:35], v[52:55], v[132:135]
    ds_read_b64_tr_b16 v[82:83], v10 offset:41984
    v_mfma_f32_16x16x32_bf16 v[136:139], v[32:35], v[56:59], v[136:139]
    ds_read_b64_tr_b16 v[84:85], v11 offset:40960
    v_mfma_f32_16x16x32_bf16 v[140:143], v[32:35], v[60:63], v[140:143]
    ds_read_b64_tr_b16 v[86:87], v11 offset:41984
    v_mfma_f32_16x16x32_bf16 v[144:147], v[32:35], v[64:67], v[144:147]
    ds_read_b64_tr_b16 v[88:89], v10 offset:57344
    v_mfma_f32_16x16x32_bf16 v[148:151], v[32:35], v[68:71], v[148:151]
    v_mfma_f32_16x16x32_bf16 v[152:155], v[32:35], v[72:75], v[152:155]
    ds_read_b64_tr_b16 v[90:91], v10 offset:58368
    v_mfma_f32_16x16x32_bf16 v[156:159], v[32:35], v[76:79], v[156:159]
    ds_read_b64_tr_b16 v[92:93], v11 offset:57344
    v_mfma_f32_16x16x32_bf16 v[160:163], v[36:39], v[48:51], v[160:163]
    ds_read_b64_tr_b16 v[94:95], v11 offset:58368
    v_mfma_f32_16x16x32_bf16 v[164:167], v[36:39], v[52:55], v[164:167]
    ds_read_b128 v[96:99], v19 offset:0
    v_mfma_f32_16x16x32_bf16 v[168:171], v[36:39], v[56:59], v[168:171]
    ds_read_b128 v[100:103], v19 offset:2048
    v_mfma_f32_16x16x32_bf16 v[172:175], v[36:39], v[60:63], v[172:175]
    v_mfma_f32_16x16x32_bf16 v[176:179], v[36:39], v[64:67], v[176:179]
    ds_read_b128 v[104:107], v19 offset:4096
    v_mfma_f32_16x16x32_bf16 v[180:183], v[36:39], v[68:71], v[180:183]
    ds_read_b128 v[108:111], v19 offset:6144
    v_mfma_f32_16x16x32_bf16 v[184:187], v[36:39], v[72:75], v[184:187]
    ds_read_b128 v[112:115], v19 offset:8192
    v_mfma_f32_16x16x32_bf16 v[188:191], v[36:39], v[76:79], v[188:191]
    s_setprio 0
    ds_read_b128 v[116:119], v19 offset:10240
    v_mfma_f32_16x16x32_bf16 v[192:195], v[40:43], v[48:51], v[192:195]
    ds_read_b128 v[120:123], v19 offset:12288
    v_mfma_f32_16x16x32_bf16 v[196:199], v[40:43], v[52:55], v[196:199]
    v_mfma_f32_16x16x32_bf16 v[200:203], v[40:43], v[56:59], v[200:203]
    ds_read_b128 v[124:127], v19 offset:14336
    v_mfma_f32_16x16x32_bf16 v[204:207], v[40:43], v[60:63], v[204:207]
    v_mfma_f32_16x16x32_bf16 v[208:211], v[40:43], v[64:67], v[208:211]
    v_mfma_f32_16x16x32_bf16 v[212:215], v[40:43], v[68:71], v[212:215]
    v_mfma_f32_16x16x32_bf16 v[216:219], v[40:43], v[72:75], v[216:219]
    v_mfma_f32_16x16x32_bf16 v[220:223], v[40:43], v[76:79], v[220:223]
    v_mfma_f32_16x16x32_bf16 v[224:227], v[44:47], v[48:51], v[224:227]
    v_mfma_f32_16x16x32_bf16 v[228:231], v[44:47], v[52:55], v[228:231]
    v_mfma_f32_16x16x32_bf16 v[232:235], v[44:47], v[56:59], v[232:235]
    v_mfma_f32_16x16x32_bf16 v[236:239], v[44:47], v[60:63], v[236:239]
    v_mfma_f32_16x16x32_bf16 v[240:243], v[44:47], v[64:67], v[240:243]
    v_mfma_f32_16x16x32_bf16 v[244:247], v[44:47], v[68:71], v[244:247]
    v_mfma_f32_16x16x32_bf16 v[248:251], v[44:47], v[72:75], v[248:251]
    v_mfma_f32_16x16x32_bf16 v[252:255], v[44:47], v[76:79], v[252:255]
    s_waitcnt lgkmcnt(0)
    s_setprio 3
    s_waitcnt vmcnt(0)
    s_barrier
    v_mfma_f32_16x16x32_bf16 v[128:131], v[80:83], v[96:99], v[128:131]
    ds_read_b64_tr_b16 v[32:33], v8 offset:0
    v_mfma_f32_16x16x32_bf16 v[132:135], v[80:83], v[100:103], v[132:135]
    ds_read_b64_tr_b16 v[34:35], v8 offset:1024
    v_mfma_f32_16x16x32_bf16 v[136:139], v[80:83], v[104:107], v[136:139]
    ds_read_b64_tr_b16 v[36:37], v9 offset:0
    v_mfma_f32_16x16x32_bf16 v[140:143], v[80:83], v[108:111], v[140:143]
    ds_read_b64_tr_b16 v[38:39], v9 offset:1024
    v_mfma_f32_16x16x32_bf16 v[144:147], v[80:83], v[112:115], v[144:147]
    ds_read_b64_tr_b16 v[40:41], v8 offset:16384
    v_mfma_f32_16x16x32_bf16 v[148:151], v[80:83], v[116:119], v[148:151]
    ds_read_b64_tr_b16 v[42:43], v8 offset:17408
    v_mfma_f32_16x16x32_bf16 v[152:155], v[80:83], v[120:123], v[152:155]
    ds_read_b64_tr_b16 v[44:45], v9 offset:16384
    v_mfma_f32_16x16x32_bf16 v[156:159], v[80:83], v[124:127], v[156:159]
    ds_read_b64_tr_b16 v[46:47], v9 offset:17408
    v_mfma_f32_16x16x32_bf16 v[160:163], v[84:87], v[96:99], v[160:163]
    ds_read_b128 v[48:51], v14 offset:32768
    v_mfma_f32_16x16x32_bf16 v[164:167], v[84:87], v[100:103], v[164:167]
    ds_read_b128 v[52:55], v14 offset:34816
    v_mfma_f32_16x16x32_bf16 v[168:171], v[84:87], v[104:107], v[168:171]
    ds_read_b128 v[56:59], v14 offset:36864
    v_mfma_f32_16x16x32_bf16 v[172:175], v[84:87], v[108:111], v[172:175]
    ds_read_b128 v[60:63], v14 offset:38912
    v_mfma_f32_16x16x32_bf16 v[176:179], v[84:87], v[112:115], v[176:179]
    ds_read_b128 v[64:67], v14 offset:40960
    v_mfma_f32_16x16x32_bf16 v[180:183], v[84:87], v[116:119], v[180:183]
    ds_read_b128 v[68:71], v14 offset:43008
    v_mfma_f32_16x16x32_bf16 v[184:187], v[84:87], v[120:123], v[184:187]
    ds_read_b128 v[72:75], v14 offset:45056
    v_mfma_f32_16x16x32_bf16 v[188:191], v[84:87], v[124:127], v[188:191]
    ds_read_b128 v[76:79], v14 offset:47104
    v_mfma_f32_16x16x32_bf16 v[192:195], v[88:91], v[96:99], v[192:195]
    v_mfma_f32_16x16x32_bf16 v[196:199], v[88:91], v[100:103], v[196:199]
    v_mfma_f32_16x16x32_bf16 v[200:203], v[88:91], v[104:107], v[200:203]
    v_mfma_f32_16x16x32_bf16 v[204:207], v[88:91], v[108:111], v[204:207]
    v_mfma_f32_16x16x32_bf16 v[208:211], v[88:91], v[112:115], v[208:211]
    v_mfma_f32_16x16x32_bf16 v[212:215], v[88:91], v[116:119], v[212:215]
    v_mfma_f32_16x16x32_bf16 v[216:219], v[88:91], v[120:123], v[216:219]
    v_mfma_f32_16x16x32_bf16 v[220:223], v[88:91], v[124:127], v[220:223]
    v_mfma_f32_16x16x32_bf16 v[224:227], v[92:95], v[96:99], v[224:227]
    v_mfma_f32_16x16x32_bf16 v[228:231], v[92:95], v[100:103], v[228:231]
    v_mfma_f32_16x16x32_bf16 v[232:235], v[92:95], v[104:107], v[232:235]
    v_mfma_f32_16x16x32_bf16 v[236:239], v[92:95], v[108:111], v[236:239]
    v_mfma_f32_16x16x32_bf16 v[240:243], v[92:95], v[112:115], v[240:243]
    v_mfma_f32_16x16x32_bf16 v[244:247], v[92:95], v[116:119], v[244:247]
    v_mfma_f32_16x16x32_bf16 v[248:251], v[92:95], v[120:123], v[248:251]
    v_mfma_f32_16x16x32_bf16 v[252:255], v[92:95], v[124:127], v[252:255]
    s_waitcnt lgkmcnt(0)
    ds_read_b64_tr_b16 v[80:81], v8 offset:8192
    ds_read_b64_tr_b16 v[82:83], v8 offset:9216
    ds_read_b64_tr_b16 v[84:85], v9 offset:8192
    ds_read_b64_tr_b16 v[86:87], v9 offset:9216
    ds_read_b64_tr_b16 v[88:89], v8 offset:24576
    ds_read_b64_tr_b16 v[90:91], v8 offset:25600
    ds_read_b64_tr_b16 v[92:93], v9 offset:24576
    ds_read_b64_tr_b16 v[94:95], v9 offset:25600
    ds_read_b128 v[96:99], v15 offset:32768
    ds_read_b128 v[100:103], v15 offset:34816
    ds_read_b128 v[104:107], v15 offset:36864
    ds_read_b128 v[108:111], v15 offset:38912
    ds_read_b128 v[112:115], v15 offset:40960
    ds_read_b128 v[116:119], v15 offset:43008
    ds_read_b128 v[120:123], v15 offset:45056
    ds_read_b128 v[124:127], v15 offset:47104
    v_mfma_f32_16x16x32_bf16 v[128:131], v[32:35], v[48:51], v[128:131]
    v_mfma_f32_16x16x32_bf16 v[160:163], v[36:39], v[48:51], v[160:163]
    v_mfma_f32_16x16x32_bf16 v[192:195], v[40:43], v[48:51], v[192:195]
    v_mfma_f32_16x16x32_bf16 v[224:227], v[44:47], v[48:51], v[224:227]
    s_waitcnt lgkmcnt(7)
    v_mfma_f32_16x16x32_bf16 v[128:131], v[80:83], v[96:99], v[128:131]
    v_mfma_f32_16x16x32_bf16 v[160:163], v[84:87], v[96:99], v[160:163]
    v_mfma_f32_16x16x32_bf16 v[192:195], v[88:91], v[96:99], v[192:195]
    v_mfma_f32_16x16x32_bf16 v[224:227], v[92:95], v[96:99], v[224:227]
    v_mfma_f32_16x16x32_bf16 v[132:135], v[32:35], v[52:55], v[132:135]
    v_mfma_f32_16x16x32_bf16 v[164:167], v[36:39], v[52:55], v[164:167]
    v_mfma_f32_16x16x32_bf16 v[196:199], v[40:43], v[52:55], v[196:199]
    v_mfma_f32_16x16x32_bf16 v[228:231], v[44:47], v[52:55], v[228:231]
    s_waitcnt lgkmcnt(6)
    v_mfma_f32_16x16x32_bf16 v[132:135], v[80:83], v[100:103], v[132:135]
    v_mfma_f32_16x16x32_bf16 v[164:167], v[84:87], v[100:103], v[164:167]
    v_mfma_f32_16x16x32_bf16 v[196:199], v[88:91], v[100:103], v[196:199]
    v_mfma_f32_16x16x32_bf16 v[228:231], v[92:95], v[100:103], v[228:231]
    v_mfma_f32_16x16x32_bf16 v[136:139], v[32:35], v[56:59], v[136:139]
    v_pk_mul_f32 v[8:9], v[128:129], s[40:41]
    v_pk_mul_f32 v[10:11], v[130:131], s[40:41]
    v_pk_mul_f32 v[12:13], v[160:161], s[40:41]
    v_pk_mul_f32 v[14:15], v[162:163], s[40:41]
    v_exp_f32 v8, v8
    v_exp_f32 v9, v9
    v_mfma_f32_16x16x32_bf16 v[168:171], v[36:39], v[56:59], v[168:171]
    v_exp_f32 v10, v10
    v_exp_f32 v11, v11
    v_exp_f32 v12, v12
    v_exp_f32 v13, v13
    v_exp_f32 v14, v14
    v_exp_f32 v15, v15
    v_mfma_f32_16x16x32_bf16 v[200:203], v[40:43], v[56:59], v[200:203]
    v_pk_mul_f32 v[192:193], v[128:129], v[192:193]
    v_pk_mul_f32 v[194:195], v[130:131], v[194:195]
    v_pk_mul_f32 v[224:225], v[160:161], v[224:225]
    v_pk_mul_f32 v[226:227], v[162:163], v[226:227]
    v_pk_add_f32 v[8:9], v[8:9], s[42:43]
    v_pk_add_f32 v[10:11], v[10:11], s[42:43]
    v_mfma_f32_16x16x32_bf16 v[232:235], v[44:47], v[56:59], v[232:235]
    v_pk_add_f32 v[12:13], v[12:13], s[42:43]
    v_pk_add_f32 v[14:15], v[14:15], s[42:43]
    v_rcp_f32 v8, v8
    v_rcp_f32 v9, v9
    v_rcp_f32 v10, v10
    v_rcp_f32 v11, v11
    s_waitcnt lgkmcnt(5)
    v_mfma_f32_16x16x32_bf16 v[136:139], v[80:83], v[104:107], v[136:139]
    v_rcp_f32 v12, v12
    v_rcp_f32 v13, v13
    v_rcp_f32 v14, v14
    v_rcp_f32 v15, v15
    s_nop 0
    v_pk_mul_f32 v[192:193], v[192:193], v[8:9]
    v_mfma_f32_16x16x32_bf16 v[168:171], v[84:87], v[104:107], v[168:171]
    v_pk_mul_f32 v[194:195], v[194:195], v[10:11]
    v_pk_mul_f32 v[224:225], v[224:225], v[12:13]
    v_pk_mul_f32 v[226:227], v[226:227], v[14:15]
    v_cvt_pk_bf16_f32 v20, v192, v193
    v_cvt_pk_bf16_f32 v21, v194, v195
    v_cvt_pk_bf16_f32 v22, v224, v225
    v_mfma_f32_16x16x32_bf16 v[200:203], v[88:91], v[104:107], v[200:203]
    v_cvt_pk_bf16_f32 v23, v226, v227
    s_nop 1
    v_permlane16_swap_b32 v20, v22
    v_permlane16_swap_b32 v21, v23
    buffer_store_dwordx4 v[20:23], v1, s[24:27], s44 offen sc1
    s_add_u32 s44, s44, 0x1c000
    v_mfma_f32_16x16x32_bf16 v[232:235], v[92:95], v[104:107], v[232:235]
    v_mfma_f32_16x16x32_bf16 v[140:143], v[32:35], v[60:63], v[140:143]
    v_pk_mul_f32 v[8:9], v[132:133], s[40:41]
    v_pk_mul_f32 v[10:11], v[134:135], s[40:41]
    v_pk_mul_f32 v[12:13], v[164:165], s[40:41]
    v_pk_mul_f32 v[14:15], v[166:167], s[40:41]
    v_exp_f32 v8, v8
    v_exp_f32 v9, v9
    v_mfma_f32_16x16x32_bf16 v[172:175], v[36:39], v[60:63], v[172:175]
    v_exp_f32 v10, v10
    v_exp_f32 v11, v11
    v_exp_f32 v12, v12
    v_exp_f32 v13, v13
    v_exp_f32 v14, v14
    v_exp_f32 v15, v15
    v_mfma_f32_16x16x32_bf16 v[204:207], v[40:43], v[60:63], v[204:207]
    v_pk_mul_f32 v[196:197], v[132:133], v[196:197]
    v_pk_mul_f32 v[198:199], v[134:135], v[198:199]
    v_pk_mul_f32 v[228:229], v[164:165], v[228:229]
    v_pk_mul_f32 v[230:231], v[166:167], v[230:231]
    v_pk_add_f32 v[8:9], v[8:9], s[42:43]
    v_pk_add_f32 v[10:11], v[10:11], s[42:43]
    v_mfma_f32_16x16x32_bf16 v[236:239], v[44:47], v[60:63], v[236:239]
    v_pk_add_f32 v[12:13], v[12:13], s[42:43]
    v_pk_add_f32 v[14:15], v[14:15], s[42:43]
    v_rcp_f32 v8, v8
    v_rcp_f32 v9, v9
    v_rcp_f32 v10, v10
    v_rcp_f32 v11, v11
    s_waitcnt lgkmcnt(4)
    v_mfma_f32_16x16x32_bf16 v[140:143], v[80:83], v[108:111], v[140:143]
    v_rcp_f32 v12, v12
    v_rcp_f32 v13, v13
    v_rcp_f32 v14, v14
    v_rcp_f32 v15, v15
    s_nop 0
    v_pk_mul_f32 v[196:197], v[196:197], v[8:9]
    v_mfma_f32_16x16x32_bf16 v[172:175], v[84:87], v[108:111], v[172:175]
    v_pk_mul_f32 v[198:199], v[198:199], v[10:11]
    v_pk_mul_f32 v[228:229], v[228:229], v[12:13]
    v_pk_mul_f32 v[230:231], v[230:231], v[14:15]
    v_cvt_pk_bf16_f32 v24, v196, v197
    v_cvt_pk_bf16_f32 v25, v198, v199
    v_cvt_pk_bf16_f32 v26, v228, v229
    v_mfma_f32_16x16x32_bf16 v[204:207], v[88:91], v[108:111], v[204:207]
    v_cvt_pk_bf16_f32 v27, v230, v231
    s_nop 1
    v_permlane16_swap_b32 v24, v26
    v_permlane16_swap_b32 v25, v27
    buffer_store_dwordx4 v[24:27], v1, s[24:27], s44 offen sc1
    s_add_u32 s44, s44, 0x1c000
    v_mfma_f32_16x16x32_bf16 v[236:239], v[92:95], v[108:111], v[236:239]
    v_mfma_f32_16x16x32_bf16 v[144:147], v[32:35], v[64:67], v[144:147]
    v_pk_mul_f32 v[8:9], v[136:137], s[40:41]
    v_pk_mul_f32 v[10:11], v[138:139], s[40:41]
    v_pk_mul_f32 v[12:13], v[168:169], s[40:41]
    v_pk_mul_f32 v[14:15], v[170:171], s[40:41]
    v_exp_f32 v8, v8
    v_exp_f32 v9, v9
    v_mfma_f32_16x16x32_bf16 v[176:179], v[36:39], v[64:67], v[176:179]
    v_exp_f32 v10, v10
    v_exp_f32 v11, v11
    v_exp_f32 v12, v12
    v_exp_f32 v13, v13
    v_exp_f32 v14, v14
    v_exp_f32 v15, v15
    v_mfma_f32_16x16x32_bf16 v[208:211], v[40:43], v[64:67], v[208:211]
    v_pk_mul_f32 v[200:201], v[136:137], v[200:201]
    v_pk_mul_f32 v[202:203], v[138:139], v[202:203]
    v_pk_mul_f32 v[232:233], v[168:169], v[232:233]
    v_pk_mul_f32 v[234:235], v[170:171], v[234:235]
    v_pk_add_f32 v[8:9], v[8:9], s[42:43]
    v_pk_add_f32 v[10:11], v[10:11], s[42:43]
    v_mfma_f32_16x16x32_bf16 v[240:243], v[44:47], v[64:67], v[240:243]
    v_pk_add_f32 v[12:13], v[12:13], s[42:43]
    v_pk_add_f32 v[14:15], v[14:15], s[42:43]
    v_rcp_f32 v8, v8
    v_rcp_f32 v9, v9
    v_rcp_f32 v10, v10
    v_rcp_f32 v11, v11
    s_waitcnt lgkmcnt(3)
    v_mfma_f32_16x16x32_bf16 v[144:147], v[80:83], v[112:115], v[144:147]
    v_rcp_f32 v12, v12
    v_rcp_f32 v13, v13
    v_rcp_f32 v14, v14
    v_rcp_f32 v15, v15
    s_nop 0
    v_pk_mul_f32 v[200:201], v[200:201], v[8:9]
    v_mfma_f32_16x16x32_bf16 v[176:179], v[84:87], v[112:115], v[176:179]
    v_pk_mul_f32 v[202:203], v[202:203], v[10:11]
    v_pk_mul_f32 v[232:233], v[232:233], v[12:13]
    v_pk_mul_f32 v[234:235], v[234:235], v[14:15]
    v_cvt_pk_bf16_f32 v28, v200, v201
    v_cvt_pk_bf16_f32 v29, v202, v203
    v_cvt_pk_bf16_f32 v30, v232, v233
    v_mfma_f32_16x16x32_bf16 v[208:211], v[88:91], v[112:115], v[208:211]
    v_cvt_pk_bf16_f32 v31, v234, v235
    s_nop 1
    v_permlane16_swap_b32 v28, v30
    v_permlane16_swap_b32 v29, v31
    buffer_store_dwordx4 v[28:31], v1, s[24:27], s44 offen sc1
    s_add_u32 s44, s44, 0x1c000
    v_mfma_f32_16x16x32_bf16 v[240:243], v[92:95], v[112:115], v[240:243]
    v_mfma_f32_16x16x32_bf16 v[148:151], v[32:35], v[68:71], v[148:151]
    v_pk_mul_f32 v[8:9], v[140:141], s[40:41]
    v_pk_mul_f32 v[10:11], v[142:143], s[40:41]
    v_pk_mul_f32 v[12:13], v[172:173], s[40:41]
    v_pk_mul_f32 v[14:15], v[174:175], s[40:41]
    v_exp_f32 v8, v8
    v_exp_f32 v9, v9
    v_mfma_f32_16x16x32_bf16 v[180:183], v[36:39], v[68:71], v[180:183]
    v_exp_f32 v10, v10
    v_exp_f32 v11, v11
    v_exp_f32 v12, v12
    v_exp_f32 v13, v13
    v_exp_f32 v14, v14
    v_exp_f32 v15, v15
    v_mfma_f32_16x16x32_bf16 v[212:215], v[40:43], v[68:71], v[212:215]
    v_pk_mul_f32 v[204:205], v[140:141], v[204:205]
    v_pk_mul_f32 v[206:207], v[142:143], v[206:207]
    v_pk_mul_f32 v[236:237], v[172:173], v[236:237]
    v_pk_mul_f32 v[238:239], v[174:175], v[238:239]
    v_pk_add_f32 v[8:9], v[8:9], s[42:43]
    v_pk_add_f32 v[10:11], v[10:11], s[42:43]
    v_mfma_f32_16x16x32_bf16 v[244:247], v[44:47], v[68:71], v[244:247]
    v_pk_add_f32 v[12:13], v[12:13], s[42:43]
    v_pk_add_f32 v[14:15], v[14:15], s[42:43]
    v_rcp_f32 v8, v8
    v_rcp_f32 v9, v9
    v_rcp_f32 v10, v10
    v_rcp_f32 v11, v11
    s_waitcnt lgkmcnt(2)
    v_mfma_f32_16x16x32_bf16 v[148:151], v[80:83], v[116:119], v[148:151]
    v_rcp_f32 v12, v12
    v_rcp_f32 v13, v13
    v_rcp_f32 v14, v14
    v_rcp_f32 v15, v15
    s_nop 0
    v_pk_mul_f32 v[204:205], v[204:205], v[8:9]
    v_mfma_f32_16x16x32_bf16 v[180:183], v[84:87], v[116:119], v[180:183]
    v_pk_mul_f32 v[206:207], v[206:207], v[10:11]
    v_pk_mul_f32 v[236:237], v[236:237], v[12:13]
    v_pk_mul_f32 v[238:239], v[238:239], v[14:15]
    v_cvt_pk_bf16_f32 v20, v204, v205
    v_cvt_pk_bf16_f32 v21, v206, v207
    v_cvt_pk_bf16_f32 v22, v236, v237
    v_mfma_f32_16x16x32_bf16 v[212:215], v[88:91], v[116:119], v[212:215]
    v_cvt_pk_bf16_f32 v23, v238, v239
    s_nop 1
    v_permlane16_swap_b32 v20, v22
    v_permlane16_swap_b32 v21, v23
    buffer_store_dwordx4 v[20:23], v1, s[24:27], s44 offen sc1
    s_add_u32 s44, s44, 0x1c000
    v_mfma_f32_16x16x32_bf16 v[244:247], v[92:95], v[116:119], v[244:247]
    v_mfma_f32_16x16x32_bf16 v[152:155], v[32:35], v[72:75], v[152:155]
    v_pk_mul_f32 v[8:9], v[144:145], s[40:41]
    v_pk_mul_f32 v[10:11], v[146:147], s[40:41]
    v_pk_mul_f32 v[12:13], v[176:177], s[40:41]
    v_pk_mul_f32 v[14:15], v[178:179], s[40:41]
    v_exp_f32 v8, v8
    v_exp_f32 v9, v9
    v_mfma_f32_16x16x32_bf16 v[184:187], v[36:39], v[72:75], v[184:187]
    v_exp_f32 v10, v10
    v_exp_f32 v11, v11
    v_exp_f32 v12, v12
    v_exp_f32 v13, v13
    v_exp_f32 v14, v14
    v_exp_f32 v15, v15
    v_mfma_f32_16x16x32_bf16 v[216:219], v[40:43], v[72:75], v[216:219]
    v_pk_mul_f32 v[208:209], v[144:145], v[208:209]
    v_pk_mul_f32 v[210:211], v[146:147], v[210:211]
    v_pk_mul_f32 v[240:241], v[176:177], v[240:241]
    v_pk_mul_f32 v[242:243], v[178:179], v[242:243]
    v_pk_add_f32 v[8:9], v[8:9], s[42:43]
    v_pk_add_f32 v[10:11], v[10:11], s[42:43]
    v_mfma_f32_16x16x32_bf16 v[248:251], v[44:47], v[72:75], v[248:251]
    v_pk_add_f32 v[12:13], v[12:13], s[42:43]
    v_pk_add_f32 v[14:15], v[14:15], s[42:43]
    v_rcp_f32 v8, v8
    v_rcp_f32 v9, v9
    v_rcp_f32 v10, v10
    v_rcp_f32 v11, v11
    s_waitcnt lgkmcnt(1)
    v_mfma_f32_16x16x32_bf16 v[152:155], v[80:83], v[120:123], v[152:155]
    v_rcp_f32 v12, v12
    v_rcp_f32 v13, v13
    v_rcp_f32 v14, v14
    v_rcp_f32 v15, v15
    s_nop 0
    v_pk_mul_f32 v[208:209], v[208:209], v[8:9]
    v_mfma_f32_16x16x32_bf16 v[184:187], v[84:87], v[120:123], v[184:187]
    v_pk_mul_f32 v[210:211], v[210:211], v[10:11]
    v_pk_mul_f32 v[240:241], v[240:241], v[12:13]
    v_pk_mul_f32 v[242:243], v[242:243], v[14:15]
    v_cvt_pk_bf16_f32 v24, v208, v209
    v_cvt_pk_bf16_f32 v25, v210, v211
    v_cvt_pk_bf16_f32 v26, v240, v241
    v_mfma_f32_16x16x32_bf16 v[216:219], v[88:91], v[120:123], v[216:219]
    v_cvt_pk_bf16_f32 v27, v242, v243
    s_nop 1
    v_permlane16_swap_b32 v24, v26
    v_permlane16_swap_b32 v25, v27
    buffer_store_dwordx4 v[24:27], v1, s[24:27], s44 offen sc1
    s_add_u32 s44, s44, 0x1c000
    v_mfma_f32_16x16x32_bf16 v[248:251], v[92:95], v[120:123], v[248:251]
    v_mfma_f32_16x16x32_bf16 v[156:159], v[32:35], v[76:79], v[156:159]
    v_pk_mul_f32 v[8:9], v[148:149], s[40:41]
    v_pk_mul_f32 v[10:11], v[150:151], s[40:41]
    v_pk_mul_f32 v[12:13], v[180:181], s[40:41]
    v_pk_mul_f32 v[14:15], v[182:183], s[40:41]
    v_exp_f32 v8, v8
    v_exp_f32 v9, v9
    v_mfma_f32_16x16x32_bf16 v[188:191], v[36:39], v[76:79], v[188:191]
    v_exp_f32 v10, v10
    v_exp_f32 v11, v11
    v_exp_f32 v12, v12
    v_exp_f32 v13, v13
    v_exp_f32 v14, v14
    v_exp_f32 v15, v15
    v_mfma_f32_16x16x32_bf16 v[220:223], v[40:43], v[76:79], v[220:223]
    v_pk_mul_f32 v[212:213], v[148:149], v[212:213]
    v_pk_mul_f32 v[214:215], v[150:151], v[214:215]
    v_pk_mul_f32 v[244:245], v[180:181], v[244:245]
    v_pk_mul_f32 v[246:247], v[182:183], v[246:247]
    v_pk_add_f32 v[8:9], v[8:9], s[42:43]
    v_pk_add_f32 v[10:11], v[10:11], s[42:43]
    v_mfma_f32_16x16x32_bf16 v[252:255], v[44:47], v[76:79], v[252:255]
    v_pk_add_f32 v[12:13], v[12:13], s[42:43]
    v_pk_add_f32 v[14:15], v[14:15], s[42:43]
    v_rcp_f32 v8, v8
    v_rcp_f32 v9, v9
    v_rcp_f32 v10, v10
    v_rcp_f32 v11, v11
    s_waitcnt lgkmcnt(0)
    v_mfma_f32_16x16x32_bf16 v[156:159], v[80:83], v[124:127], v[156:159]
    v_rcp_f32 v12, v12
    v_rcp_f32 v13, v13
    v_rcp_f32 v14, v14
    v_rcp_f32 v15, v15
    s_nop 0
    v_pk_mul_f32 v[212:213], v[212:213], v[8:9]
    v_mfma_f32_16x16x32_bf16 v[188:191], v[84:87], v[124:127], v[188:191]
    v_pk_mul_f32 v[214:215], v[214:215], v[10:11]
    v_pk_mul_f32 v[244:245], v[244:245], v[12:13]
    v_pk_mul_f32 v[246:247], v[246:247], v[14:15]
    v_cvt_pk_bf16_f32 v28, v212, v213
    v_cvt_pk_bf16_f32 v29, v214, v215
    v_cvt_pk_bf16_f32 v30, v244, v245
    v_mfma_f32_16x16x32_bf16 v[220:223], v[88:91], v[124:127], v[220:223]
    v_cvt_pk_bf16_f32 v31, v246, v247
    s_nop 1
    v_permlane16_swap_b32 v28, v30
    v_permlane16_swap_b32 v29, v31
    buffer_store_dwordx4 v[28:31], v1, s[24:27], s44 offen sc1
    s_add_u32 s44, s44, 0x1c000
    v_mfma_f32_16x16x32_bf16 v[252:255], v[92:95], v[124:127], v[252:255]
    v_pk_mul_f32 v[8:9], v[152:153], s[40:41]
    v_pk_mul_f32 v[10:11], v[154:155], s[40:41]
    v_pk_mul_f32 v[12:13], v[184:185], s[40:41]
    v_pk_mul_f32 v[14:15], v[186:187], s[40:41]
    v_exp_f32 v8, v8
    v_exp_f32 v9, v9
    v_exp_f32 v10, v10
    v_exp_f32 v11, v11
    v_exp_f32 v12, v12
    v_exp_f32 v13, v13
    v_exp_f32 v14, v14
    v_exp_f32 v15, v15
    v_pk_mul_f32 v[216:217], v[152:153], v[216:217]
    v_pk_mul_f32 v[218:219], v[154:155], v[218:219]
    v_pk_mul_f32 v[248:249], v[184:185], v[248:249]
    v_pk_mul_f32 v[250:251], v[186:187], v[250:251]
    v_pk_add_f32 v[8:9], v[8:9], s[42:43]
    v_pk_add_f32 v[10:11], v[10:11], s[42:43]
    v_pk_add_f32 v[12:13], v[12:13], s[42:43]
    v_pk_add_f32 v[14:15], v[14:15], s[42:43]
    v_rcp_f32 v8, v8
    v_rcp_f32 v9, v9
    v_rcp_f32 v10, v10
    v_rcp_f32 v11, v11
    v_rcp_f32 v12, v12
    v_rcp_f32 v13, v13
    v_rcp_f32 v14, v14
    v_rcp_f32 v15, v15
    s_nop 0
    v_pk_mul_f32 v[216:217], v[216:217], v[8:9]
    v_pk_mul_f32 v[218:219], v[218:219], v[10:11]
    v_pk_mul_f32 v[248:249], v[248:249], v[12:13]
    v_pk_mul_f32 v[250:251], v[250:251], v[14:15]
    v_cvt_pk_bf16_f32 v20, v216, v217
    v_cvt_pk_bf16_f32 v21, v218, v219
    v_cvt_pk_bf16_f32 v22, v248, v249
    v_cvt_pk_bf16_f32 v23, v250, v251
    s_nop 1
    v_permlane16_swap_b32 v20, v22
    v_permlane16_swap_b32 v21, v23
    buffer_store_dwordx4 v[20:23], v1, s[24:27], s44 offen sc1
    s_add_u32 s44, s44, 0x1c000
    s_nop 4
    v_pk_mul_f32 v[8:9], v[156:157], s[40:41]
    v_pk_mul_f32 v[10:11], v[158:159], s[40:41]
    v_pk_mul_f32 v[12:13], v[188:189], s[40:41]
    v_pk_mul_f32 v[14:15], v[190:191], s[40:41]
    v_exp_f32 v8, v8
    v_exp_f32 v9, v9
    v_exp_f32 v10, v10
    v_exp_f32 v11, v11
    v_exp_f32 v12, v12
    v_exp_f32 v13, v13
    v_exp_f32 v14, v14
    v_exp_f32 v15, v15
    v_pk_mul_f32 v[220:221], v[156:157], v[220:221]
    v_pk_mul_f32 v[222:223], v[158:159], v[222:223]
    v_pk_mul_f32 v[252:253], v[188:189], v[252:253]
    v_pk_mul_f32 v[254:255], v[190:191], v[254:255]
    v_pk_add_f32 v[8:9], v[8:9], s[42:43]
    v_pk_add_f32 v[10:11], v[10:11], s[42:43]
    v_pk_add_f32 v[12:13], v[12:13], s[42:43]
    v_pk_add_f32 v[14:15], v[14:15], s[42:43]
    v_rcp_f32 v8, v8
    v_rcp_f32 v9, v9
    v_rcp_f32 v10, v10
    v_rcp_f32 v11, v11
    v_rcp_f32 v12, v12
    v_rcp_f32 v13, v13
    v_rcp_f32 v14, v14
    v_rcp_f32 v15, v15
    s_nop 0
    v_pk_mul_f32 v[220:221], v[220:221], v[8:9]
    v_pk_mul_f32 v[222:223], v[222:223], v[10:11]
    v_pk_mul_f32 v[252:253], v[252:253], v[12:13]
    v_pk_mul_f32 v[254:255], v[254:255], v[14:15]
    v_cvt_pk_bf16_f32 v24, v220, v221
    v_cvt_pk_bf16_f32 v25, v222, v223
    v_cvt_pk_bf16_f32 v26, v252, v253
    v_cvt_pk_bf16_f32 v27, v254, v255
    s_nop 1
    v_permlane16_swap_b32 v24, v26
    v_permlane16_swap_b32 v25, v27
    buffer_store_dwordx4 v[24:27], v1, s[24:27], s44 offen sc1
    s_add_u32 s44, s44, 0x1c000
    s_nop 4
    s_setprio 0
    s_cmp_ge_u32 s30, 14
    s_cselect_b32 s45, 1, 0
    s_cselect_b32 s46, 14, 0
    s_sub_u32 s46, s30, s46
    s_lshl_b32 s47, s29, 1
    s_add_u32 s47, s47, s45
    s_lshl_b32 s47, s47, 7
    s_lshl_b32 s46, s46, 2
    s_add_u32 s59, s47, s46
    s_add_u32 s59, s59, 2176
    s_branch PHASE3
ROLE_FFT:
    v_lshrrev_b32 v2, 4, v0
    v_and_b32 v3, 15, v0
    s_sub_u32 s33, s2, 224
    s_lshl_b32 s33, s33, 3
    s_add_u32 s29, s33, s96
    s_add_u32 s34, s86, 0x400000
    s_addc_u32 s35, s87, 0
    s_mov_b32 s12, s34
    s_and_b32 s13, s35, 0xffff
    s_mov_b32 s14, 0x410000
    s_mov_b32 s15, 0x20000
    s_add_u32 s34, s86, 0x2000000
    s_addc_u32 s35, s87, 0
    s_mov_b32 s16, s34
    s_and_b32 s17, s35, 0xffff
    s_mov_b32 s18, 0x400000
    s_mov_b32 s19, 0x20000
    s_waitcnt vmcnt(0)
    s_barrier
    s_cmp_lg_u32 s96, s98
    s_cbranch_scc1 SIG_4
    v_mov_b32 v232, s97
    v_mov_b32 v233, s59
    s_mov_b64 exec, 1
    buffer_store_dword v232, v233, s[80:83], 0 offen sc0 sc1
    s_mov_b64 exec, -1
SIG_4:
    v_lshrrev_b32 v4, 3, v0
    v_mul_u32_u24 v4, 16640, v4
    v_and_b32 v5, 7, v0
    s_and_b32 s33, s96, 3
    v_xor_b32 v5, s33, v5
    v_lshlrev_b32 v6, 4, v5
    v_add_u32 v6, v4, v6
    v_xor_b32 v5, 4, v5
    v_lshlrev_b32 v7, 4, v5
    v_add_u32 v7, v4, v7
    s_lshl_b32 s36, s96, 10
    s_mul_i32 s33, s96, 133120
    s_mov_b32 s40, 0x3d000000
    s_mov_b32 s41, 0x3a000000
    s_mov_b32 s42, 0x3c800000
    s_mov_b32 s47, 0x80008000
    v_add_u32 v104, 0, v3
    v_lshlrev_b32 v105, 3, v2
    v_mul_u32_u24 v105, v105, v104
    v_and_b32 v106, 31, v105
    v_cvt_f32_u32 v107, v106
    v_mul_f32 v107, s40, v107
    v_cos_f32 v108, v107
    v_sin_f32_e64 v116, -v107
    v_add_u32 v105, v105, v104
    v_and_b32 v106, 31, v105
    v_cvt_f32_u32 v107, v106
    v_mul_f32 v107, s40, v107
    v_cos_f32 v109, v107
    v_sin_f32_e64 v117, -v107
    v_add_u32 v105, v105, v104
    v_and_b32 v106, 31, v105
    v_cvt_f32_u32 v107, v106
    v_mul_f32 v107, s40, v107
    v_cos_f32 v110, v107
    v_sin_f32_e64 v118, -v107
    v_add_u32 v105, v105, v104
    v_and_b32 v106, 31, v105
    v_cvt_f32_u32 v107, v106
    v_mul_f32 v107, s40, v107
    v_cos_f32 v111, v107
    v_sin_f32_e64 v119, -v107
    v_add_u32 v105, v105, v104
    v_and_b32 v106, 31, v105
    v_cvt_f32_u32 v107, v106
    v_mul_f32 v107, s40, v107
    v_cos_f32 v112, v107
    v_sin_f32_e64 v120, -v107
    v_add_u32 v105, v105, v104
    v_and_b32 v106, 31, v105
    v_cvt_f32_u32 v107, v106
    v_mul_f32 v107, s40, v107
    v_cos_f32 v113, v107
    v_sin_f32_e64 v121, -v107
    v_add_u32 v105, v105, v104
    v_and_b32 v106, 31, v105
    v_cvt_f32_u32 v107, v106
    v_mul_f32 v107, s40, v107
    v_cos_f32 v114, v107
    v_sin_f32_e64 v122, -v107
    v_add_u32 v105, v105, v104
    v_and_b32 v106, 31, v105
    v_cvt_f32_u32 v107, v106
    v_mul_f32 v107, s40, v107
    v_cos_f32 v115, v107
    v_sin_f32_e64 v123, -v107
    s_nop 0
    v_cvt_pk_bf16_f32 v16, v108, v109
    v_cvt_pk_bf16_f32 v24, v116, v117
    v_xor_b32 v32, s47, v24
    v_cvt_pk_bf16_f32 v17, v110, v111
    v_cvt_pk_bf16_f32 v25, v118, v119
    v_xor_b32 v33, s47, v25
    v_cvt_pk_bf16_f32 v18, v112, v113
    v_cvt_pk_bf16_f32 v26, v120, v121
    v_xor_b32 v34, s47, v26
    v_cvt_pk_bf16_f32 v19, v114, v115
    v_cvt_pk_bf16_f32 v27, v122, v123
    v_xor_b32 v35, s47, v27
    v_add_u32 v104, 16, v3
    v_lshlrev_b32 v105, 3, v2
    v_mul_u32_u24 v105, v105, v104
    v_and_b32 v106, 31, v105
    v_cvt_f32_u32 v107, v106
    v_mul_f32 v107, s40, v107
    v_cos_f32 v108, v107
    v_sin_f32_e64 v116, -v107
    v_add_u32 v105, v105, v104
    v_and_b32 v106, 31, v105
    v_cvt_f32_u32 v107, v106
    v_mul_f32 v107, s40, v107
    v_cos_f32 v109, v107
    v_sin_f32_e64 v117, -v107
    v_add_u32 v105, v105, v104
    v_and_b32 v106, 31, v105
    v_cvt_f32_u32 v107, v106
    v_mul_f32 v107, s40, v107
    v_cos_f32 v110, v107
    v_sin_f32_e64 v118, -v107
    v_add_u32 v105, v105, v104
    v_and_b32 v106, 31, v105
    v_cvt_f32_u32 v107, v106
    v_mul_f32 v107, s40, v107
    v_cos_f32 v111, v107
    v_sin_f32_e64 v119, -v107
    v_add_u32 v105, v105, v104
    v_and_b32 v106, 31, v105
    v_cvt_f32_u32 v107, v106
    v_mul_f32 v107, s40, v107
    v_cos_f32 v112, v107
    v_sin_f32_e64 v120, -v107
    v_add_u32 v105, v105, v104
    v_and_b32 v106, 31, v105
    v_cvt_f32_u32 v107, v106
    v_mul_f32 v107, s40, v107
    v_cos_f32 v113, v107
    v_sin_f32_e64 v121, -v107
    v_add_u32 v105, v105, v104
    v_and_b32 v106, 31, v105
    v_cvt_f32_u32 v107, v106
    v_mul_f32 v107, s40, v107
    v_cos_f32 v114, v107
    v_sin_f32_e64 v122, -v107
    v_add_u32 v105, v105, v104
    v_and_b32 v106, 31, v105
    v_cvt_f32_u32 v107, v106
    v_mul_f32 v107, s40, v107
    v_cos_f32 v115, v107
    v_sin_f32_e64 v123, -v107
    s_nop 0
    v_cvt_pk_bf16_f32 v20, v108, v109
    v_cvt_pk_bf16_f32 v28, v116, v117
    v_xor_b32 v36, s47, v28
    v_cvt_pk_bf16_f32 v21, v110, v111
    v_cvt_pk_bf16_f32 v29, v118, v119
    v_xor_b32 v37, s47, v29
    v_cvt_pk_bf16_f32 v22, v112, v113
    v_cvt_pk_bf16_f32 v30, v120, v121
    v_xor_b32 v38, s47, v30
    v_cvt_pk_bf16_f32 v23, v114, v115
    v_cvt_pk_bf16_f32 v31, v122, v123
    v_xor_b32 v39, s47, v31
    v_add_u32 v232, 0, v3
    v_lshlrev_b32 v233, 2, v2
    v_add_u32 v233, 0, v233
    v_mul_u32_u24 v233, v233, v232
    v_cvt_f32_u32 v235, v233
    v_mul_f32 v235, s41, v235
    v_cos_f32 v40, v235
    v_sin_f32_e64 v72, -v235
    v_add_u32 v233, v233, v232
    v_cvt_f32_u32 v235, v233
    v_mul_f32 v235, s41, v235
    v_cos_f32 v41, v235
    v_sin_f32_e64 v73, -v235
    v_add_u32 v233, v233, v232
    v_cvt_f32_u32 v235, v233
    v_mul_f32 v235, s41, v235
    v_cos_f32 v42, v235
    v_sin_f32_e64 v74, -v235
    v_add_u32 v233, v233, v232
    v_cvt_f32_u32 v235, v233
    v_mul_f32 v235, s41, v235
    v_cos_f32 v43, v235
    v_sin_f32_e64 v75, -v235
    v_add_u32 v232, 16, v3
    v_lshlrev_b32 v233, 2, v2
    v_add_u32 v233, 0, v233
    v_mul_u32_u24 v233, v233, v232
    v_cvt_f32_u32 v235, v233
    v_mul_f32 v235, s41, v235
    v_cos_f32 v44, v235
    v_sin_f32_e64 v76, -v235
    v_add_u32 v233, v233, v232
    v_cvt_f32_u32 v235, v233
    v_mul_f32 v235, s41, v235
    v_cos_f32 v45, v235
    v_sin_f32_e64 v77, -v235
    v_add_u32 v233, v233, v232
    v_cvt_f32_u32 v235, v233
    v_mul_f32 v235, s41, v235
    v_cos_f32 v46, v235
    v_sin_f32_e64 v78, -v235
    v_add_u32 v233, v233, v232
    v_cvt_f32_u32 v235, v233
    v_mul_f32 v235, s41, v235
    v_cos_f32 v47, v235
    v_sin_f32_e64 v79, -v235
    v_add_u32 v232, 0, v3
    v_lshlrev_b32 v233, 2, v2
    v_add_u32 v233, 16, v233
    v_mul_u32_u24 v233, v233, v232
    v_cvt_f32_u32 v235, v233
    v_mul_f32 v235, s41, v235
    v_cos_f32 v48, v235
    v_sin_f32_e64 v80, -v235
    v_add_u32 v233, v233, v232
    v_cvt_f32_u32 v235, v233
    v_mul_f32 v235, s41, v235
    v_cos_f32 v49, v235
    v_sin_f32_e64 v81, -v235
    v_add_u32 v233, v233, v232
    v_cvt_f32_u32 v235, v233
    v_mul_f32 v235, s41, v235
    v_cos_f32 v50, v235
    v_sin_f32_e64 v82, -v235
    v_add_u32 v233, v233, v232
    v_cvt_f32_u32 v235, v233
    v_mul_f32 v235, s41, v235
    v_cos_f32 v51, v235
    v_sin_f32_e64 v83, -v235
    v_add_u32 v232, 16, v3
    v_lshlrev_b32 v233, 2, v2
    v_add_u32 v233, 16, v233
    v_mul_u32_u24 v233, v233, v232
    v_cvt_f32_u32 v235, v233
    v_mul_f32 v235, s41, v235
    v_cos_f32 v52, v235
    v_sin_f32_e64 v84, -v235
    v_add_u32 v233, v233, v232
    v_cvt_f32_u32 v235, v233
    v_mul_f32 v235, s41, v235
    v_cos_f32 v53, v235
    v_sin_f32_e64 v85, -v235
    v_add_u32 v233, v233, v232
    v_cvt_f32_u32 v235, v233
    v_mul_f32 v235, s41, v235
    v_cos_f32 v54, v235
    v_sin_f32_e64 v86, -v235
    v_add_u32 v233, v233, v232
    v_cvt_f32_u32 v235, v233
    v_mul_f32 v235, s41, v235
    v_cos_f32 v55, v235
    v_sin_f32_e64 v87, -v235
    v_add_u32 v232, 0, v3
    v_lshlrev_b32 v233, 2, v2
    v_add_u32 v233, 32, v233
    v_mul_u32_u24 v233, v233, v232
    v_cvt_f32_u32 v235, v233
    v_mul_f32 v235, s41, v235
    v_cos_f32 v56, v235
    v_sin_f32_e64 v88, -v235
    v_add_u32 v233, v233, v232
    v_cvt_f32_u32 v235, v233
    v_mul_f32 v235, s41, v235
    v_cos_f32 v57, v235
    v_sin_f32_e64 v89, -v235
    v_add_u32 v233, v233, v232
    v_cvt_f32_u32 v235, v233
    v_mul_f32 v235, s41, v235
    v_cos_f32 v58, v235
    v_sin_f32_e64 v90, -v235
    v_add_u32 v233, v233, v232
    v_cvt_f32_u32 v235, v233
    v_mul_f32 v235, s41, v235
    v_cos_f32 v59, v235
    v_sin_f32_e64 v91, -v235
    v_add_u32 v232, 16, v3
    v_lshlrev_b32 v233, 2, v2
    v_add_u32 v233, 32, v233
    v_mul_u32_u24 v233, v233, v232
    v_cvt_f32_u32 v235, v233
    v_mul_f32 v235, s41, v235
    v_cos_f32 v60, v235
    v_sin_f32_e64 v92, -v235
    v_add_u32 v233, v233, v232
    v_cvt_f32_u32 v235, v233
    v_mul_f32 v235, s41, v235
    v_cos_f32 v61, v235
    v_sin_f32_e64 v93, -v235
    v_add_u32 v233, v233, v232
    v_cvt_f32_u32 v235, v233
    v_mul_f32 v235, s41, v235
    v_cos_f32 v62, v235
    v_sin_f32_e64 v94, -v235
    v_add_u32 v233, v233, v232
    v_cvt_f32_u32 v235, v233
    v_mul_f32 v235, s41, v235
    v_cos_f32 v63, v235
    v_sin_f32_e64 v95, -v235
    v_add_u32 v232, 0, v3
    v_lshlrev_b32 v233, 2, v2
    v_add_u32 v233, 48, v233
    v_mul_u32_u24 v233, v233, v232
    v_cvt_f32_u32 v235, v233
    v_mul_f32 v235, s41, v235
    v_cos_f32 v64, v235
    v_sin_f32_e64 v96, -v235
    v_add_u32 v233, v233, v232
    v_cvt_f32_u32 v235, v233
    v_mul_f32 v235, s41, v235
    v_cos_f32 v65, v235
    v_sin_f32_e64 v97, -v235
    v_add_u32 v233, v233, v232
    v_cvt_f32_u32 v235, v233
    v_mul_f32 v235, s41, v235
    v_cos_f32 v66, v235
    v_sin_f32_e64 v98, -v235
    v_add_u32 v233, v233, v232
    v_cvt_f32_u32 v235, v233
    v_mul_f32 v235, s41, v235
    v_cos_f32 v67, v235
    v_sin_f32_e64 v99, -v235
    v_add_u32 v232, 16, v3
    v_lshlrev_b32 v233, 2, v2
    v_add_u32 v233, 48, v233
    v_mul_u32_u24 v233, v233, v232
    v_cvt_f32_u32 v235, v233
    v_mul_f32 v235, s41, v235
    v_cos_f32 v68, v235
    v_sin_f32_e64 v100, -v235
    v_add_u32 v233, v233, v232
    v_cvt_f32_u32 v235, v233
    v_mul_f32 v235, s41, v235
    v_cos_f32 v69, v235
    v_sin_f32_e64 v101, -v235
    v_add_u32 v233, v233, v232
    v_cvt_f32_u32 v235, v233
    v_mul_f32 v235, s41, v235
    v_cos_f32 v70, v235
    v_sin_f32_e64 v102, -v235
    v_add_u32 v233, v233, v232
    v_cvt_f32_u32 v235, v233
    v_mul_f32 v235, s41, v235
    v_cos_f32 v71, v235
    v_sin_f32_e64 v103, -v235
    s_lshr_b32 s43, s96, 1
    s_lshl_b32 s43, s43, 4
    v_add_u32 v232, s43, v3
    s_and_b32 s44, s96, 1
    s_lshl_b32 s44, s44, 5
    v_lshlrev_b32 v233, 2, v2
    v_add_u32 v233, s44, v233
    v_mul_u32_u24 v234, v233, v232
    v_and_b32 v235, 63, v234
    v_cvt_f32_u32 v236, v235
    v_mul_f32 v236, s42, v236
    v_cos_f32 v104, v236
    v_sin_f32 v112, v236
    v_add_u32 v234, v234, v232
    v_and_b32 v235, 63, v234
    v_cvt_f32_u32 v236, v235
    v_mul_f32 v236, s42, v236
    v_cos_f32 v105, v236
    v_sin_f32 v113, v236
    v_add_u32 v234, v234, v232
    v_and_b32 v235, 63, v234
    v_cvt_f32_u32 v236, v235
    v_mul_f32 v236, s42, v236
    v_cos_f32 v106, v236
    v_sin_f32 v114, v236
    v_add_u32 v234, v234, v232
    v_and_b32 v235, 63, v234
    v_cvt_f32_u32 v236, v235
    v_mul_f32 v236, s42, v236
    v_cos_f32 v107, v236
    v_sin_f32 v115, v236
    v_add_u32 v234, v234, v232
    v_add_u32 v233, 16, v233
    v_mul_u32_u24 v234, v233, v232
    v_and_b32 v235, 63, v234
    v_cvt_f32_u32 v236, v235
    v_mul_f32 v236, s42, v236
    v_cos_f32 v108, v236
    v_sin_f32 v116, v236
    v_add_u32 v234, v234, v232
    v_and_b32 v235, 63, v234
    v_cvt_f32_u32 v236, v235
    v_mul_f32 v236, s42, v236
    v_cos_f32 v109, v236
    v_sin_f32 v117, v236
    v_add_u32 v234, v234, v232
    v_and_b32 v235, 63, v234
    v_cvt_f32_u32 v236, v235
    v_mul_f32 v236, s42, v236
    v_cos_f32 v110, v236
    v_sin_f32 v118, v236
    v_add_u32 v234, v234, v232
    v_and_b32 v235, 63, v234
    v_cvt_f32_u32 v236, v235
    v_mul_f32 v236, s42, v236
    v_cos_f32 v111, v236
    v_sin_f32 v119, v236
    v_add_u32 v234, v234, v232
    s_nop 0
    v_cvt_pk_bf16_f32 v240, v104, v105
    v_cvt_pk_bf16_f32 v244, v112, v113
    v_cvt_pk_bf16_f32 v241, v106, v107
    v_cvt_pk_bf16_f32 v245, v114, v115
    v_cvt_pk_bf16_f32 v242, v108, v109
    v_cvt_pk_bf16_f32 v246, v116, v117
    v_cvt_pk_bf16_f32 v243, v110, v111
    v_cvt_pk_bf16_f32 v247, v118, v119
    s_lshl_b32 s43, s96, 10
    s_add_u32 s43, s43, 131072
    v_lshlrev_b32 v8, 4, v0
    v_add_u32 v9, s43, v8
    ds_write_b128 v9, v[240:243]
    ds_write_b128 v9, v[244:247] offset:8192
    v_add_u32 v8, 131072, v8
    v_lshrrev_b32 v10, 2, v0
    v_and_b32 v10, 3, v10
    v_lshlrev_b32 v11, 3, v2
    v_add_u32 v11, v11, v10
    v_lshlrev_b32 v11, 10, v11
    v_and_b32 v12, 1, v2
    v_lshlrev_b32 v12, 2, v12
    v_or_b32 v10, v10, v12
    v_xor_b32 v10, s96, v10
    v_lshlrev_b32 v10, 4, v10
    v_add_u32 v11, v11, v10
    v_and_b32 v12, 2, v0
    v_lshlrev_b32 v12, 6, v12
    v_add_u32 v11, v11, v12
    v_and_b32 v12, 1, v0
    v_lshlrev_b32 v12, 3, v12
    v_add_u32 v12, v11, v12
    v_add_u32 v13, 0x10000, v12
    v_and_b32 v10, 1, v2
    v_lshlrev_b32 v10, 5, v10
    v_lshrrev_b32 v11, 1, v2
    v_lshlrev_b32 v11, 4, v11
    v_add_u32 v10, v10, v11
    v_lshlrev_b32 v11, 6, v3
    v_add_u32 v10, v10, v11
    s_mov_b32 s48, 1152
    s_mov_b32 s49, 1408
    s_mov_b32 s50, 1664
    s_mov_b32 s51, 1920
    s_waitcnt vmcnt(0) lgkmcnt(0)
    s_cmp_lg_u32 s96, s98
    s_cbranch_scc1 POLL_5_END
    v_lshlrev_b32 v253, 2, v0
    v_add_u32 v253, s48, v253
    s_mov_b64 exec, -1
    s_mov_b32 s52, 0x20000
POLL_5_0:
    buffer_load_dword v252, v253, s[80:83], 0 offen sc0 sc1
    s_waitcnt vmcnt(0)
    v_cmp_ne_u32 vcc, s97, v252
    s_nop 4
    s_cbranch_vccz POLL_5_0_OK
    s_sleep 1
    s_sub_u32 s52, s52, 1
    s_cmp_lg_u32 s52, 0
    s_cbranch_scc1 POLL_5_0
POLL_5_0_OK:
    s_mov_b64 exec, -1
    v_lshlrev_b32 v253, 2, v0
    v_add_u32 v253, s49, v253
    s_mov_b64 exec, -1
    s_mov_b32 s52, 0x20000
POLL_5_1:
    buffer_load_dword v252, v253, s[80:83], 0 offen sc0 sc1
    s_waitcnt vmcnt(0)
    v_cmp_ne_u32 vcc, s97, v252
    s_nop 4
    s_cbranch_vccz POLL_5_1_OK
    s_sleep 1
    s_sub_u32 s52, s52, 1
    s_cmp_lg_u32 s52, 0
    s_cbranch_scc1 POLL_5_1
POLL_5_1_OK:
    s_mov_b64 exec, -1
    v_lshlrev_b32 v253, 2, v0
    v_add_u32 v253, s50, v253
    s_mov_b64 exec, -1
    s_mov_b32 s52, 0x20000
POLL_5_2:
    buffer_load_dword v252, v253, s[80:83], 0 offen sc0 sc1
    s_waitcnt vmcnt(0)
    v_cmp_ne_u32 vcc, s97, v252
    s_nop 4
    s_cbranch_vccz POLL_5_2_OK
    s_sleep 1
    s_sub_u32 s52, s52, 1
    s_cmp_lg_u32 s52, 0
    s_cbranch_scc1 POLL_5_2
POLL_5_2_OK:
    s_mov_b64 exec, -1
    v_lshlrev_b32 v253, 2, v0
    v_add_u32 v253, s51, v253
    s_mov_b64 exec, -1
    s_mov_b32 s52, 0x20000
POLL_5_3:
    buffer_load_dword v252, v253, s[80:83], 0 offen sc0 sc1
    s_waitcnt vmcnt(0)
    v_cmp_ne_u32 vcc, s97, v252
    s_nop 4
    s_cbranch_vccz POLL_5_3_OK
    s_sleep 1
    s_sub_u32 s52, s52, 1
    s_cmp_lg_u32 s52, 0
    s_cbranch_scc1 POLL_5_3
POLL_5_3_OK:
    s_mov_b64 exec, -1
POLL_5_END:
    s_cmp_lg_u32 s2, 224
    s_cbranch_scc1 SEED_6
    s_mov_b32 s52, 0
    s_cmp_lg_u32 s96, s98
    s_cbranch_scc1 SIG_7
    v_mov_b32 v252, s97
    v_mov_b32 v253, s52
    s_mov_b64 exec, 1
    buffer_store_dword v252, v253, s[80:83], 0 offen sc0 sc1
    s_mov_b64 exec, -1
SIG_7:
SEED_6:
    s_barrier
    s_sub_u32 s34, s2, 224
    s_lshl_b32 s34, s34, 7
    s_add_u32 s35, s34, 4096
    s_add_u32 m0, s36, 0
    s_add_u32 s39, s33, s34
    s_add_u32 s39, s39, 0
    buffer_load_dwordx4 v6, s[12:15], s39 offen lds
    s_add_u32 m0, s36, 8192
    s_add_u32 s39, s33, s34
    s_add_u32 s39, s39, 1064960
    buffer_load_dwordx4 v7, s[12:15], s39 offen lds
    s_add_u32 m0, s36, 16384
    s_add_u32 s39, s33, s34
    s_add_u32 s39, s39, 2129920
    buffer_load_dwordx4 v6, s[12:15], s39 offen lds
    s_add_u32 m0, s36, 24576
    s_add_u32 s39, s33, s34
    s_add_u32 s39, s39, 3194880
    buffer_load_dwordx4 v7, s[12:15], s39 offen lds
    s_add_u32 m0, s36, 32768
    s_add_u32 s39, s33, s34
    s_add_u32 s39, s39, 8320
    buffer_load_dwordx4 v6, s[12:15], s39 offen lds
    s_add_u32 m0, s36, 40960
    s_add_u32 s39, s33, s34
    s_add_u32 s39, s39, 1073280
    buffer_load_dwordx4 v7, s[12:15], s39 offen lds
    s_add_u32 m0, s36, 49152
    s_add_u32 s39, s33, s34
    s_add_u32 s39, s39, 2138240
    buffer_load_dwordx4 v6, s[12:15], s39 offen lds
    s_add_u32 m0, s36, 57344
    s_add_u32 s39, s33, s34
    s_add_u32 s39, s39, 3203200
    buffer_load_dwordx4 v7, s[12:15], s39 offen lds
    s_add_u32 m0, s36, 65536
    s_add_u32 s39, s33, s35
    s_add_u32 s39, s39, 0
    buffer_load_dwordx4 v6, s[12:15], s39 offen lds
    s_add_u32 m0, s36, 73728
    s_add_u32 s39, s33, s35
    s_add_u32 s39, s39, 1064960
    buffer_load_dwordx4 v7, s[12:15], s39 offen lds
    s_add_u32 m0, s36, 81920
    s_add_u32 s39, s33, s35
    s_add_u32 s39, s39, 2129920
    buffer_load_dwordx4 v6, s[12:15], s39 offen lds
    s_add_u32 m0, s36, 90112
    s_add_u32 s39, s33, s35
    s_add_u32 s39, s39, 3194880
    buffer_load_dwordx4 v7, s[12:15], s39 offen lds
    s_add_u32 m0, s36, 98304
    s_add_u32 s39, s33, s35
    s_add_u32 s39, s39, 8320
    buffer_load_dwordx4 v6, s[12:15], s39 offen lds
    s_add_u32 m0, s36, 106496
    s_add_u32 s39, s33, s35
    s_add_u32 s39, s39, 1073280
    buffer_load_dwordx4 v7, s[12:15], s39 offen lds
    s_add_u32 m0, s36, 114688
    s_add_u32 s39, s33, s35
    s_add_u32 s39, s39, 2138240
    buffer_load_dwordx4 v6, s[12:15], s39 offen lds
    s_add_u32 m0, s36, 122880
    s_add_u32 s39, s33, s35
    s_add_u32 s39, s39, 3203200
    buffer_load_dwordx4 v7, s[12:15], s39 offen lds
    s_waitcnt vmcnt(8)
    s_barrier
    s_add_u32 s30, s29, 0
    s_mov_b32 s46, 1
    s_mov_b32 s47, 0x80008000
    ds_read_b64_tr_b16 v[104:105], v12 offset:0
    ds_read_b64_tr_b16 v[120:121], v12 offset:32768
    ds_read_b64_tr_b16 v[106:107], v12 offset:4096
    ds_read_b64_tr_b16 v[122:123], v12 offset:36864
    ds_read_b64_tr_b16 v[108:109], v12 offset:256
    ds_read_b64_tr_b16 v[124:125], v12 offset:33024
    ds_read_b64_tr_b16 v[110:111], v12 offset:4352
    ds_read_b64_tr_b16 v[126:127], v12 offset:37120
    ds_read_b64_tr_b16 v[112:113], v12 offset:512
    ds_read_b64_tr_b16 v[128:129], v12 offset:33280
    ds_read_b64_tr_b16 v[114:115], v12 offset:4608
    ds_read_b64_tr_b16 v[130:131], v12 offset:37376
    ds_read_b64_tr_b16 v[116:117], v12 offset:768
    ds_read_b64_tr_b16 v[132:133], v12 offset:33536
    ds_read_b64_tr_b16 v[118:119], v12 offset:4864
    ds_read_b64_tr_b16 v[134:135], v12 offset:37632
    s_lshl_b32 s45, s30, 12
    s_waitcnt lgkmcnt(0)
    v_mfma_f32_16x16x32_bf16 v[136:139], v[104:107], v[16:19], 0
    v_mfma_f32_16x16x32_bf16 v[168:171], v[104:107], v[24:27], 0
    v_mfma_f32_16x16x32_bf16 v[140:143], v[104:107], v[20:23], 0
    v_mfma_f32_16x16x32_bf16 v[172:175], v[104:107], v[28:31], 0
    v_mfma_f32_16x16x32_bf16 v[144:147], v[108:111], v[16:19], 0
    v_mfma_f32_16x16x32_bf16 v[176:179], v[108:111], v[24:27], 0
    v_mfma_f32_16x16x32_bf16 v[148:151], v[108:111], v[20:23], 0
    v_mfma_f32_16x16x32_bf16 v[180:183], v[108:111], v[28:31], 0
    v_mfma_f32_16x16x32_bf16 v[152:155], v[112:115], v[16:19], 0
    v_mfma_f32_16x16x32_bf16 v[184:187], v[112:115], v[24:27], 0
    v_mfma_f32_16x16x32_bf16 v[156:159], v[112:115], v[20:23], 0
    v_mfma_f32_16x16x32_bf16 v[188:191], v[112:115], v[28:31], 0
    v_mfma_f32_16x16x32_bf16 v[160:163], v[116:119], v[16:19], 0
    v_mfma_f32_16x16x32_bf16 v[192:195], v[116:119], v[24:27], 0
    v_mfma_f32_16x16x32_bf16 v[164:167], v[116:119], v[20:23], 0
    v_mfma_f32_16x16x32_bf16 v[196:199], v[116:119], v[28:31], 0
    v_mfma_f32_16x16x32_bf16 v[136:139], v[120:123], v[32:35], v[136:139]
    v_mfma_f32_16x16x32_bf16 v[168:171], v[120:123], v[16:19], v[168:171]
    v_mfma_f32_16x16x32_bf16 v[140:143], v[120:123], v[36:39], v[140:143]
    v_mfma_f32_16x16x32_bf16 v[172:175], v[120:123], v[20:23], v[172:175]
    v_mfma_f32_16x16x32_bf16 v[144:147], v[124:127], v[32:35], v[144:147]
    v_mfma_f32_16x16x32_bf16 v[176:179], v[124:127], v[16:19], v[176:179]
    v_mfma_f32_16x16x32_bf16 v[148:151], v[124:127], v[36:39], v[148:151]
    v_mfma_f32_16x16x32_bf16 v[180:183], v[124:127], v[20:23], v[180:183]
    v_mfma_f32_16x16x32_bf16 v[152:155], v[128:131], v[32:35], v[152:155]
    v_mfma_f32_16x16x32_bf16 v[184:187], v[128:131], v[16:19], v[184:187]
    v_mfma_f32_16x16x32_bf16 v[156:159], v[128:131], v[36:39], v[156:159]
    v_mfma_f32_16x16x32_bf16 v[188:191], v[128:131], v[20:23], v[188:191]
    v_mfma_f32_16x16x32_bf16 v[160:163], v[132:135], v[32:35], v[160:163]
    v_mfma_f32_16x16x32_bf16 v[192:195], v[132:135], v[16:19], v[192:195]
    v_mfma_f32_16x16x32_bf16 v[164:167], v[132:135], v[36:39], v[164:167]
    v_mfma_f32_16x16x32_bf16 v[196:199], v[132:135], v[20:23], v[196:199]
    s_nop 7
    ds_read_b128 v[104:107], v8 offset:0
    ds_read_b128 v[120:123], v8 offset:8192
    ds_read_b128 v[108:111], v8 offset:1024
    ds_read_b128 v[124:127], v8 offset:9216
    ds_read_b128 v[112:115], v8 offset:2048
    ds_read_b128 v[128:131], v8 offset:10240
    ds_read_b128 v[116:119], v8 offset:3072
    ds_read_b128 v[132:135], v8 offset:11264
    v_pk_mul_f32 v[232:233], v[168:169], v[72:73]
    v_pk_mul_f32 v[234:235], v[168:169], v[40:41]
    v_pk_fma_f32 v[168:169], v[136:137], v[72:73], v[234:235]
    v_pk_fma_f32 v[136:137], v[136:137], v[40:41], v[232:233] neg_lo:[0,0,1] neg_hi:[0,0,1]
    v_pk_mul_f32 v[232:233], v[170:171], v[74:75]
    v_pk_mul_f32 v[234:235], v[170:171], v[42:43]
    v_pk_fma_f32 v[170:171], v[138:139], v[74:75], v[234:235]
    v_pk_fma_f32 v[138:139], v[138:139], v[42:43], v[232:233] neg_lo:[0,0,1] neg_hi:[0,0,1]
    v_pk_mul_f32 v[232:233], v[172:173], v[76:77]
    v_pk_mul_f32 v[234:235], v[172:173], v[44:45]
    v_pk_fma_f32 v[172:173], v[140:141], v[76:77], v[234:235]
    v_pk_fma_f32 v[140:141], v[140:141], v[44:45], v[232:233] neg_lo:[0,0,1] neg_hi:[0,0,1]
    v_pk_mul_f32 v[232:233], v[174:175], v[78:79]
    v_pk_mul_f32 v[234:235], v[174:175], v[46:47]
    v_pk_fma_f32 v[174:175], v[142:143], v[78:79], v[234:235]
    v_pk_fma_f32 v[142:143], v[142:143], v[46:47], v[232:233] neg_lo:[0,0,1] neg_hi:[0,0,1]
    v_pk_mul_f32 v[232:233], v[176:177], v[80:81]
    v_pk_mul_f32 v[234:235], v[176:177], v[48:49]
    v_pk_fma_f32 v[176:177], v[144:145], v[80:81], v[234:235]
    v_pk_fma_f32 v[144:145], v[144:145], v[48:49], v[232:233] neg_lo:[0,0,1] neg_hi:[0,0,1]
    v_pk_mul_f32 v[232:233], v[178:179], v[82:83]
    v_pk_mul_f32 v[234:235], v[178:179], v[50:51]
    v_pk_fma_f32 v[178:179], v[146:147], v[82:83], v[234:235]
    v_pk_fma_f32 v[146:147], v[146:147], v[50:51], v[232:233] neg_lo:[0,0,1] neg_hi:[0,0,1]
    v_pk_mul_f32 v[232:233], v[180:181], v[84:85]
    v_pk_mul_f32 v[234:235], v[180:181], v[52:53]
    v_pk_fma_f32 v[180:181], v[148:149], v[84:85], v[234:235]
    v_pk_fma_f32 v[148:149], v[148:149], v[52:53], v[232:233] neg_lo:[0,0,1] neg_hi:[0,0,1]
    v_pk_mul_f32 v[232:233], v[182:183], v[86:87]
    v_pk_mul_f32 v[234:235], v[182:183], v[54:55]
    v_pk_fma_f32 v[182:183], v[150:151], v[86:87], v[234:235]
    v_pk_fma_f32 v[150:151], v[150:151], v[54:55], v[232:233] neg_lo:[0,0,1] neg_hi:[0,0,1]
    v_pk_mul_f32 v[232:233], v[184:185], v[88:89]
    v_pk_mul_f32 v[234:235], v[184:185], v[56:57]
    v_pk_fma_f32 v[184:185], v[152:153], v[88:89], v[234:235]
    v_pk_fma_f32 v[152:153], v[152:153], v[56:57], v[232:233] neg_lo:[0,0,1] neg_hi:[0,0,1]
    v_pk_mul_f32 v[232:233], v[186:187], v[90:91]
    v_pk_mul_f32 v[234:235], v[186:187], v[58:59]
    v_pk_fma_f32 v[186:187], v[154:155], v[90:91], v[234:235]
    v_pk_fma_f32 v[154:155], v[154:155], v[58:59], v[232:233] neg_lo:[0,0,1] neg_hi:[0,0,1]
    v_pk_mul_f32 v[232:233], v[188:189], v[92:93]
    v_pk_mul_f32 v[234:235], v[188:189], v[60:61]
    v_pk_fma_f32 v[188:189], v[156:157], v[92:93], v[234:235]
    v_pk_fma_f32 v[156:157], v[156:157], v[60:61], v[232:233] neg_lo:[0,0,1] neg_hi:[0,0,1]
    v_pk_mul_f32 v[232:233], v[190:191], v[94:95]
    v_pk_mul_f32 v[234:235], v[190:191], v[62:63]
    v_pk_fma_f32 v[190:191], v[158:159], v[94:95], v[234:235]
    v_pk_fma_f32 v[158:159], v[158:159], v[62:63], v[232:233] neg_lo:[0,0,1] neg_hi:[0,0,1]
    v_pk_mul_f32 v[232:233], v[192:193], v[96:97]
    v_pk_mul_f32 v[234:235], v[192:193], v[64:65]
    v_pk_fma_f32 v[192:193], v[160:161], v[96:97], v[234:235]
    v_pk_fma_f32 v[160:161], v[160:161], v[64:65], v[232:233] neg_lo:[0,0,1] neg_hi:[0,0,1]
    v_pk_mul_f32 v[232:233], v[194:195], v[98:99]
    v_pk_mul_f32 v[234:235], v[194:195], v[66:67]
    v_pk_fma_f32 v[194:195], v[162:163], v[98:99], v[234:235]
    v_pk_fma_f32 v[162:163], v[162:163], v[66:67], v[232:233] neg_lo:[0,0,1] neg_hi:[0,0,1]
    v_pk_mul_f32 v[232:233], v[196:197], v[100:101]
    v_pk_mul_f32 v[234:235], v[196:197], v[68:69]
    v_pk_fma_f32 v[196:197], v[164:165], v[100:101], v[234:235]
    v_pk_fma_f32 v[164:165], v[164:165], v[68:69], v[232:233] neg_lo:[0,0,1] neg_hi:[0,0,1]
    v_pk_mul_f32 v[232:233], v[198:199], v[102:103]
    v_pk_mul_f32 v[234:235], v[198:199], v[70:71]
    v_pk_fma_f32 v[198:199], v[166:167], v[102:103], v[234:235]
    v_pk_fma_f32 v[166:167], v[166:167], v[70:71], v[232:233] neg_lo:[0,0,1] neg_hi:[0,0,1]
    v_cvt_pk_bf16_f32 v200, v136, v137
    v_cvt_pk_bf16_f32 v216, v168, v169
    v_cvt_pk_bf16_f32 v201, v138, v139
    v_cvt_pk_bf16_f32 v217, v170, v171
    v_cvt_pk_bf16_f32 v202, v144, v145
    v_cvt_pk_bf16_f32 v218, v176, v177
    v_cvt_pk_bf16_f32 v203, v146, v147
    v_cvt_pk_bf16_f32 v219, v178, v179
    v_cvt_pk_bf16_f32 v204, v152, v153
    v_cvt_pk_bf16_f32 v220, v184, v185
    v_cvt_pk_bf16_f32 v205, v154, v155
    v_cvt_pk_bf16_f32 v221, v186, v187
    v_cvt_pk_bf16_f32 v206, v160, v161
    v_cvt_pk_bf16_f32 v222, v192, v193
    v_cvt_pk_bf16_f32 v207, v162, v163
    v_cvt_pk_bf16_f32 v223, v194, v195
    v_cvt_pk_bf16_f32 v208, v140, v141
    v_cvt_pk_bf16_f32 v224, v172, v173
    v_cvt_pk_bf16_f32 v209, v142, v143
    v_cvt_pk_bf16_f32 v225, v174, v175
    v_cvt_pk_bf16_f32 v210, v148, v149
    v_cvt_pk_bf16_f32 v226, v180, v181
    v_cvt_pk_bf16_f32 v211, v150, v151
    v_cvt_pk_bf16_f32 v227, v182, v183
    v_cvt_pk_bf16_f32 v212, v156, v157
    v_cvt_pk_bf16_f32 v228, v188, v189
    v_cvt_pk_bf16_f32 v213, v158, v159
    v_cvt_pk_bf16_f32 v229, v190, v191
    v_cvt_pk_bf16_f32 v214, v164, v165
    v_cvt_pk_bf16_f32 v230, v196, v197
    v_cvt_pk_bf16_f32 v215, v166, v167
    v_cvt_pk_bf16_f32 v231, v198, v199
    s_waitcnt lgkmcnt(0)
    s_nop 1
    v_mfma_f32_16x16x32_bf16 v[136:139], v[200:203], v[104:107], 0
    v_mfma_f32_16x16x32_bf16 v[136:139], v[216:219], v[120:123], v[136:139]
    v_mfma_f32_16x16x32_bf16 v[136:139], v[204:207], v[108:111], v[136:139]
    v_mfma_f32_16x16x32_bf16 v[136:139], v[220:223], v[124:127], v[136:139]
    v_mfma_f32_16x16x32_bf16 v[152:155], v[208:211], v[104:107], 0
    v_mfma_f32_16x16x32_bf16 v[152:155], v[224:227], v[120:123], v[152:155]
    v_mfma_f32_16x16x32_bf16 v[152:155], v[212:215], v[108:111], v[152:155]
    v_mfma_f32_16x16x32_bf16 v[152:155], v[228:231], v[124:127], v[152:155]
    v_mfma_f32_16x16x32_bf16 v[140:143], v[200:203], v[112:115], 0
    v_mfma_f32_16x16x32_bf16 v[140:143], v[216:219], v[128:131], v[140:143]
    v_mfma_f32_16x16x32_bf16 v[140:143], v[204:207], v[116:119], v[140:143]
    v_mfma_f32_16x16x32_bf16 v[140:143], v[220:223], v[132:135], v[140:143]
    v_mfma_f32_16x16x32_bf16 v[156:159], v[208:211], v[112:115], 0
    v_mfma_f32_16x16x32_bf16 v[156:159], v[224:227], v[128:131], v[156:159]
    v_mfma_f32_16x16x32_bf16 v[156:159], v[212:215], v[116:119], v[156:159]
    v_mfma_f32_16x16x32_bf16 v[156:159], v[228:231], v[132:135], v[156:159]
    ds_read_b128 v[104:107], v8 offset:4096
    ds_read_b128 v[120:123], v8 offset:12288
    ds_read_b128 v[108:111], v8 offset:5120
    ds_read_b128 v[124:127], v8 offset:13312
    ds_read_b128 v[112:115], v8 offset:6144
    ds_read_b128 v[128:131], v8 offset:14336
    ds_read_b128 v[116:119], v8 offset:7168
    ds_read_b128 v[132:135], v8 offset:15360
    s_waitcnt lgkmcnt(0)
    s_nop 1
    v_mfma_f32_16x16x32_bf16 v[144:147], v[200:203], v[104:107], 0
    v_mfma_f32_16x16x32_bf16 v[144:147], v[216:219], v[120:123], v[144:147]
    v_mfma_f32_16x16x32_bf16 v[144:147], v[204:207], v[108:111], v[144:147]
    v_mfma_f32_16x16x32_bf16 v[144:147], v[220:223], v[124:127], v[144:147]
    v_mfma_f32_16x16x32_bf16 v[160:163], v[208:211], v[104:107], 0
    v_mfma_f32_16x16x32_bf16 v[160:163], v[224:227], v[120:123], v[160:163]
    v_mfma_f32_16x16x32_bf16 v[160:163], v[212:215], v[108:111], v[160:163]
    v_mfma_f32_16x16x32_bf16 v[160:163], v[228:231], v[124:127], v[160:163]
    v_mfma_f32_16x16x32_bf16 v[148:151], v[200:203], v[112:115], 0
    v_mfma_f32_16x16x32_bf16 v[148:151], v[216:219], v[128:131], v[148:151]
    v_mfma_f32_16x16x32_bf16 v[148:151], v[204:207], v[116:119], v[148:151]
    v_mfma_f32_16x16x32_bf16 v[148:151], v[220:223], v[132:135], v[148:151]
    v_mfma_f32_16x16x32_bf16 v[164:167], v[208:211], v[112:115], 0
    v_mfma_f32_16x16x32_bf16 v[164:167], v[224:227], v[128:131], v[164:167]
    v_mfma_f32_16x16x32_bf16 v[164:167], v[212:215], v[116:119], v[164:167]
    v_mfma_f32_16x16x32_bf16 v[164:167], v[228:231], v[132:135], v[164:167]
    s_cmp_eq_u32 s46, 0
    s_cbranch_scc1 NOST_8
    s_nop 7
    v_cvt_pk_bf16_f32 v232, v136, v137
    v_cvt_pk_bf16_f32 v233, v138, v139
    v_cvt_pk_bf16_f32 v234, v152, v153
    v_cvt_pk_bf16_f32 v235, v154, v155
    s_nop 1
    v_permlane16_swap_b32 v232, v234
    v_permlane16_swap_b32 v233, v235
    buffer_store_dwordx4 v[232:235], v10, s[16:19], s45 offen offset:0 sc1
    s_nop 1
    v_cvt_pk_bf16_f32 v236, v140, v141
    v_cvt_pk_bf16_f32 v237, v142, v143
    v_cvt_pk_bf16_f32 v238, v156, v157
    v_cvt_pk_bf16_f32 v239, v158, v159
    s_nop 1
    v_permlane16_swap_b32 v236, v238
    v_permlane16_swap_b32 v237, v239
    buffer_store_dwordx4 v[236:239], v10, s[16:19], s45 offen offset:1024 sc1
    s_nop 1
    v_cvt_pk_bf16_f32 v232, v144, v145
    v_cvt_pk_bf16_f32 v233, v146, v147
    v_cvt_pk_bf16_f32 v234, v160, v161
    v_cvt_pk_bf16_f32 v235, v162, v163
    s_nop 1
    v_permlane16_swap_b32 v232, v234
    v_permlane16_swap_b32 v233, v235
    buffer_store_dwordx4 v[232:235], v10, s[16:19], s45 offen offset:2048 sc1
    s_nop 1
    v_cvt_pk_bf16_f32 v236, v148, v149
    v_cvt_pk_bf16_f32 v237, v150, v151
    v_cvt_pk_bf16_f32 v238, v164, v165
    v_cvt_pk_bf16_f32 v239, v166, v167
    s_nop 1
    v_permlane16_swap_b32 v236, v238
    v_permlane16_swap_b32 v237, v239
    buffer_store_dwordx4 v[236:239], v10, s[16:19], s45 offen offset:3072 sc1
    s_nop 1
NOST_8:
    s_sub_u32 s30, 1024, s30
    s_cmp_lg_u32 s30, 1024
    s_cselect_b32 s46, 1, 0
    ds_read_b64_tr_b16 v[104:105], v12 offset:0
    ds_read_b64_tr_b16 v[120:121], v12 offset:32768
    ds_read_b64_tr_b16 v[106:107], v12 offset:4096
    ds_read_b64_tr_b16 v[122:123], v12 offset:36864
    ds_read_b64_tr_b16 v[108:109], v12 offset:256
    ds_read_b64_tr_b16 v[124:125], v12 offset:33024
    ds_read_b64_tr_b16 v[110:111], v12 offset:4352
    ds_read_b64_tr_b16 v[126:127], v12 offset:37120
    ds_read_b64_tr_b16 v[112:113], v12 offset:512
    ds_read_b64_tr_b16 v[128:129], v12 offset:33280
    ds_read_b64_tr_b16 v[114:115], v12 offset:4608
    ds_read_b64_tr_b16 v[130:131], v12 offset:37376
    ds_read_b64_tr_b16 v[116:117], v12 offset:768
    ds_read_b64_tr_b16 v[132:133], v12 offset:33536
    ds_read_b64_tr_b16 v[118:119], v12 offset:4864
    ds_read_b64_tr_b16 v[134:135], v12 offset:37632
    s_lshl_b32 s45, s30, 12
    s_waitcnt lgkmcnt(0)
    v_xor_b32 v120, s47, v120
    v_xor_b32 v121, s47, v121
    v_xor_b32 v122, s47, v122
    v_xor_b32 v123, s47, v123
    v_xor_b32 v124, s47, v124
    v_xor_b32 v125, s47, v125
    v_xor_b32 v126, s47, v126
    v_xor_b32 v127, s47, v127
    v_xor_b32 v128, s47, v128
    v_xor_b32 v129, s47, v129
    v_xor_b32 v130, s47, v130
    v_xor_b32 v131, s47, v131
    v_xor_b32 v132, s47, v132
    v_xor_b32 v133, s47, v133
    v_xor_b32 v134, s47, v134
    v_xor_b32 v135, s47, v135
    s_nop 1
    v_mfma_f32_16x16x32_bf16 v[136:139], v[104:107], v[16:19], 0
    v_mfma_f32_16x16x32_bf16 v[168:171], v[104:107], v[24:27], 0
    v_mfma_f32_16x16x32_bf16 v[140:143], v[104:107], v[20:23], 0
    v_mfma_f32_16x16x32_bf16 v[172:175], v[104:107], v[28:31], 0
    v_mfma_f32_16x16x32_bf16 v[144:147], v[108:111], v[16:19], 0
    v_mfma_f32_16x16x32_bf16 v[176:179], v[108:111], v[24:27], 0
    v_mfma_f32_16x16x32_bf16 v[148:151], v[108:111], v[20:23], 0
    v_mfma_f32_16x16x32_bf16 v[180:183], v[108:111], v[28:31], 0
    v_mfma_f32_16x16x32_bf16 v[152:155], v[112:115], v[16:19], 0
    v_mfma_f32_16x16x32_bf16 v[184:187], v[112:115], v[24:27], 0
    v_mfma_f32_16x16x32_bf16 v[156:159], v[112:115], v[20:23], 0
    v_mfma_f32_16x16x32_bf16 v[188:191], v[112:115], v[28:31], 0
    v_mfma_f32_16x16x32_bf16 v[160:163], v[116:119], v[16:19], 0
    v_mfma_f32_16x16x32_bf16 v[192:195], v[116:119], v[24:27], 0
    v_mfma_f32_16x16x32_bf16 v[164:167], v[116:119], v[20:23], 0
    v_mfma_f32_16x16x32_bf16 v[196:199], v[116:119], v[28:31], 0
    v_mfma_f32_16x16x32_bf16 v[136:139], v[120:123], v[32:35], v[136:139]
    v_mfma_f32_16x16x32_bf16 v[168:171], v[120:123], v[16:19], v[168:171]
    v_mfma_f32_16x16x32_bf16 v[140:143], v[120:123], v[36:39], v[140:143]
    v_mfma_f32_16x16x32_bf16 v[172:175], v[120:123], v[20:23], v[172:175]
    v_mfma_f32_16x16x32_bf16 v[144:147], v[124:127], v[32:35], v[144:147]
    v_mfma_f32_16x16x32_bf16 v[176:179], v[124:127], v[16:19], v[176:179]
    v_mfma_f32_16x16x32_bf16 v[148:151], v[124:127], v[36:39], v[148:151]
    v_mfma_f32_16x16x32_bf16 v[180:183], v[124:127], v[20:23], v[180:183]
    v_mfma_f32_16x16x32_bf16 v[152:155], v[128:131], v[32:35], v[152:155]
    v_mfma_f32_16x16x32_bf16 v[184:187], v[128:131], v[16:19], v[184:187]
    v_mfma_f32_16x16x32_bf16 v[156:159], v[128:131], v[36:39], v[156:159]
    v_mfma_f32_16x16x32_bf16 v[188:191], v[128:131], v[20:23], v[188:191]
    v_mfma_f32_16x16x32_bf16 v[160:163], v[132:135], v[32:35], v[160:163]
    v_mfma_f32_16x16x32_bf16 v[192:195], v[132:135], v[16:19], v[192:195]
    v_mfma_f32_16x16x32_bf16 v[164:167], v[132:135], v[36:39], v[164:167]
    v_mfma_f32_16x16x32_bf16 v[196:199], v[132:135], v[20:23], v[196:199]
    s_nop 7
    ds_read_b128 v[104:107], v8 offset:0
    ds_read_b128 v[120:123], v8 offset:8192
    ds_read_b128 v[108:111], v8 offset:1024
    ds_read_b128 v[124:127], v8 offset:9216
    ds_read_b128 v[112:115], v8 offset:2048
    ds_read_b128 v[128:131], v8 offset:10240
    ds_read_b128 v[116:119], v8 offset:3072
    ds_read_b128 v[132:135], v8 offset:11264
    v_pk_mul_f32 v[232:233], v[168:169], v[72:73]
    v_pk_mul_f32 v[234:235], v[168:169], v[40:41]
    v_pk_fma_f32 v[168:169], v[136:137], v[72:73], v[234:235]
    v_pk_fma_f32 v[136:137], v[136:137], v[40:41], v[232:233] neg_lo:[0,0,1] neg_hi:[0,0,1]
    v_pk_mul_f32 v[232:233], v[170:171], v[74:75]
    v_pk_mul_f32 v[234:235], v[170:171], v[42:43]
    v_pk_fma_f32 v[170:171], v[138:139], v[74:75], v[234:235]
    v_pk_fma_f32 v[138:139], v[138:139], v[42:43], v[232:233] neg_lo:[0,0,1] neg_hi:[0,0,1]
    v_pk_mul_f32 v[232:233], v[172:173], v[76:77]
    v_pk_mul_f32 v[234:235], v[172:173], v[44:45]
    v_pk_fma_f32 v[172:173], v[140:141], v[76:77], v[234:235]
    v_pk_fma_f32 v[140:141], v[140:141], v[44:45], v[232:233] neg_lo:[0,0,1] neg_hi:[0,0,1]
    v_pk_mul_f32 v[232:233], v[174:175], v[78:79]
    v_pk_mul_f32 v[234:235], v[174:175], v[46:47]
    v_pk_fma_f32 v[174:175], v[142:143], v[78:79], v[234:235]
    v_pk_fma_f32 v[142:143], v[142:143], v[46:47], v[232:233] neg_lo:[0,0,1] neg_hi:[0,0,1]
    v_pk_mul_f32 v[232:233], v[176:177], v[80:81]
    v_pk_mul_f32 v[234:235], v[176:177], v[48:49]
    v_pk_fma_f32 v[176:177], v[144:145], v[80:81], v[234:235]
    v_pk_fma_f32 v[144:145], v[144:145], v[48:49], v[232:233] neg_lo:[0,0,1] neg_hi:[0,0,1]
    v_pk_mul_f32 v[232:233], v[178:179], v[82:83]
    v_pk_mul_f32 v[234:235], v[178:179], v[50:51]
    v_pk_fma_f32 v[178:179], v[146:147], v[82:83], v[234:235]
    v_pk_fma_f32 v[146:147], v[146:147], v[50:51], v[232:233] neg_lo:[0,0,1] neg_hi:[0,0,1]
    v_pk_mul_f32 v[232:233], v[180:181], v[84:85]
    v_pk_mul_f32 v[234:235], v[180:181], v[52:53]
    v_pk_fma_f32 v[180:181], v[148:149], v[84:85], v[234:235]
    v_pk_fma_f32 v[148:149], v[148:149], v[52:53], v[232:233] neg_lo:[0,0,1] neg_hi:[0,0,1]
    v_pk_mul_f32 v[232:233], v[182:183], v[86:87]
    v_pk_mul_f32 v[234:235], v[182:183], v[54:55]
    v_pk_fma_f32 v[182:183], v[150:151], v[86:87], v[234:235]
    v_pk_fma_f32 v[150:151], v[150:151], v[54:55], v[232:233] neg_lo:[0,0,1] neg_hi:[0,0,1]
    v_pk_mul_f32 v[232:233], v[184:185], v[88:89]
    v_pk_mul_f32 v[234:235], v[184:185], v[56:57]
    v_pk_fma_f32 v[184:185], v[152:153], v[88:89], v[234:235]
    v_pk_fma_f32 v[152:153], v[152:153], v[56:57], v[232:233] neg_lo:[0,0,1] neg_hi:[0,0,1]
    v_pk_mul_f32 v[232:233], v[186:187], v[90:91]
    v_pk_mul_f32 v[234:235], v[186:187], v[58:59]
    v_pk_fma_f32 v[186:187], v[154:155], v[90:91], v[234:235]
    v_pk_fma_f32 v[154:155], v[154:155], v[58:59], v[232:233] neg_lo:[0,0,1] neg_hi:[0,0,1]
    v_pk_mul_f32 v[232:233], v[188:189], v[92:93]
    v_pk_mul_f32 v[234:235], v[188:189], v[60:61]
    v_pk_fma_f32 v[188:189], v[156:157], v[92:93], v[234:235]
    v_pk_fma_f32 v[156:157], v[156:157], v[60:61], v[232:233] neg_lo:[0,0,1] neg_hi:[0,0,1]
    v_pk_mul_f32 v[232:233], v[190:191], v[94:95]
    v_pk_mul_f32 v[234:235], v[190:191], v[62:63]
    v_pk_fma_f32 v[190:191], v[158:159], v[94:95], v[234:235]
    v_pk_fma_f32 v[158:159], v[158:159], v[62:63], v[232:233] neg_lo:[0,0,1] neg_hi:[0,0,1]
    v_pk_mul_f32 v[232:233], v[192:193], v[96:97]
    v_pk_mul_f32 v[234:235], v[192:193], v[64:65]
    v_pk_fma_f32 v[192:193], v[160:161], v[96:97], v[234:235]
    v_pk_fma_f32 v[160:161], v[160:161], v[64:65], v[232:233] neg_lo:[0,0,1] neg_hi:[0,0,1]
    v_pk_mul_f32 v[232:233], v[194:195], v[98:99]
    v_pk_mul_f32 v[234:235], v[194:195], v[66:67]
    v_pk_fma_f32 v[194:195], v[162:163], v[98:99], v[234:235]
    v_pk_fma_f32 v[162:163], v[162:163], v[66:67], v[232:233] neg_lo:[0,0,1] neg_hi:[0,0,1]
    v_pk_mul_f32 v[232:233], v[196:197], v[100:101]
    v_pk_mul_f32 v[234:235], v[196:197], v[68:69]
    v_pk_fma_f32 v[196:197], v[164:165], v[100:101], v[234:235]
    v_pk_fma_f32 v[164:165], v[164:165], v[68:69], v[232:233] neg_lo:[0,0,1] neg_hi:[0,0,1]
    v_pk_mul_f32 v[232:233], v[198:199], v[102:103]
    v_pk_mul_f32 v[234:235], v[198:199], v[70:71]
    v_pk_fma_f32 v[198:199], v[166:167], v[102:103], v[234:235]
    v_pk_fma_f32 v[166:167], v[166:167], v[70:71], v[232:233] neg_lo:[0,0,1] neg_hi:[0,0,1]
    v_cvt_pk_bf16_f32 v200, v136, v137
    v_cvt_pk_bf16_f32 v216, v168, v169
    v_cvt_pk_bf16_f32 v201, v138, v139
    v_cvt_pk_bf16_f32 v217, v170, v171
    v_cvt_pk_bf16_f32 v202, v144, v145
    v_cvt_pk_bf16_f32 v218, v176, v177
    v_cvt_pk_bf16_f32 v203, v146, v147
    v_cvt_pk_bf16_f32 v219, v178, v179
    v_cvt_pk_bf16_f32 v204, v152, v153
    v_cvt_pk_bf16_f32 v220, v184, v185
    v_cvt_pk_bf16_f32 v205, v154, v155
    v_cvt_pk_bf16_f32 v221, v186, v187
    v_cvt_pk_bf16_f32 v206, v160, v161
    v_cvt_pk_bf16_f32 v222, v192, v193
    v_cvt_pk_bf16_f32 v207, v162, v163
    v_cvt_pk_bf16_f32 v223, v194, v195
    v_cvt_pk_bf16_f32 v208, v140, v141
    v_cvt_pk_bf16_f32 v224, v172, v173
    v_cvt_pk_bf16_f32 v209, v142, v143
    v_cvt_pk_bf16_f32 v225, v174, v175
    v_cvt_pk_bf16_f32 v210, v148, v149
    v_cvt_pk_bf16_f32 v226, v180, v181
    v_cvt_pk_bf16_f32 v211, v150, v151
    v_cvt_pk_bf16_f32 v227, v182, v183
    v_cvt_pk_bf16_f32 v212, v156, v157
    v_cvt_pk_bf16_f32 v228, v188, v189
    v_cvt_pk_bf16_f32 v213, v158, v159
    v_cvt_pk_bf16_f32 v229, v190, v191
    v_cvt_pk_bf16_f32 v214, v164, v165
    v_cvt_pk_bf16_f32 v230, v196, v197
    v_cvt_pk_bf16_f32 v215, v166, v167
    v_cvt_pk_bf16_f32 v231, v198, v199
    s_waitcnt lgkmcnt(0)
    s_nop 1
    v_mfma_f32_16x16x32_bf16 v[136:139], v[200:203], v[104:107], 0
    v_mfma_f32_16x16x32_bf16 v[136:139], v[216:219], v[120:123], v[136:139]
    v_mfma_f32_16x16x32_bf16 v[136:139], v[204:207], v[108:111], v[136:139]
    v_mfma_f32_16x16x32_bf16 v[136:139], v[220:223], v[124:127], v[136:139]
    v_mfma_f32_16x16x32_bf16 v[152:155], v[208:211], v[104:107], 0
    v_mfma_f32_16x16x32_bf16 v[152:155], v[224:227], v[120:123], v[152:155]
    v_mfma_f32_16x16x32_bf16 v[152:155], v[212:215], v[108:111], v[152:155]
    v_mfma_f32_16x16x32_bf16 v[152:155], v[228:231], v[124:127], v[152:155]
    v_mfma_f32_16x16x32_bf16 v[140:143], v[200:203], v[112:115], 0
    v_mfma_f32_16x16x32_bf16 v[140:143], v[216:219], v[128:131], v[140:143]
    v_mfma_f32_16x16x32_bf16 v[140:143], v[204:207], v[116:119], v[140:143]
    v_mfma_f32_16x16x32_bf16 v[140:143], v[220:223], v[132:135], v[140:143]
    v_mfma_f32_16x16x32_bf16 v[156:159], v[208:211], v[112:115], 0
    v_mfma_f32_16x16x32_bf16 v[156:159], v[224:227], v[128:131], v[156:159]
    v_mfma_f32_16x16x32_bf16 v[156:159], v[212:215], v[116:119], v[156:159]
    v_mfma_f32_16x16x32_bf16 v[156:159], v[228:231], v[132:135], v[156:159]
    ds_read_b128 v[104:107], v8 offset:4096
    ds_read_b128 v[120:123], v8 offset:12288
    ds_read_b128 v[108:111], v8 offset:5120
    ds_read_b128 v[124:127], v8 offset:13312
    ds_read_b128 v[112:115], v8 offset:6144
    ds_read_b128 v[128:131], v8 offset:14336
    ds_read_b128 v[116:119], v8 offset:7168
    ds_read_b128 v[132:135], v8 offset:15360
    s_waitcnt lgkmcnt(0)
    s_nop 1
    v_mfma_f32_16x16x32_bf16 v[144:147], v[200:203], v[104:107], 0
    v_mfma_f32_16x16x32_bf16 v[144:147], v[216:219], v[120:123], v[144:147]
    v_mfma_f32_16x16x32_bf16 v[144:147], v[204:207], v[108:111], v[144:147]
    v_mfma_f32_16x16x32_bf16 v[144:147], v[220:223], v[124:127], v[144:147]
    v_mfma_f32_16x16x32_bf16 v[160:163], v[208:211], v[104:107], 0
    v_mfma_f32_16x16x32_bf16 v[160:163], v[224:227], v[120:123], v[160:163]
    v_mfma_f32_16x16x32_bf16 v[160:163], v[212:215], v[108:111], v[160:163]
    v_mfma_f32_16x16x32_bf16 v[160:163], v[228:231], v[124:127], v[160:163]
    v_mfma_f32_16x16x32_bf16 v[148:151], v[200:203], v[112:115], 0
    v_mfma_f32_16x16x32_bf16 v[148:151], v[216:219], v[128:131], v[148:151]
    v_mfma_f32_16x16x32_bf16 v[148:151], v[204:207], v[116:119], v[148:151]
    v_mfma_f32_16x16x32_bf16 v[148:151], v[220:223], v[132:135], v[148:151]
    v_mfma_f32_16x16x32_bf16 v[164:167], v[208:211], v[112:115], 0
    v_mfma_f32_16x16x32_bf16 v[164:167], v[224:227], v[128:131], v[164:167]
    v_mfma_f32_16x16x32_bf16 v[164:167], v[212:215], v[116:119], v[164:167]
    v_mfma_f32_16x16x32_bf16 v[164:167], v[228:231], v[132:135], v[164:167]
    s_cmp_eq_u32 s46, 0
    s_cbranch_scc1 NOST_9
    s_nop 7
    v_cvt_pk_bf16_f32 v232, v136, v137
    v_cvt_pk_bf16_f32 v233, v138, v139
    v_cvt_pk_bf16_f32 v234, v152, v153
    v_cvt_pk_bf16_f32 v235, v154, v155
    s_nop 1
    v_permlane16_swap_b32 v232, v234
    v_permlane16_swap_b32 v233, v235
    buffer_store_dwordx4 v[232:235], v10, s[16:19], s45 offen offset:0 sc1
    s_nop 1
    v_cvt_pk_bf16_f32 v236, v140, v141
    v_cvt_pk_bf16_f32 v237, v142, v143
    v_cvt_pk_bf16_f32 v238, v156, v157
    v_cvt_pk_bf16_f32 v239, v158, v159
    s_nop 1
    v_permlane16_swap_b32 v236, v238
    v_permlane16_swap_b32 v237, v239
    buffer_store_dwordx4 v[236:239], v10, s[16:19], s45 offen offset:1024 sc1
    s_nop 1
    v_cvt_pk_bf16_f32 v232, v144, v145
    v_cvt_pk_bf16_f32 v233, v146, v147
    v_cvt_pk_bf16_f32 v234, v160, v161
    v_cvt_pk_bf16_f32 v235, v162, v163
    s_nop 1
    v_permlane16_swap_b32 v232, v234
    v_permlane16_swap_b32 v233, v235
    buffer_store_dwordx4 v[232:235], v10, s[16:19], s45 offen offset:2048 sc1
    s_nop 1
    v_cvt_pk_bf16_f32 v236, v148, v149
    v_cvt_pk_bf16_f32 v237, v150, v151
    v_cvt_pk_bf16_f32 v238, v164, v165
    v_cvt_pk_bf16_f32 v239, v166, v167
    s_nop 1
    v_permlane16_swap_b32 v236, v238
    v_permlane16_swap_b32 v237, v239
    buffer_store_dwordx4 v[236:239], v10, s[16:19], s45 offen offset:3072 sc1
    s_nop 1
NOST_9:
    s_waitcnt vmcnt(0)
    s_barrier
    s_add_u32 s30, s29, 256
    s_mov_b32 s46, 1
    s_mov_b32 s47, 0x80008000
    ds_read_b64_tr_b16 v[104:105], v13 offset:0
    ds_read_b64_tr_b16 v[120:121], v13 offset:32768
    ds_read_b64_tr_b16 v[106:107], v13 offset:4096
    ds_read_b64_tr_b16 v[122:123], v13 offset:36864
    ds_read_b64_tr_b16 v[108:109], v13 offset:256
    ds_read_b64_tr_b16 v[124:125], v13 offset:33024
    ds_read_b64_tr_b16 v[110:111], v13 offset:4352
    ds_read_b64_tr_b16 v[126:127], v13 offset:37120
    ds_read_b64_tr_b16 v[112:113], v13 offset:512
    ds_read_b64_tr_b16 v[128:129], v13 offset:33280
    ds_read_b64_tr_b16 v[114:115], v13 offset:4608
    ds_read_b64_tr_b16 v[130:131], v13 offset:37376
    ds_read_b64_tr_b16 v[116:117], v13 offset:768
    ds_read_b64_tr_b16 v[132:133], v13 offset:33536
    ds_read_b64_tr_b16 v[118:119], v13 offset:4864
    ds_read_b64_tr_b16 v[134:135], v13 offset:37632
    s_lshl_b32 s45, s30, 12
    s_waitcnt lgkmcnt(0)
    v_mfma_f32_16x16x32_bf16 v[136:139], v[104:107], v[16:19], 0
    v_mfma_f32_16x16x32_bf16 v[168:171], v[104:107], v[24:27], 0
    v_mfma_f32_16x16x32_bf16 v[140:143], v[104:107], v[20:23], 0
    v_mfma_f32_16x16x32_bf16 v[172:175], v[104:107], v[28:31], 0
    v_mfma_f32_16x16x32_bf16 v[144:147], v[108:111], v[16:19], 0
    v_mfma_f32_16x16x32_bf16 v[176:179], v[108:111], v[24:27], 0
    v_mfma_f32_16x16x32_bf16 v[148:151], v[108:111], v[20:23], 0
    v_mfma_f32_16x16x32_bf16 v[180:183], v[108:111], v[28:31], 0
    v_mfma_f32_16x16x32_bf16 v[152:155], v[112:115], v[16:19], 0
    v_mfma_f32_16x16x32_bf16 v[184:187], v[112:115], v[24:27], 0
    v_mfma_f32_16x16x32_bf16 v[156:159], v[112:115], v[20:23], 0
    v_mfma_f32_16x16x32_bf16 v[188:191], v[112:115], v[28:31], 0
    v_mfma_f32_16x16x32_bf16 v[160:163], v[116:119], v[16:19], 0
    v_mfma_f32_16x16x32_bf16 v[192:195], v[116:119], v[24:27], 0
    v_mfma_f32_16x16x32_bf16 v[164:167], v[116:119], v[20:23], 0
    v_mfma_f32_16x16x32_bf16 v[196:199], v[116:119], v[28:31], 0
    v_mfma_f32_16x16x32_bf16 v[136:139], v[120:123], v[32:35], v[136:139]
    v_mfma_f32_16x16x32_bf16 v[168:171], v[120:123], v[16:19], v[168:171]
    v_mfma_f32_16x16x32_bf16 v[140:143], v[120:123], v[36:39], v[140:143]
    v_mfma_f32_16x16x32_bf16 v[172:175], v[120:123], v[20:23], v[172:175]
    v_mfma_f32_16x16x32_bf16 v[144:147], v[124:127], v[32:35], v[144:147]
    v_mfma_f32_16x16x32_bf16 v[176:179], v[124:127], v[16:19], v[176:179]
    v_mfma_f32_16x16x32_bf16 v[148:151], v[124:127], v[36:39], v[148:151]
    v_mfma_f32_16x16x32_bf16 v[180:183], v[124:127], v[20:23], v[180:183]
    v_mfma_f32_16x16x32_bf16 v[152:155], v[128:131], v[32:35], v[152:155]
    v_mfma_f32_16x16x32_bf16 v[184:187], v[128:131], v[16:19], v[184:187]
    v_mfma_f32_16x16x32_bf16 v[156:159], v[128:131], v[36:39], v[156:159]
    v_mfma_f32_16x16x32_bf16 v[188:191], v[128:131], v[20:23], v[188:191]
    v_mfma_f32_16x16x32_bf16 v[160:163], v[132:135], v[32:35], v[160:163]
    v_mfma_f32_16x16x32_bf16 v[192:195], v[132:135], v[16:19], v[192:195]
    v_mfma_f32_16x16x32_bf16 v[164:167], v[132:135], v[36:39], v[164:167]
    v_mfma_f32_16x16x32_bf16 v[196:199], v[132:135], v[20:23], v[196:199]
    s_nop 7
    ds_read_b128 v[104:107], v8 offset:0
    ds_read_b128 v[120:123], v8 offset:8192
    ds_read_b128 v[108:111], v8 offset:1024
    ds_read_b128 v[124:127], v8 offset:9216
    ds_read_b128 v[112:115], v8 offset:2048
    ds_read_b128 v[128:131], v8 offset:10240
    ds_read_b128 v[116:119], v8 offset:3072
    ds_read_b128 v[132:135], v8 offset:11264
    v_pk_mul_f32 v[232:233], v[168:169], v[72:73]
    v_pk_mul_f32 v[234:235], v[168:169], v[40:41]
    v_pk_fma_f32 v[168:169], v[136:137], v[72:73], v[234:235]
    v_pk_fma_f32 v[136:137], v[136:137], v[40:41], v[232:233] neg_lo:[0,0,1] neg_hi:[0,0,1]
    v_pk_mul_f32 v[232:233], v[170:171], v[74:75]
    v_pk_mul_f32 v[234:235], v[170:171], v[42:43]
    v_pk_fma_f32 v[170:171], v[138:139], v[74:75], v[234:235]
    v_pk_fma_f32 v[138:139], v[138:139], v[42:43], v[232:233] neg_lo:[0,0,1] neg_hi:[0,0,1]
    v_pk_mul_f32 v[232:233], v[172:173], v[76:77]
    v_pk_mul_f32 v[234:235], v[172:173], v[44:45]
    v_pk_fma_f32 v[172:173], v[140:141], v[76:77], v[234:235]
    v_pk_fma_f32 v[140:141], v[140:141], v[44:45], v[232:233] neg_lo:[0,0,1] neg_hi:[0,0,1]
    v_pk_mul_f32 v[232:233], v[174:175], v[78:79]
    v_pk_mul_f32 v[234:235], v[174:175], v[46:47]
    v_pk_fma_f32 v[174:175], v[142:143], v[78:79], v[234:235]
    v_pk_fma_f32 v[142:143], v[142:143], v[46:47], v[232:233] neg_lo:[0,0,1] neg_hi:[0,0,1]
    v_pk_mul_f32 v[232:233], v[176:177], v[80:81]
    v_pk_mul_f32 v[234:235], v[176:177], v[48:49]
    v_pk_fma_f32 v[176:177], v[144:145], v[80:81], v[234:235]
    v_pk_fma_f32 v[144:145], v[144:145], v[48:49], v[232:233] neg_lo:[0,0,1] neg_hi:[0,0,1]
    v_pk_mul_f32 v[232:233], v[178:179], v[82:83]
    v_pk_mul_f32 v[234:235], v[178:179], v[50:51]
    v_pk_fma_f32 v[178:179], v[146:147], v[82:83], v[234:235]
    v_pk_fma_f32 v[146:147], v[146:147], v[50:51], v[232:233] neg_lo:[0,0,1] neg_hi:[0,0,1]
    v_pk_mul_f32 v[232:233], v[180:181], v[84:85]
    v_pk_mul_f32 v[234:235], v[180:181], v[52:53]
    v_pk_fma_f32 v[180:181], v[148:149], v[84:85], v[234:235]
    v_pk_fma_f32 v[148:149], v[148:149], v[52:53], v[232:233] neg_lo:[0,0,1] neg_hi:[0,0,1]
    v_pk_mul_f32 v[232:233], v[182:183], v[86:87]
    v_pk_mul_f32 v[234:235], v[182:183], v[54:55]
    v_pk_fma_f32 v[182:183], v[150:151], v[86:87], v[234:235]
    v_pk_fma_f32 v[150:151], v[150:151], v[54:55], v[232:233] neg_lo:[0,0,1] neg_hi:[0,0,1]
    v_pk_mul_f32 v[232:233], v[184:185], v[88:89]
    v_pk_mul_f32 v[234:235], v[184:185], v[56:57]
    v_pk_fma_f32 v[184:185], v[152:153], v[88:89], v[234:235]
    v_pk_fma_f32 v[152:153], v[152:153], v[56:57], v[232:233] neg_lo:[0,0,1] neg_hi:[0,0,1]
    v_pk_mul_f32 v[232:233], v[186:187], v[90:91]
    v_pk_mul_f32 v[234:235], v[186:187], v[58:59]
    v_pk_fma_f32 v[186:187], v[154:155], v[90:91], v[234:235]
    v_pk_fma_f32 v[154:155], v[154:155], v[58:59], v[232:233] neg_lo:[0,0,1] neg_hi:[0,0,1]
    v_pk_mul_f32 v[232:233], v[188:189], v[92:93]
    v_pk_mul_f32 v[234:235], v[188:189], v[60:61]
    v_pk_fma_f32 v[188:189], v[156:157], v[92:93], v[234:235]
    v_pk_fma_f32 v[156:157], v[156:157], v[60:61], v[232:233] neg_lo:[0,0,1] neg_hi:[0,0,1]
    v_pk_mul_f32 v[232:233], v[190:191], v[94:95]
    v_pk_mul_f32 v[234:235], v[190:191], v[62:63]
    v_pk_fma_f32 v[190:191], v[158:159], v[94:95], v[234:235]
    v_pk_fma_f32 v[158:159], v[158:159], v[62:63], v[232:233] neg_lo:[0,0,1] neg_hi:[0,0,1]
    v_pk_mul_f32 v[232:233], v[192:193], v[96:97]
    v_pk_mul_f32 v[234:235], v[192:193], v[64:65]
    v_pk_fma_f32 v[192:193], v[160:161], v[96:97], v[234:235]
    v_pk_fma_f32 v[160:161], v[160:161], v[64:65], v[232:233] neg_lo:[0,0,1] neg_hi:[0,0,1]
    v_pk_mul_f32 v[232:233], v[194:195], v[98:99]
    v_pk_mul_f32 v[234:235], v[194:195], v[66:67]
    v_pk_fma_f32 v[194:195], v[162:163], v[98:99], v[234:235]
    v_pk_fma_f32 v[162:163], v[162:163], v[66:67], v[232:233] neg_lo:[0,0,1] neg_hi:[0,0,1]
    v_pk_mul_f32 v[232:233], v[196:197], v[100:101]
    v_pk_mul_f32 v[234:235], v[196:197], v[68:69]
    v_pk_fma_f32 v[196:197], v[164:165], v[100:101], v[234:235]
    v_pk_fma_f32 v[164:165], v[164:165], v[68:69], v[232:233] neg_lo:[0,0,1] neg_hi:[0,0,1]
    v_pk_mul_f32 v[232:233], v[198:199], v[102:103]
    v_pk_mul_f32 v[234:235], v[198:199], v[70:71]
    v_pk_fma_f32 v[198:199], v[166:167], v[102:103], v[234:235]
    v_pk_fma_f32 v[166:167], v[166:167], v[70:71], v[232:233] neg_lo:[0,0,1] neg_hi:[0,0,1]
    v_cvt_pk_bf16_f32 v200, v136, v137
    v_cvt_pk_bf16_f32 v216, v168, v169
    v_cvt_pk_bf16_f32 v201, v138, v139
    v_cvt_pk_bf16_f32 v217, v170, v171
    v_cvt_pk_bf16_f32 v202, v144, v145
    v_cvt_pk_bf16_f32 v218, v176, v177
    v_cvt_pk_bf16_f32 v203, v146, v147
    v_cvt_pk_bf16_f32 v219, v178, v179
    v_cvt_pk_bf16_f32 v204, v152, v153
    v_cvt_pk_bf16_f32 v220, v184, v185
    v_cvt_pk_bf16_f32 v205, v154, v155
    v_cvt_pk_bf16_f32 v221, v186, v187
    v_cvt_pk_bf16_f32 v206, v160, v161
    v_cvt_pk_bf16_f32 v222, v192, v193
    v_cvt_pk_bf16_f32 v207, v162, v163
    v_cvt_pk_bf16_f32 v223, v194, v195
    v_cvt_pk_bf16_f32 v208, v140, v141
    v_cvt_pk_bf16_f32 v224, v172, v173
    v_cvt_pk_bf16_f32 v209, v142, v143
    v_cvt_pk_bf16_f32 v225, v174, v175
    v_cvt_pk_bf16_f32 v210, v148, v149
    v_cvt_pk_bf16_f32 v226, v180, v181
    v_cvt_pk_bf16_f32 v211, v150, v151
    v_cvt_pk_bf16_f32 v227, v182, v183
    v_cvt_pk_bf16_f32 v212, v156, v157
    v_cvt_pk_bf16_f32 v228, v188, v189
    v_cvt_pk_bf16_f32 v213, v158, v159
    v_cvt_pk_bf16_f32 v229, v190, v191
    v_cvt_pk_bf16_f32 v214, v164, v165
    v_cvt_pk_bf16_f32 v230, v196, v197
    v_cvt_pk_bf16_f32 v215, v166, v167
    v_cvt_pk_bf16_f32 v231, v198, v199
    s_waitcnt lgkmcnt(0)
    s_nop 1
    v_mfma_f32_16x16x32_bf16 v[136:139], v[200:203], v[104:107], 0
    v_mfma_f32_16x16x32_bf16 v[136:139], v[216:219], v[120:123], v[136:139]
    v_mfma_f32_16x16x32_bf16 v[136:139], v[204:207], v[108:111], v[136:139]
    v_mfma_f32_16x16x32_bf16 v[136:139], v[220:223], v[124:127], v[136:139]
    v_mfma_f32_16x16x32_bf16 v[152:155], v[208:211], v[104:107], 0
    v_mfma_f32_16x16x32_bf16 v[152:155], v[224:227], v[120:123], v[152:155]
    v_mfma_f32_16x16x32_bf16 v[152:155], v[212:215], v[108:111], v[152:155]
    v_mfma_f32_16x16x32_bf16 v[152:155], v[228:231], v[124:127], v[152:155]
    v_mfma_f32_16x16x32_bf16 v[140:143], v[200:203], v[112:115], 0
    v_mfma_f32_16x16x32_bf16 v[140:143], v[216:219], v[128:131], v[140:143]
    v_mfma_f32_16x16x32_bf16 v[140:143], v[204:207], v[116:119], v[140:143]
    v_mfma_f32_16x16x32_bf16 v[140:143], v[220:223], v[132:135], v[140:143]
    v_mfma_f32_16x16x32_bf16 v[156:159], v[208:211], v[112:115], 0
    v_mfma_f32_16x16x32_bf16 v[156:159], v[224:227], v[128:131], v[156:159]
    v_mfma_f32_16x16x32_bf16 v[156:159], v[212:215], v[116:119], v[156:159]
    v_mfma_f32_16x16x32_bf16 v[156:159], v[228:231], v[132:135], v[156:159]
    ds_read_b128 v[104:107], v8 offset:4096
    ds_read_b128 v[120:123], v8 offset:12288
    ds_read_b128 v[108:111], v8 offset:5120
    ds_read_b128 v[124:127], v8 offset:13312
    ds_read_b128 v[112:115], v8 offset:6144
    ds_read_b128 v[128:131], v8 offset:14336
    ds_read_b128 v[116:119], v8 offset:7168
    ds_read_b128 v[132:135], v8 offset:15360
    s_waitcnt lgkmcnt(0)
    s_nop 1
    v_mfma_f32_16x16x32_bf16 v[144:147], v[200:203], v[104:107], 0
    v_mfma_f32_16x16x32_bf16 v[144:147], v[216:219], v[120:123], v[144:147]
    v_mfma_f32_16x16x32_bf16 v[144:147], v[204:207], v[108:111], v[144:147]
    v_mfma_f32_16x16x32_bf16 v[144:147], v[220:223], v[124:127], v[144:147]
    v_mfma_f32_16x16x32_bf16 v[160:163], v[208:211], v[104:107], 0
    v_mfma_f32_16x16x32_bf16 v[160:163], v[224:227], v[120:123], v[160:163]
    v_mfma_f32_16x16x32_bf16 v[160:163], v[212:215], v[108:111], v[160:163]
    v_mfma_f32_16x16x32_bf16 v[160:163], v[228:231], v[124:127], v[160:163]
    v_mfma_f32_16x16x32_bf16 v[148:151], v[200:203], v[112:115], 0
    v_mfma_f32_16x16x32_bf16 v[148:151], v[216:219], v[128:131], v[148:151]
    v_mfma_f32_16x16x32_bf16 v[148:151], v[204:207], v[116:119], v[148:151]
    v_mfma_f32_16x16x32_bf16 v[148:151], v[220:223], v[132:135], v[148:151]
    v_mfma_f32_16x16x32_bf16 v[164:167], v[208:211], v[112:115], 0
    v_mfma_f32_16x16x32_bf16 v[164:167], v[224:227], v[128:131], v[164:167]
    v_mfma_f32_16x16x32_bf16 v[164:167], v[212:215], v[116:119], v[164:167]
    v_mfma_f32_16x16x32_bf16 v[164:167], v[228:231], v[132:135], v[164:167]
    s_cmp_eq_u32 s46, 0
    s_cbranch_scc1 NOST_10
    s_nop 7
    v_cvt_pk_bf16_f32 v232, v136, v137
    v_cvt_pk_bf16_f32 v233, v138, v139
    v_cvt_pk_bf16_f32 v234, v152, v153
    v_cvt_pk_bf16_f32 v235, v154, v155
    s_nop 1
    v_permlane16_swap_b32 v232, v234
    v_permlane16_swap_b32 v233, v235
    buffer_store_dwordx4 v[232:235], v10, s[16:19], s45 offen offset:0 sc1
    s_nop 1
    v_cvt_pk_bf16_f32 v236, v140, v141
    v_cvt_pk_bf16_f32 v237, v142, v143
    v_cvt_pk_bf16_f32 v238, v156, v157
    v_cvt_pk_bf16_f32 v239, v158, v159
    s_nop 1
    v_permlane16_swap_b32 v236, v238
    v_permlane16_swap_b32 v237, v239
    buffer_store_dwordx4 v[236:239], v10, s[16:19], s45 offen offset:1024 sc1
    s_nop 1
    v_cvt_pk_bf16_f32 v232, v144, v145
    v_cvt_pk_bf16_f32 v233, v146, v147
    v_cvt_pk_bf16_f32 v234, v160, v161
    v_cvt_pk_bf16_f32 v235, v162, v163
    s_nop 1
    v_permlane16_swap_b32 v232, v234
    v_permlane16_swap_b32 v233, v235
    buffer_store_dwordx4 v[232:235], v10, s[16:19], s45 offen offset:2048 sc1
    s_nop 1
    v_cvt_pk_bf16_f32 v236, v148, v149
    v_cvt_pk_bf16_f32 v237, v150, v151
    v_cvt_pk_bf16_f32 v238, v164, v165
    v_cvt_pk_bf16_f32 v239, v166, v167
    s_nop 1
    v_permlane16_swap_b32 v236, v238
    v_permlane16_swap_b32 v237, v239
    buffer_store_dwordx4 v[236:239], v10, s[16:19], s45 offen offset:3072 sc1
    s_nop 1
NOST_10:
    s_sub_u32 s30, 1024, s30
    s_cmp_lg_u32 s30, 1024
    s_cselect_b32 s46, 1, 0
    ds_read_b64_tr_b16 v[104:105], v13 offset:0
    ds_read_b64_tr_b16 v[120:121], v13 offset:32768
    ds_read_b64_tr_b16 v[106:107], v13 offset:4096
    ds_read_b64_tr_b16 v[122:123], v13 offset:36864
    ds_read_b64_tr_b16 v[108:109], v13 offset:256
    ds_read_b64_tr_b16 v[124:125], v13 offset:33024
    ds_read_b64_tr_b16 v[110:111], v13 offset:4352
    ds_read_b64_tr_b16 v[126:127], v13 offset:37120
    ds_read_b64_tr_b16 v[112:113], v13 offset:512
    ds_read_b64_tr_b16 v[128:129], v13 offset:33280
    ds_read_b64_tr_b16 v[114:115], v13 offset:4608
    ds_read_b64_tr_b16 v[130:131], v13 offset:37376
    ds_read_b64_tr_b16 v[116:117], v13 offset:768
    ds_read_b64_tr_b16 v[132:133], v13 offset:33536
    ds_read_b64_tr_b16 v[118:119], v13 offset:4864
    ds_read_b64_tr_b16 v[134:135], v13 offset:37632
    s_lshl_b32 s45, s30, 12
    s_waitcnt lgkmcnt(0)
    v_xor_b32 v120, s47, v120
    v_xor_b32 v121, s47, v121
    v_xor_b32 v122, s47, v122
    v_xor_b32 v123, s47, v123
    v_xor_b32 v124, s47, v124
    v_xor_b32 v125, s47, v125
    v_xor_b32 v126, s47, v126
    v_xor_b32 v127, s47, v127
    v_xor_b32 v128, s47, v128
    v_xor_b32 v129, s47, v129
    v_xor_b32 v130, s47, v130
    v_xor_b32 v131, s47, v131
    v_xor_b32 v132, s47, v132
    v_xor_b32 v133, s47, v133
    v_xor_b32 v134, s47, v134
    v_xor_b32 v135, s47, v135
    s_nop 1
    v_mfma_f32_16x16x32_bf16 v[136:139], v[104:107], v[16:19], 0
    v_mfma_f32_16x16x32_bf16 v[168:171], v[104:107], v[24:27], 0
    v_mfma_f32_16x16x32_bf16 v[140:143], v[104:107], v[20:23], 0
    v_mfma_f32_16x16x32_bf16 v[172:175], v[104:107], v[28:31], 0
    v_mfma_f32_16x16x32_bf16 v[144:147], v[108:111], v[16:19], 0
    v_mfma_f32_16x16x32_bf16 v[176:179], v[108:111], v[24:27], 0
    v_mfma_f32_16x16x32_bf16 v[148:151], v[108:111], v[20:23], 0
    v_mfma_f32_16x16x32_bf16 v[180:183], v[108:111], v[28:31], 0
    v_mfma_f32_16x16x32_bf16 v[152:155], v[112:115], v[16:19], 0
    v_mfma_f32_16x16x32_bf16 v[184:187], v[112:115], v[24:27], 0
    v_mfma_f32_16x16x32_bf16 v[156:159], v[112:115], v[20:23], 0
    v_mfma_f32_16x16x32_bf16 v[188:191], v[112:115], v[28:31], 0
    v_mfma_f32_16x16x32_bf16 v[160:163], v[116:119], v[16:19], 0
    v_mfma_f32_16x16x32_bf16 v[192:195], v[116:119], v[24:27], 0
    v_mfma_f32_16x16x32_bf16 v[164:167], v[116:119], v[20:23], 0
    v_mfma_f32_16x16x32_bf16 v[196:199], v[116:119], v[28:31], 0
    v_mfma_f32_16x16x32_bf16 v[136:139], v[120:123], v[32:35], v[136:139]
    v_mfma_f32_16x16x32_bf16 v[168:171], v[120:123], v[16:19], v[168:171]
    v_mfma_f32_16x16x32_bf16 v[140:143], v[120:123], v[36:39], v[140:143]
    v_mfma_f32_16x16x32_bf16 v[172:175], v[120:123], v[20:23], v[172:175]
    v_mfma_f32_16x16x32_bf16 v[144:147], v[124:127], v[32:35], v[144:147]
    v_mfma_f32_16x16x32_bf16 v[176:179], v[124:127], v[16:19], v[176:179]
    v_mfma_f32_16x16x32_bf16 v[148:151], v[124:127], v[36:39], v[148:151]
    v_mfma_f32_16x16x32_bf16 v[180:183], v[124:127], v[20:23], v[180:183]
    v_mfma_f32_16x16x32_bf16 v[152:155], v[128:131], v[32:35], v[152:155]
    v_mfma_f32_16x16x32_bf16 v[184:187], v[128:131], v[16:19], v[184:187]
    v_mfma_f32_16x16x32_bf16 v[156:159], v[128:131], v[36:39], v[156:159]
    v_mfma_f32_16x16x32_bf16 v[188:191], v[128:131], v[20:23], v[188:191]
    v_mfma_f32_16x16x32_bf16 v[160:163], v[132:135], v[32:35], v[160:163]
    v_mfma_f32_16x16x32_bf16 v[192:195], v[132:135], v[16:19], v[192:195]
    v_mfma_f32_16x16x32_bf16 v[164:167], v[132:135], v[36:39], v[164:167]
    v_mfma_f32_16x16x32_bf16 v[196:199], v[132:135], v[20:23], v[196:199]
    s_nop 7
    ds_read_b128 v[104:107], v8 offset:0
    ds_read_b128 v[120:123], v8 offset:8192
    ds_read_b128 v[108:111], v8 offset:1024
    ds_read_b128 v[124:127], v8 offset:9216
    ds_read_b128 v[112:115], v8 offset:2048
    ds_read_b128 v[128:131], v8 offset:10240
    ds_read_b128 v[116:119], v8 offset:3072
    ds_read_b128 v[132:135], v8 offset:11264
    v_pk_mul_f32 v[232:233], v[168:169], v[72:73]
    v_pk_mul_f32 v[234:235], v[168:169], v[40:41]
    v_pk_fma_f32 v[168:169], v[136:137], v[72:73], v[234:235]
    v_pk_fma_f32 v[136:137], v[136:137], v[40:41], v[232:233] neg_lo:[0,0,1] neg_hi:[0,0,1]
    v_pk_mul_f32 v[232:233], v[170:171], v[74:75]
    v_pk_mul_f32 v[234:235], v[170:171], v[42:43]
    v_pk_fma_f32 v[170:171], v[138:139], v[74:75], v[234:235]
    v_pk_fma_f32 v[138:139], v[138:139], v[42:43], v[232:233] neg_lo:[0,0,1] neg_hi:[0,0,1]
    v_pk_mul_f32 v[232:233], v[172:173], v[76:77]
    v_pk_mul_f32 v[234:235], v[172:173], v[44:45]
    v_pk_fma_f32 v[172:173], v[140:141], v[76:77], v[234:235]
    v_pk_fma_f32 v[140:141], v[140:141], v[44:45], v[232:233] neg_lo:[0,0,1] neg_hi:[0,0,1]
    v_pk_mul_f32 v[232:233], v[174:175], v[78:79]
    v_pk_mul_f32 v[234:235], v[174:175], v[46:47]
    v_pk_fma_f32 v[174:175], v[142:143], v[78:79], v[234:235]
    v_pk_fma_f32 v[142:143], v[142:143], v[46:47], v[232:233] neg_lo:[0,0,1] neg_hi:[0,0,1]
    v_pk_mul_f32 v[232:233], v[176:177], v[80:81]
    v_pk_mul_f32 v[234:235], v[176:177], v[48:49]
    v_pk_fma_f32 v[176:177], v[144:145], v[80:81], v[234:235]
    v_pk_fma_f32 v[144:145], v[144:145], v[48:49], v[232:233] neg_lo:[0,0,1] neg_hi:[0,0,1]
    v_pk_mul_f32 v[232:233], v[178:179], v[82:83]
    v_pk_mul_f32 v[234:235], v[178:179], v[50:51]
    v_pk_fma_f32 v[178:179], v[146:147], v[82:83], v[234:235]
    v_pk_fma_f32 v[146:147], v[146:147], v[50:51], v[232:233] neg_lo:[0,0,1] neg_hi:[0,0,1]
    v_pk_mul_f32 v[232:233], v[180:181], v[84:85]
    v_pk_mul_f32 v[234:235], v[180:181], v[52:53]
    v_pk_fma_f32 v[180:181], v[148:149], v[84:85], v[234:235]
    v_pk_fma_f32 v[148:149], v[148:149], v[52:53], v[232:233] neg_lo:[0,0,1] neg_hi:[0,0,1]
    v_pk_mul_f32 v[232:233], v[182:183], v[86:87]
    v_pk_mul_f32 v[234:235], v[182:183], v[54:55]
    v_pk_fma_f32 v[182:183], v[150:151], v[86:87], v[234:235]
    v_pk_fma_f32 v[150:151], v[150:151], v[54:55], v[232:233] neg_lo:[0,0,1] neg_hi:[0,0,1]
    v_pk_mul_f32 v[232:233], v[184:185], v[88:89]
    v_pk_mul_f32 v[234:235], v[184:185], v[56:57]
    v_pk_fma_f32 v[184:185], v[152:153], v[88:89], v[234:235]
    v_pk_fma_f32 v[152:153], v[152:153], v[56:57], v[232:233] neg_lo:[0,0,1] neg_hi:[0,0,1]
    v_pk_mul_f32 v[232:233], v[186:187], v[90:91]
    v_pk_mul_f32 v[234:235], v[186:187], v[58:59]
    v_pk_fma_f32 v[186:187], v[154:155], v[90:91], v[234:235]
    v_pk_fma_f32 v[154:155], v[154:155], v[58:59], v[232:233] neg_lo:[0,0,1] neg_hi:[0,0,1]
    v_pk_mul_f32 v[232:233], v[188:189], v[92:93]
    v_pk_mul_f32 v[234:235], v[188:189], v[60:61]
    v_pk_fma_f32 v[188:189], v[156:157], v[92:93], v[234:235]
    v_pk_fma_f32 v[156:157], v[156:157], v[60:61], v[232:233] neg_lo:[0,0,1] neg_hi:[0,0,1]
    v_pk_mul_f32 v[232:233], v[190:191], v[94:95]
    v_pk_mul_f32 v[234:235], v[190:191], v[62:63]
    v_pk_fma_f32 v[190:191], v[158:159], v[94:95], v[234:235]
    v_pk_fma_f32 v[158:159], v[158:159], v[62:63], v[232:233] neg_lo:[0,0,1] neg_hi:[0,0,1]
    v_pk_mul_f32 v[232:233], v[192:193], v[96:97]
    v_pk_mul_f32 v[234:235], v[192:193], v[64:65]
    v_pk_fma_f32 v[192:193], v[160:161], v[96:97], v[234:235]
    v_pk_fma_f32 v[160:161], v[160:161], v[64:65], v[232:233] neg_lo:[0,0,1] neg_hi:[0,0,1]
    v_pk_mul_f32 v[232:233], v[194:195], v[98:99]
    v_pk_mul_f32 v[234:235], v[194:195], v[66:67]
    v_pk_fma_f32 v[194:195], v[162:163], v[98:99], v[234:235]
    v_pk_fma_f32 v[162:163], v[162:163], v[66:67], v[232:233] neg_lo:[0,0,1] neg_hi:[0,0,1]
    v_pk_mul_f32 v[232:233], v[196:197], v[100:101]
    v_pk_mul_f32 v[234:235], v[196:197], v[68:69]
    v_pk_fma_f32 v[196:197], v[164:165], v[100:101], v[234:235]
    v_pk_fma_f32 v[164:165], v[164:165], v[68:69], v[232:233] neg_lo:[0,0,1] neg_hi:[0,0,1]
    v_pk_mul_f32 v[232:233], v[198:199], v[102:103]
    v_pk_mul_f32 v[234:235], v[198:199], v[70:71]
    v_pk_fma_f32 v[198:199], v[166:167], v[102:103], v[234:235]
    v_pk_fma_f32 v[166:167], v[166:167], v[70:71], v[232:233] neg_lo:[0,0,1] neg_hi:[0,0,1]
    v_cvt_pk_bf16_f32 v200, v136, v137
    v_cvt_pk_bf16_f32 v216, v168, v169
    v_cvt_pk_bf16_f32 v201, v138, v139
    v_cvt_pk_bf16_f32 v217, v170, v171
    v_cvt_pk_bf16_f32 v202, v144, v145
    v_cvt_pk_bf16_f32 v218, v176, v177
    v_cvt_pk_bf16_f32 v203, v146, v147
    v_cvt_pk_bf16_f32 v219, v178, v179
    v_cvt_pk_bf16_f32 v204, v152, v153
    v_cvt_pk_bf16_f32 v220, v184, v185
    v_cvt_pk_bf16_f32 v205, v154, v155
    v_cvt_pk_bf16_f32 v221, v186, v187
    v_cvt_pk_bf16_f32 v206, v160, v161
    v_cvt_pk_bf16_f32 v222, v192, v193
    v_cvt_pk_bf16_f32 v207, v162, v163
    v_cvt_pk_bf16_f32 v223, v194, v195
    v_cvt_pk_bf16_f32 v208, v140, v141
    v_cvt_pk_bf16_f32 v224, v172, v173
    v_cvt_pk_bf16_f32 v209, v142, v143
    v_cvt_pk_bf16_f32 v225, v174, v175
    v_cvt_pk_bf16_f32 v210, v148, v149
    v_cvt_pk_bf16_f32 v226, v180, v181
    v_cvt_pk_bf16_f32 v211, v150, v151
    v_cvt_pk_bf16_f32 v227, v182, v183
    v_cvt_pk_bf16_f32 v212, v156, v157
    v_cvt_pk_bf16_f32 v228, v188, v189
    v_cvt_pk_bf16_f32 v213, v158, v159
    v_cvt_pk_bf16_f32 v229, v190, v191
    v_cvt_pk_bf16_f32 v214, v164, v165
    v_cvt_pk_bf16_f32 v230, v196, v197
    v_cvt_pk_bf16_f32 v215, v166, v167
    v_cvt_pk_bf16_f32 v231, v198, v199
    s_waitcnt lgkmcnt(0)
    s_nop 1
    v_mfma_f32_16x16x32_bf16 v[136:139], v[200:203], v[104:107], 0
    v_mfma_f32_16x16x32_bf16 v[136:139], v[216:219], v[120:123], v[136:139]
    v_mfma_f32_16x16x32_bf16 v[136:139], v[204:207], v[108:111], v[136:139]
    v_mfma_f32_16x16x32_bf16 v[136:139], v[220:223], v[124:127], v[136:139]
    v_mfma_f32_16x16x32_bf16 v[152:155], v[208:211], v[104:107], 0
    v_mfma_f32_16x16x32_bf16 v[152:155], v[224:227], v[120:123], v[152:155]
    v_mfma_f32_16x16x32_bf16 v[152:155], v[212:215], v[108:111], v[152:155]
    v_mfma_f32_16x16x32_bf16 v[152:155], v[228:231], v[124:127], v[152:155]
    v_mfma_f32_16x16x32_bf16 v[140:143], v[200:203], v[112:115], 0
    v_mfma_f32_16x16x32_bf16 v[140:143], v[216:219], v[128:131], v[140:143]
    v_mfma_f32_16x16x32_bf16 v[140:143], v[204:207], v[116:119], v[140:143]
    v_mfma_f32_16x16x32_bf16 v[140:143], v[220:223], v[132:135], v[140:143]
    v_mfma_f32_16x16x32_bf16 v[156:159], v[208:211], v[112:115], 0
    v_mfma_f32_16x16x32_bf16 v[156:159], v[224:227], v[128:131], v[156:159]
    v_mfma_f32_16x16x32_bf16 v[156:159], v[212:215], v[116:119], v[156:159]
    v_mfma_f32_16x16x32_bf16 v[156:159], v[228:231], v[132:135], v[156:159]
    ds_read_b128 v[104:107], v8 offset:4096
    ds_read_b128 v[120:123], v8 offset:12288
    ds_read_b128 v[108:111], v8 offset:5120
    ds_read_b128 v[124:127], v8 offset:13312
    ds_read_b128 v[112:115], v8 offset:6144
    ds_read_b128 v[128:131], v8 offset:14336
    ds_read_b128 v[116:119], v8 offset:7168
    ds_read_b128 v[132:135], v8 offset:15360
    s_waitcnt lgkmcnt(0)
    s_nop 1
    v_mfma_f32_16x16x32_bf16 v[144:147], v[200:203], v[104:107], 0
    v_mfma_f32_16x16x32_bf16 v[144:147], v[216:219], v[120:123], v[144:147]
    v_mfma_f32_16x16x32_bf16 v[144:147], v[204:207], v[108:111], v[144:147]
    v_mfma_f32_16x16x32_bf16 v[144:147], v[220:223], v[124:127], v[144:147]
    v_mfma_f32_16x16x32_bf16 v[160:163], v[208:211], v[104:107], 0
    v_mfma_f32_16x16x32_bf16 v[160:163], v[224:227], v[120:123], v[160:163]
    v_mfma_f32_16x16x32_bf16 v[160:163], v[212:215], v[108:111], v[160:163]
    v_mfma_f32_16x16x32_bf16 v[160:163], v[228:231], v[124:127], v[160:163]
    v_mfma_f32_16x16x32_bf16 v[148:151], v[200:203], v[112:115], 0
    v_mfma_f32_16x16x32_bf16 v[148:151], v[216:219], v[128:131], v[148:151]
    v_mfma_f32_16x16x32_bf16 v[148:151], v[204:207], v[116:119], v[148:151]
    v_mfma_f32_16x16x32_bf16 v[148:151], v[220:223], v[132:135], v[148:151]
    v_mfma_f32_16x16x32_bf16 v[164:167], v[208:211], v[112:115], 0
    v_mfma_f32_16x16x32_bf16 v[164:167], v[224:227], v[128:131], v[164:167]
    v_mfma_f32_16x16x32_bf16 v[164:167], v[212:215], v[116:119], v[164:167]
    v_mfma_f32_16x16x32_bf16 v[164:167], v[228:231], v[132:135], v[164:167]
    s_cmp_eq_u32 s46, 0
    s_cbranch_scc1 NOST_11
    s_nop 7
    v_cvt_pk_bf16_f32 v232, v136, v137
    v_cvt_pk_bf16_f32 v233, v138, v139
    v_cvt_pk_bf16_f32 v234, v152, v153
    v_cvt_pk_bf16_f32 v235, v154, v155
    s_nop 1
    v_permlane16_swap_b32 v232, v234
    v_permlane16_swap_b32 v233, v235
    buffer_store_dwordx4 v[232:235], v10, s[16:19], s45 offen offset:0 sc1
    s_nop 1
    v_cvt_pk_bf16_f32 v236, v140, v141
    v_cvt_pk_bf16_f32 v237, v142, v143
    v_cvt_pk_bf16_f32 v238, v156, v157
    v_cvt_pk_bf16_f32 v239, v158, v159
    s_nop 1
    v_permlane16_swap_b32 v236, v238
    v_permlane16_swap_b32 v237, v239
    buffer_store_dwordx4 v[236:239], v10, s[16:19], s45 offen offset:1024 sc1
    s_nop 1
    v_cvt_pk_bf16_f32 v232, v144, v145
    v_cvt_pk_bf16_f32 v233, v146, v147
    v_cvt_pk_bf16_f32 v234, v160, v161
    v_cvt_pk_bf16_f32 v235, v162, v163
    s_nop 1
    v_permlane16_swap_b32 v232, v234
    v_permlane16_swap_b32 v233, v235
    buffer_store_dwordx4 v[232:235], v10, s[16:19], s45 offen offset:2048 sc1
    s_nop 1
    v_cvt_pk_bf16_f32 v236, v148, v149
    v_cvt_pk_bf16_f32 v237, v150, v151
    v_cvt_pk_bf16_f32 v238, v164, v165
    v_cvt_pk_bf16_f32 v239, v166, v167
    s_nop 1
    v_permlane16_swap_b32 v236, v238
    v_permlane16_swap_b32 v237, v239
    buffer_store_dwordx4 v[236:239], v10, s[16:19], s45 offen offset:3072 sc1
    s_nop 1
NOST_11:
    s_cmp_lg_u32 s2, 224
    s_cbranch_scc1 C512_12
    s_barrier
    s_mov_b32 s34, 8192
    s_add_u32 m0, s36, 0
    s_add_u32 s39, s33, s34
    s_add_u32 s39, s39, 0
    buffer_load_dwordx4 v6, s[12:15], s39 offen lds
    s_add_u32 m0, s36, 8192
    s_add_u32 s39, s33, s34
    s_add_u32 s39, s39, 1064960
    buffer_load_dwordx4 v7, s[12:15], s39 offen lds
    s_add_u32 m0, s36, 16384
    s_add_u32 s39, s33, s34
    s_add_u32 s39, s39, 2129920
    buffer_load_dwordx4 v6, s[12:15], s39 offen lds
    s_add_u32 m0, s36, 24576
    s_add_u32 s39, s33, s34
    s_add_u32 s39, s39, 3194880
    buffer_load_dwordx4 v7, s[12:15], s39 offen lds
    s_add_u32 m0, s36, 32768
    s_add_u32 s39, s33, s34
    s_add_u32 s39, s39, 8320
    buffer_load_dwordx4 v6, s[12:15], s39 offen lds
    s_add_u32 m0, s36, 40960
    s_add_u32 s39, s33, s34
    s_add_u32 s39, s39, 1073280
    buffer_load_dwordx4 v7, s[12:15], s39 offen lds
    s_add_u32 m0, s36, 49152
    s_add_u32 s39, s33, s34
    s_add_u32 s39, s39, 2138240
    buffer_load_dwordx4 v6, s[12:15], s39 offen lds
    s_add_u32 m0, s36, 57344
    s_add_u32 s39, s33, s34
    s_add_u32 s39, s39, 3203200
    buffer_load_dwordx4 v7, s[12:15], s39 offen lds
    s_waitcnt vmcnt(0)
    s_barrier
    s_mov_b32 s30, 512
    s_cmp_eq_u32 s96, 0
    s_cselect_b32 s46, 1, 0
    ds_read_b64_tr_b16 v[104:105], v12 offset:0
    ds_read_b64_tr_b16 v[120:121], v12 offset:32768
    ds_read_b64_tr_b16 v[106:107], v12 offset:4096
    ds_read_b64_tr_b16 v[122:123], v12 offset:36864
    ds_read_b64_tr_b16 v[108:109], v12 offset:256
    ds_read_b64_tr_b16 v[124:125], v12 offset:33024
    ds_read_b64_tr_b16 v[110:111], v12 offset:4352
    ds_read_b64_tr_b16 v[126:127], v12 offset:37120
    ds_read_b64_tr_b16 v[112:113], v12 offset:512
    ds_read_b64_tr_b16 v[128:129], v12 offset:33280
    ds_read_b64_tr_b16 v[114:115], v12 offset:4608
    ds_read_b64_tr_b16 v[130:131], v12 offset:37376
    ds_read_b64_tr_b16 v[116:117], v12 offset:768
    ds_read_b64_tr_b16 v[132:133], v12 offset:33536
    ds_read_b64_tr_b16 v[118:119], v12 offset:4864
    ds_read_b64_tr_b16 v[134:135], v12 offset:37632
    s_lshl_b32 s45, s30, 12
    s_waitcnt lgkmcnt(0)
    v_mfma_f32_16x16x32_bf16 v[136:139], v[104:107], v[16:19], 0
    v_mfma_f32_16x16x32_bf16 v[168:171], v[104:107], v[24:27], 0
    v_mfma_f32_16x16x32_bf16 v[140:143], v[104:107], v[20:23], 0
    v_mfma_f32_16x16x32_bf16 v[172:175], v[104:107], v[28:31], 0
    v_mfma_f32_16x16x32_bf16 v[144:147], v[108:111], v[16:19], 0
    v_mfma_f32_16x16x32_bf16 v[176:179], v[108:111], v[24:27], 0
    v_mfma_f32_16x16x32_bf16 v[148:151], v[108:111], v[20:23], 0
    v_mfma_f32_16x16x32_bf16 v[180:183], v[108:111], v[28:31], 0
    v_mfma_f32_16x16x32_bf16 v[152:155], v[112:115], v[16:19], 0
    v_mfma_f32_16x16x32_bf16 v[184:187], v[112:115], v[24:27], 0
    v_mfma_f32_16x16x32_bf16 v[156:159], v[112:115], v[20:23], 0
    v_mfma_f32_16x16x32_bf16 v[188:191], v[112:115], v[28:31], 0
    v_mfma_f32_16x16x32_bf16 v[160:163], v[116:119], v[16:19], 0
    v_mfma_f32_16x16x32_bf16 v[192:195], v[116:119], v[24:27], 0
    v_mfma_f32_16x16x32_bf16 v[164:167], v[116:119], v[20:23], 0
    v_mfma_f32_16x16x32_bf16 v[196:199], v[116:119], v[28:31], 0
    v_mfma_f32_16x16x32_bf16 v[136:139], v[120:123], v[32:35], v[136:139]
    v_mfma_f32_16x16x32_bf16 v[168:171], v[120:123], v[16:19], v[168:171]
    v_mfma_f32_16x16x32_bf16 v[140:143], v[120:123], v[36:39], v[140:143]
    v_mfma_f32_16x16x32_bf16 v[172:175], v[120:123], v[20:23], v[172:175]
    v_mfma_f32_16x16x32_bf16 v[144:147], v[124:127], v[32:35], v[144:147]
    v_mfma_f32_16x16x32_bf16 v[176:179], v[124:127], v[16:19], v[176:179]
    v_mfma_f32_16x16x32_bf16 v[148:151], v[124:127], v[36:39], v[148:151]
    v_mfma_f32_16x16x32_bf16 v[180:183], v[124:127], v[20:23], v[180:183]
    v_mfma_f32_16x16x32_bf16 v[152:155], v[128:131], v[32:35], v[152:155]
    v_mfma_f32_16x16x32_bf16 v[184:187], v[128:131], v[16:19], v[184:187]
    v_mfma_f32_16x16x32_bf16 v[156:159], v[128:131], v[36:39], v[156:159]
    v_mfma_f32_16x16x32_bf16 v[188:191], v[128:131], v[20:23], v[188:191]
    v_mfma_f32_16x16x32_bf16 v[160:163], v[132:135], v[32:35], v[160:163]
    v_mfma_f32_16x16x32_bf16 v[192:195], v[132:135], v[16:19], v[192:195]
    v_mfma_f32_16x16x32_bf16 v[164:167], v[132:135], v[36:39], v[164:167]
    v_mfma_f32_16x16x32_bf16 v[196:199], v[132:135], v[20:23], v[196:199]
    s_nop 7
    ds_read_b128 v[104:107], v8 offset:0
    ds_read_b128 v[120:123], v8 offset:8192
    ds_read_b128 v[108:111], v8 offset:1024
    ds_read_b128 v[124:127], v8 offset:9216
    ds_read_b128 v[112:115], v8 offset:2048
    ds_read_b128 v[128:131], v8 offset:10240
    ds_read_b128 v[116:119], v8 offset:3072
    ds_read_b128 v[132:135], v8 offset:11264
    v_pk_mul_f32 v[232:233], v[168:169], v[72:73]
    v_pk_mul_f32 v[234:235], v[168:169], v[40:41]
    v_pk_fma_f32 v[168:169], v[136:137], v[72:73], v[234:235]
    v_pk_fma_f32 v[136:137], v[136:137], v[40:41], v[232:233] neg_lo:[0,0,1] neg_hi:[0,0,1]
    v_pk_mul_f32 v[232:233], v[170:171], v[74:75]
    v_pk_mul_f32 v[234:235], v[170:171], v[42:43]
    v_pk_fma_f32 v[170:171], v[138:139], v[74:75], v[234:235]
    v_pk_fma_f32 v[138:139], v[138:139], v[42:43], v[232:233] neg_lo:[0,0,1] neg_hi:[0,0,1]
    v_pk_mul_f32 v[232:233], v[172:173], v[76:77]
    v_pk_mul_f32 v[234:235], v[172:173], v[44:45]
    v_pk_fma_f32 v[172:173], v[140:141], v[76:77], v[234:235]
    v_pk_fma_f32 v[140:141], v[140:141], v[44:45], v[232:233] neg_lo:[0,0,1] neg_hi:[0,0,1]
    v_pk_mul_f32 v[232:233], v[174:175], v[78:79]
    v_pk_mul_f32 v[234:235], v[174:175], v[46:47]
    v_pk_fma_f32 v[174:175], v[142:143], v[78:79], v[234:235]
    v_pk_fma_f32 v[142:143], v[142:143], v[46:47], v[232:233] neg_lo:[0,0,1] neg_hi:[0,0,1]
    v_pk_mul_f32 v[232:233], v[176:177], v[80:81]
    v_pk_mul_f32 v[234:235], v[176:177], v[48:49]
    v_pk_fma_f32 v[176:177], v[144:145], v[80:81], v[234:235]
    v_pk_fma_f32 v[144:145], v[144:145], v[48:49], v[232:233] neg_lo:[0,0,1] neg_hi:[0,0,1]
    v_pk_mul_f32 v[232:233], v[178:179], v[82:83]
    v_pk_mul_f32 v[234:235], v[178:179], v[50:51]
    v_pk_fma_f32 v[178:179], v[146:147], v[82:83], v[234:235]
    v_pk_fma_f32 v[146:147], v[146:147], v[50:51], v[232:233] neg_lo:[0,0,1] neg_hi:[0,0,1]
    v_pk_mul_f32 v[232:233], v[180:181], v[84:85]
    v_pk_mul_f32 v[234:235], v[180:181], v[52:53]
    v_pk_fma_f32 v[180:181], v[148:149], v[84:85], v[234:235]
    v_pk_fma_f32 v[148:149], v[148:149], v[52:53], v[232:233] neg_lo:[0,0,1] neg_hi:[0,0,1]
    v_pk_mul_f32 v[232:233], v[182:183], v[86:87]
    v_pk_mul_f32 v[234:235], v[182:183], v[54:55]
    v_pk_fma_f32 v[182:183], v[150:151], v[86:87], v[234:235]
    v_pk_fma_f32 v[150:151], v[150:151], v[54:55], v[232:233] neg_lo:[0,0,1] neg_hi:[0,0,1]
    v_pk_mul_f32 v[232:233], v[184:185], v[88:89]
    v_pk_mul_f32 v[234:235], v[184:185], v[56:57]
    v_pk_fma_f32 v[184:185], v[152:153], v[88:89], v[234:235]
    v_pk_fma_f32 v[152:153], v[152:153], v[56:57], v[232:233] neg_lo:[0,0,1] neg_hi:[0,0,1]
    v_pk_mul_f32 v[232:233], v[186:187], v[90:91]
    v_pk_mul_f32 v[234:235], v[186:187], v[58:59]
    v_pk_fma_f32 v[186:187], v[154:155], v[90:91], v[234:235]
    v_pk_fma_f32 v[154:155], v[154:155], v[58:59], v[232:233] neg_lo:[0,0,1] neg_hi:[0,0,1]
    v_pk_mul_f32 v[232:233], v[188:189], v[92:93]
    v_pk_mul_f32 v[234:235], v[188:189], v[60:61]
    v_pk_fma_f32 v[188:189], v[156:157], v[92:93], v[234:235]
    v_pk_fma_f32 v[156:157], v[156:157], v[60:61], v[232:233] neg_lo:[0,0,1] neg_hi:[0,0,1]
    v_pk_mul_f32 v[232:233], v[190:191], v[94:95]
    v_pk_mul_f32 v[234:235], v[190:191], v[62:63]
    v_pk_fma_f32 v[190:191], v[158:159], v[94:95], v[234:235]
    v_pk_fma_f32 v[158:159], v[158:159], v[62:63], v[232:233] neg_lo:[0,0,1] neg_hi:[0,0,1]
    v_pk_mul_f32 v[232:233], v[192:193], v[96:97]
    v_pk_mul_f32 v[234:235], v[192:193], v[64:65]
    v_pk_fma_f32 v[192:193], v[160:161], v[96:97], v[234:235]
    v_pk_fma_f32 v[160:161], v[160:161], v[64:65], v[232:233] neg_lo:[0,0,1] neg_hi:[0,0,1]
    v_pk_mul_f32 v[232:233], v[194:195], v[98:99]
    v_pk_mul_f32 v[234:235], v[194:195], v[66:67]
    v_pk_fma_f32 v[194:195], v[162:163], v[98:99], v[234:235]
    v_pk_fma_f32 v[162:163], v[162:163], v[66:67], v[232:233] neg_lo:[0,0,1] neg_hi:[0,0,1]
    v_pk_mul_f32 v[232:233], v[196:197], v[100:101]
    v_pk_mul_f32 v[234:235], v[196:197], v[68:69]
    v_pk_fma_f32 v[196:197], v[164:165], v[100:101], v[234:235]
    v_pk_fma_f32 v[164:165], v[164:165], v[68:69], v[232:233] neg_lo:[0,0,1] neg_hi:[0,0,1]
    v_pk_mul_f32 v[232:233], v[198:199], v[102:103]
    v_pk_mul_f32 v[234:235], v[198:199], v[70:71]
    v_pk_fma_f32 v[198:199], v[166:167], v[102:103], v[234:235]
    v_pk_fma_f32 v[166:167], v[166:167], v[70:71], v[232:233] neg_lo:[0,0,1] neg_hi:[0,0,1]
    v_cvt_pk_bf16_f32 v200, v136, v137
    v_cvt_pk_bf16_f32 v216, v168, v169
    v_cvt_pk_bf16_f32 v201, v138, v139
    v_cvt_pk_bf16_f32 v217, v170, v171
    v_cvt_pk_bf16_f32 v202, v144, v145
    v_cvt_pk_bf16_f32 v218, v176, v177
    v_cvt_pk_bf16_f32 v203, v146, v147
    v_cvt_pk_bf16_f32 v219, v178, v179
    v_cvt_pk_bf16_f32 v204, v152, v153
    v_cvt_pk_bf16_f32 v220, v184, v185
    v_cvt_pk_bf16_f32 v205, v154, v155
    v_cvt_pk_bf16_f32 v221, v186, v187
    v_cvt_pk_bf16_f32 v206, v160, v161
    v_cvt_pk_bf16_f32 v222, v192, v193
    v_cvt_pk_bf16_f32 v207, v162, v163
    v_cvt_pk_bf16_f32 v223, v194, v195
    v_cvt_pk_bf16_f32 v208, v140, v141
    v_cvt_pk_bf16_f32 v224, v172, v173
    v_cvt_pk_bf16_f32 v209, v142, v143
    v_cvt_pk_bf16_f32 v225, v174, v175
    v_cvt_pk_bf16_f32 v210, v148, v149
    v_cvt_pk_bf16_f32 v226, v180, v181
    v_cvt_pk_bf16_f32 v211, v150, v151
    v_cvt_pk_bf16_f32 v227, v182, v183
    v_cvt_pk_bf16_f32 v212, v156, v157
    v_cvt_pk_bf16_f32 v228, v188, v189
    v_cvt_pk_bf16_f32 v213, v158, v159
    v_cvt_pk_bf16_f32 v229, v190, v191
    v_cvt_pk_bf16_f32 v214, v164, v165
    v_cvt_pk_bf16_f32 v230, v196, v197
    v_cvt_pk_bf16_f32 v215, v166, v167
    v_cvt_pk_bf16_f32 v231, v198, v199
    s_waitcnt lgkmcnt(0)
    s_nop 1
    v_mfma_f32_16x16x32_bf16 v[136:139], v[200:203], v[104:107], 0
    v_mfma_f32_16x16x32_bf16 v[136:139], v[216:219], v[120:123], v[136:139]
    v_mfma_f32_16x16x32_bf16 v[136:139], v[204:207], v[108:111], v[136:139]
    v_mfma_f32_16x16x32_bf16 v[136:139], v[220:223], v[124:127], v[136:139]
    v_mfma_f32_16x16x32_bf16 v[152:155], v[208:211], v[104:107], 0
    v_mfma_f32_16x16x32_bf16 v[152:155], v[224:227], v[120:123], v[152:155]
    v_mfma_f32_16x16x32_bf16 v[152:155], v[212:215], v[108:111], v[152:155]
    v_mfma_f32_16x16x32_bf16 v[152:155], v[228:231], v[124:127], v[152:155]
    v_mfma_f32_16x16x32_bf16 v[140:143], v[200:203], v[112:115], 0
    v_mfma_f32_16x16x32_bf16 v[140:143], v[216:219], v[128:131], v[140:143]
    v_mfma_f32_16x16x32_bf16 v[140:143], v[204:207], v[116:119], v[140:143]
    v_mfma_f32_16x16x32_bf16 v[140:143], v[220:223], v[132:135], v[140:143]
    v_mfma_f32_16x16x32_bf16 v[156:159], v[208:211], v[112:115], 0
    v_mfma_f32_16x16x32_bf16 v[156:159], v[224:227], v[128:131], v[156:159]
    v_mfma_f32_16x16x32_bf16 v[156:159], v[212:215], v[116:119], v[156:159]
    v_mfma_f32_16x16x32_bf16 v[156:159], v[228:231], v[132:135], v[156:159]
    ds_read_b128 v[104:107], v8 offset:4096
    ds_read_b128 v[120:123], v8 offset:12288
    ds_read_b128 v[108:111], v8 offset:5120
    ds_read_b128 v[124:127], v8 offset:13312
    ds_read_b128 v[112:115], v8 offset:6144
    ds_read_b128 v[128:131], v8 offset:14336
    ds_read_b128 v[116:119], v8 offset:7168
    ds_read_b128 v[132:135], v8 offset:15360
    s_waitcnt lgkmcnt(0)
    s_nop 1
    v_mfma_f32_16x16x32_bf16 v[144:147], v[200:203], v[104:107], 0
    v_mfma_f32_16x16x32_bf16 v[144:147], v[216:219], v[120:123], v[144:147]
    v_mfma_f32_16x16x32_bf16 v[144:147], v[204:207], v[108:111], v[144:147]
    v_mfma_f32_16x16x32_bf16 v[144:147], v[220:223], v[124:127], v[144:147]
    v_mfma_f32_16x16x32_bf16 v[160:163], v[208:211], v[104:107], 0
    v_mfma_f32_16x16x32_bf16 v[160:163], v[224:227], v[120:123], v[160:163]
    v_mfma_f32_16x16x32_bf16 v[160:163], v[212:215], v[108:111], v[160:163]
    v_mfma_f32_16x16x32_bf16 v[160:163], v[228:231], v[124:127], v[160:163]
    v_mfma_f32_16x16x32_bf16 v[148:151], v[200:203], v[112:115], 0
    v_mfma_f32_16x16x32_bf16 v[148:151], v[216:219], v[128:131], v[148:151]
    v_mfma_f32_16x16x32_bf16 v[148:151], v[204:207], v[116:119], v[148:151]
    v_mfma_f32_16x16x32_bf16 v[148:151], v[220:223], v[132:135], v[148:151]
    v_mfma_f32_16x16x32_bf16 v[164:167], v[208:211], v[112:115], 0
    v_mfma_f32_16x16x32_bf16 v[164:167], v[224:227], v[128:131], v[164:167]
    v_mfma_f32_16x16x32_bf16 v[164:167], v[212:215], v[116:119], v[164:167]
    v_mfma_f32_16x16x32_bf16 v[164:167], v[228:231], v[132:135], v[164:167]
    s_cmp_eq_u32 s46, 0
    s_cbranch_scc1 NOST_13
    s_nop 7
    v_cvt_pk_bf16_f32 v232, v136, v137
    v_cvt_pk_bf16_f32 v233, v138, v139
    v_cvt_pk_bf16_f32 v234, v152, v153
    v_cvt_pk_bf16_f32 v235, v154, v155
    s_nop 1
    v_permlane16_swap_b32 v232, v234
    v_permlane16_swap_b32 v233, v235
    buffer_store_dwordx4 v[232:235], v10, s[16:19], s45 offen offset:0 sc1
    s_nop 1
    v_cvt_pk_bf16_f32 v236, v140, v141
    v_cvt_pk_bf16_f32 v237, v142, v143
    v_cvt_pk_bf16_f32 v238, v156, v157
    v_cvt_pk_bf16_f32 v239, v158, v159
    s_nop 1
    v_permlane16_swap_b32 v236, v238
    v_permlane16_swap_b32 v237, v239
    buffer_store_dwordx4 v[236:239], v10, s[16:19], s45 offen offset:1024 sc1
    s_nop 1
    v_cvt_pk_bf16_f32 v232, v144, v145
    v_cvt_pk_bf16_f32 v233, v146, v147
    v_cvt_pk_bf16_f32 v234, v160, v161
    v_cvt_pk_bf16_f32 v235, v162, v163
    s_nop 1
    v_permlane16_swap_b32 v232, v234
    v_permlane16_swap_b32 v233, v235
    buffer_store_dwordx4 v[232:235], v10, s[16:19], s45 offen offset:2048 sc1
    s_nop 1
    v_cvt_pk_bf16_f32 v236, v148, v149
    v_cvt_pk_bf16_f32 v237, v150, v151
    v_cvt_pk_bf16_f32 v238, v164, v165
    v_cvt_pk_bf16_f32 v239, v166, v167
    s_nop 1
    v_permlane16_swap_b32 v236, v238
    v_permlane16_swap_b32 v237, v239
    buffer_store_dwordx4 v[236:239], v10, s[16:19], s45 offen offset:3072 sc1
    s_nop 1
NOST_13:
C512_12:
    s_sub_u32 s59, s2, 224
    s_lshl_b32 s59, s59, 2
    s_add_u32 s59, s59, 4224
PHASE3:
    s_and_b32 s42, s2, 7
    s_lshr_b32 s43, s2, 3
    s_lshr_b32 s55, s42, 2
    s_and_b32 s44, s42, 1
    s_lshl_b32 s44, s44, 1
    s_bfe_u32 s45, s42, 0x10001
    s_add_u32 s44, s44, s45
    s_lshl_b32 s44, s44, 2
    s_and_b32 s45, s43, 3
    s_add_u32 s53, s44, s45
    s_lshr_b32 s54, s43, 2
    s_mul_i32 s42, s53, 0xe0000
    s_add_u32 s44, s86, s42
    s_addc_u32 s45, s87, 0
    s_add_u32 s44, s44, 0x1000000
    s_addc_u32 s45, s45, 0
    s_mov_b32 s12, s44
    s_and_b32 s13, s45, 0xffff
    s_mov_b32 s14, 0xe0000
    s_mov_b32 s15, 0x20000
    s_lshl_b32 s42, s54, 8
    s_add_u32 s44, s92, s42
    s_addc_u32 s45, s93, 0
    s_sub_u32 s43, 0x700000, s42
    s_mov_b32 s16, s44
    s_and_b32 s17, s45, 0xffff
    s_mov_b32 s18, s43
    s_mov_b32 s19, 0x20000
    s_lshl_b32 s42, s53, 18
    s_lshl_b32 s43, s54, 8
    s_add_u32 s42, s42, s43
    s_lshl_b32 s43, s55, 7
    s_add_u32 s42, s42, s43
    s_add_u32 s44, s84, s42
    s_addc_u32 s45, s85, 0
    s_mov_b32 s20, s44
    s_and_b32 s21, s45, 0xffff
    s_mov_b32 s22, 0x3f880
    s_mov_b32 s23, 0x20000
    s_add_u32 s44, s94, s42
    s_addc_u32 s45, s95, 0
    s_mov_b32 s28, s44
    s_and_b32 s29, s45, 0xffff
    s_mov_b32 s30, 0x3f880
    s_mov_b32 s31, 0x20000
    s_lshl_b32 s42, s54, 1
    s_add_u32 s42, s42, s55
    s_lshl_b32 s42, s42, 18
    s_lshl_b32 s43, s53, 8
    s_add_u32 s42, s42, s43
    s_add_u32 s44, s86, s42
    s_addc_u32 s45, s87, 0
    s_add_u32 s44, s44, 0x2000000
    s_addc_u32 s45, s45, 0
    s_mov_b32 s24, s44
    s_and_b32 s25, s45, 0xffff
    s_mov_b32 s26, 0x3f100
    s_mov_b32 s27, 0x20000
    s_add_u32 s44, s86, 0x2800000
    s_addc_u32 s45, s87, 0
    s_mov_b32 s32, s44
    s_and_b32 s33, s45, 0xffff
    s_mov_b32 s34, 0x800000
    s_mov_b32 s35, 0x20000
    v_lshrrev_b32 v22, 4, v0
    s_and_b32 s36, s96, 1
    s_lshl_b32 s36, s36, 2
    v_or_b32 v23, s36, v22
    v_lshlrev_b32 v23, 1, v23
    v_and_b32 v24, 15, v0
    v_xor_b32 v23, v23, v24
    v_lshlrev_b32 v23, 4, v23
    s_lshl_b32 s36, s96, 3
    v_add_u32 v25, s36, v22
    v_mul_u32_u24 v25, 2048, v25
    v_add_u32 v4, v25, v23
    v_add_u32 v5, 0x1c00, v4
    v_lshrrev_b32 v23, 3, v0
    s_lshl_b32 s42, s96, 4
    v_add_u32 v23, s42, v23
    v_mul_u32_u24 v23, 7168, v23
    v_and_b32 v24, 7, v0
    v_xor_b32 v24, v24, v22
    v_lshlrev_b32 v24, 4, v24
    v_add_u32 v2, v23, v24
    v_xor_b32 v24, 64, v24
    v_add_u32 v23, 0xdc00, v23
    v_add_u32 v3, v23, v24
    s_lshl_b32 s42, s96, 3
    v_add_u32 v23, s42, v22
    v_lshlrev_b32 v23, 12, v23
    v_and_b32 v24, 15, v0
    v_lshlrev_b32 v24, 4, v24
    v_add_u32 v6, v23, v24
    v_add_u32 v7, 0x3c00, v6
    s_lshl_b32 s58, s96, 11
    s_mul_i32 s56, s55, 3584
    s_mul_i32 s57, s55, 0x380000
    v_and_b32 v23, 15, v0
    v_and_b32 v24, 1, v22
    v_lshlrev_b32 v24, 4, v24
    v_add_u32 v23, v23, v24
    s_lshr_b32 s42, s96, 1
    s_and_b32 s42, s42, 1
    s_lshl_b32 s43, s42, 6
    v_add_u32 v23, s43, v23
    v_lshlrev_b32 v23, 11, v23
    v_lshrrev_b32 v24, 1, v22
    v_lshlrev_b32 v24, 4, v24
    s_and_b32 s44, s96, 1
    s_lshl_b32 s44, s44, 6
    s_lshr_b32 s45, s96, 2
    s_lshl_b32 s46, s45, 5
    s_add_u32 s44, s44, s46
    v_add3_u32 v18, v23, v24, s44
    s_waitcnt vmcnt(0)
    s_barrier
    s_cmp_lg_u32 s96, s98
    s_cbranch_scc1 SIG_14
    v_mov_b32 v28, s97
    v_mov_b32 v29, s59
    s_mov_b64 exec, 1
    buffer_store_dword v28, v29, s[80:83], 0 offen sc0 sc1
    s_mov_b64 exec, -1
SIG_14:
    s_cmp_eq_u32 s96, s98
    s_cbranch_scc1 P3_E_SKIP
    s_mul_i32 s57, s55, 0x380000
    s_add_u32 m0, s58, 0x4000
    s_nop 0
    buffer_load_dwordx4 v4, s[16:19], s57 offen offset:0 lds
    buffer_load_dwordx4 v5, s[16:19], s57 offen offset:1024 lds
    s_add_u32 s57, s57, 0x20000
    s_add_u32 m0, s58, 0xc000
    s_nop 0
    buffer_load_dwordx4 v4, s[16:19], s57 offen offset:0 lds
    buffer_load_dwordx4 v5, s[16:19], s57 offen offset:1024 lds
    s_add_u32 s57, s57, 0x20000
    s_add_u32 m0, s58, 0x14000
    s_nop 0
    buffer_load_dwordx4 v4, s[16:19], s57 offen offset:0 lds
    buffer_load_dwordx4 v5, s[16:19], s57 offen offset:1024 lds
    s_add_u32 s57, s57, 0x20000
    s_mov_b32 s42, 0x10000
    buffer_load_dwordx4 v[32:35], v18, s[20:23], 0 offen
    buffer_load_dwordx4 v[36:39], v18, s[20:23], s42 offen
P3_E_SKIP:
    v_and_b32 v23, 15, v0
    v_lshrrev_b32 v24, 1, v23
    v_xor_b32 v24, v24, v22
    s_lshr_b32 s45, s96, 2
    s_lshl_b32 s46, s45, 2
    v_xor_b32 v24, s46, v24
    v_lshlrev_b32 v24, 4, v24
    s_lshr_b32 s42, s96, 1
    s_and_b32 s42, s42, 1
    s_lshl_b32 s43, s42, 13
    v_lshlrev_b32 v23, 7, v23
    v_add3_u32 v8, v23, v24, s43
    v_add_u32 v9, 0x10000, v8
    v_lshrrev_b32 v23, 2, v0
    v_and_b32 v23, 3, v23
    v_lshlrev_b32 v24, 3, v22
    v_add_u32 v24, v24, v23
    s_lshl_b32 s46, s45, 5
    v_add_u32 v24, s46, v24
    v_lshlrev_b32 v24, 8, v24
    v_and_b32 v25, 1, v22
    v_lshlrev_b32 v25, 2, v25
    v_or_b32 v25, v25, v23
    v_and_b32 v26, 3, v0
    v_lshlrev_b32 v26, 3, v26
    v_add_u32 v24, v24, v26
    v_add_u32 v24, 0x4000, v24
    s_and_b32 s44, s96, 1
    s_lshl_b32 s44, s44, 1
    s_xor_b32 s46, s55, 0
    s_lshl_b32 s46, s46, 2
    s_add_u32 s46, s46, s44
    s_add_u32 s46, s46, 0
    v_xor_b32 v26, s46, v25
    v_lshlrev_b32 v26, 5, v26
    v_add_u32 v10, v24, v26
    v_add_u32 v14, 0x10000, v10
    s_xor_b32 s46, s55, 0
    s_lshl_b32 s46, s46, 2
    s_add_u32 s46, s46, s44
    s_add_u32 s46, s46, 1
    v_xor_b32 v26, s46, v25
    v_lshlrev_b32 v26, 5, v26
    v_add_u32 v11, v24, v26
    v_add_u32 v15, 0x10000, v11
    s_xor_b32 s46, s55, 1
    s_lshl_b32 s46, s46, 2
    s_add_u32 s46, s46, s44
    s_add_u32 s46, s46, 0
    v_xor_b32 v26, s46, v25
    v_lshlrev_b32 v26, 5, v26
    v_add_u32 v12, v24, v26
    v_add_u32 v16, 0x10000, v12
    s_xor_b32 s46, s55, 1
    s_lshl_b32 s46, s46, 2
    s_add_u32 s46, s46, s44
    s_add_u32 s46, s46, 1
    v_xor_b32 v26, s46, v25
    v_lshlrev_b32 v26, 5, v26
    v_add_u32 v13, v24, v26
    v_add_u32 v17, 0x10000, v13
    v_lshlrev_b32 v24, 2, v22
    v_add_u32 v24, v24, v23
    s_and_b32 s44, s96, 1
    s_lshl_b32 s44, s44, 5
    s_lshl_b32 s46, s45, 4
    s_add_u32 s44, s44, s46
    v_add_u32 v24, s44, v24
    v_lshlrev_b32 v24, 8, v24
    v_and_b32 v26, 3, v0
    v_lshlrev_b32 v26, 3, v26
    s_lshl_b32 s43, s42, 7
    s_add_u32 s43, s43, 131072
    v_add3_u32 v19, v24, v26, s43
    s_lshr_b32 s46, s53, 1
    s_lshl_b32 s46, s46, 1
    s_add_u32 s46, s46, s55
    s_lshl_b32 s46, s46, 7
    s_add_u32 s46, s46, 2176
    s_mov_b32 s47, 4224
    s_cmp_lg_u32 s96, s98
    s_cbranch_scc1 POLL_15_END
    v_lshlrev_b32 v29, 2, v0
    v_add_u32 v29, s46, v29
    s_mov_b32 exec_lo, 0x3fff
    s_mov_b32 exec_hi, 0
    s_mov_b32 s48, 0x20000
POLL_15_0:
    buffer_load_dword v28, v29, s[80:83], 0 offen sc0 sc1
    s_waitcnt vmcnt(0)
    v_cmp_ne_u32 vcc, s97, v28
    s_nop 4
    s_cbranch_vccz POLL_15_0_OK
    s_sleep 1
    s_sub_u32 s48, s48, 1
    s_cmp_lg_u32 s48, 0
    s_cbranch_scc1 POLL_15_0
POLL_15_0_OK:
    s_mov_b64 exec, -1
    v_lshlrev_b32 v29, 2, v0
    v_add_u32 v29, s47, v29
    s_mov_b32 exec_lo, 0xffffffff
    s_mov_b32 exec_hi, 0
    s_mov_b32 s48, 0x20000
POLL_15_1:
    buffer_load_dword v28, v29, s[80:83], 0 offen sc0 sc1
    s_waitcnt vmcnt(0)
    v_cmp_ne_u32 vcc, s97, v28
    s_nop 4
    s_cbranch_vccz POLL_15_1_OK
    s_sleep 1
    s_sub_u32 s48, s48, 1
    s_cmp_lg_u32 s48, 0
    s_cbranch_scc1 POLL_15_1
POLL_15_1_OK:
    s_mov_b64 exec, -1
POLL_15_END:
    s_cmp_lg_u32 s96, s98
    s_cbranch_scc1 P3_E_DONE
    s_mul_i32 s57, s55, 0x380000
    s_add_u32 m0, s58, 0x4000
    s_nop 0
    buffer_load_dwordx4 v4, s[16:19], s57 offen offset:0 lds
    buffer_load_dwordx4 v5, s[16:19], s57 offen offset:1024 lds
    s_add_u32 s57, s57, 0x20000
    s_add_u32 m0, s58, 0xc000
    s_nop 0
    buffer_load_dwordx4 v4, s[16:19], s57 offen offset:0 lds
    buffer_load_dwordx4 v5, s[16:19], s57 offen offset:1024 lds
    s_add_u32 s57, s57, 0x20000
    s_add_u32 m0, s58, 0x14000
    s_nop 0
    buffer_load_dwordx4 v4, s[16:19], s57 offen offset:0 lds
    buffer_load_dwordx4 v5, s[16:19], s57 offen offset:1024 lds
    s_add_u32 s57, s57, 0x20000
    s_mov_b32 s42, 0x10000
    buffer_load_dwordx4 v[32:35], v18, s[20:23], 0 offen
    buffer_load_dwordx4 v[36:39], v18, s[20:23], s42 offen
P3_E_DONE:
    s_barrier
    s_add_u32 m0, s58, 0x0
    s_nop 0
    buffer_load_dwordx4 v2, s[12:15], s56 offen offset:0 sc1 lds
    buffer_load_dwordx4 v3, s[12:15], s56 offen offset:1024 sc1 lds
    s_add_u32 s56, s56, 128
    s_add_u32 m0, s58, 0x8000
    s_nop 0
    buffer_load_dwordx4 v2, s[12:15], s56 offen offset:0 sc1 lds
    buffer_load_dwordx4 v3, s[12:15], s56 offen offset:1024 sc1 lds
    s_add_u32 s56, s56, 128
    s_add_u32 m0, s58, 0x10000
    s_nop 0
    buffer_load_dwordx4 v2, s[12:15], s56 offen offset:0 sc1 lds
    buffer_load_dwordx4 v3, s[12:15], s56 offen offset:1024 sc1 lds
    s_add_u32 s56, s56, 128
    s_add_u32 m0, s58, 0x20000
    s_mov_b32 s42, 0
    buffer_load_dwordx4 v6, s[24:27], s42 offen offset:0 sc1 lds
    buffer_load_dwordx4 v7, s[24:27], s42 offen offset:1024 sc1 lds
    s_waitcnt vmcnt(6)
    s_barrier
    ds_read_b64_tr_b16 v[40:41], v10 offset:0
    ds_read_b64_tr_b16 v[42:43], v10 offset:1024
    ds_read_b64_tr_b16 v[44:45], v11 offset:0
    ds_read_b64_tr_b16 v[46:47], v11 offset:1024
    ds_read_b64_tr_b16 v[48:49], v12 offset:0
    ds_read_b64_tr_b16 v[50:51], v12 offset:1024
    ds_read_b64_tr_b16 v[52:53], v13 offset:0
    ds_read_b64_tr_b16 v[54:55], v13 offset:1024
    ds_read_b128 v[56:59], v8 offset:0
    ds_read_b128 v[60:63], v8 offset:2048
    ds_read_b128 v[64:67], v8 offset:4096
    ds_read_b128 v[68:71], v8 offset:6144
    s_add_u32 m0, s58, 0x18000
    s_nop 0
    buffer_load_dwordx4 v2, s[12:15], s56 offen offset:0 sc1 lds
    buffer_load_dwordx4 v3, s[12:15], s56 offen offset:1024 sc1 lds
    s_add_u32 s56, s56, 128
    s_add_u32 m0, s58, 0x1c000
    s_nop 0
    buffer_load_dwordx4 v4, s[16:19], s57 offen offset:0 lds
    buffer_load_dwordx4 v5, s[16:19], s57 offen offset:1024 lds
    s_add_u32 s57, s57, 0x20000
    s_waitcnt lgkmcnt(0)
    s_waitcnt vmcnt(8)
    s_barrier
    v_mfma_f32_16x16x32_bf16 v[104:107], v[40:43], v[56:59], 0
    ds_read_b64_tr_b16 v[72:73], v10 offset:32768
    s_add_u32 m0, s58, 0x0
    v_mfma_f32_16x16x32_bf16 v[108:111], v[40:43], v[60:63], 0
    ds_read_b64_tr_b16 v[74:75], v10 offset:33792
    v_mfma_f32_16x16x32_bf16 v[112:115], v[40:43], v[64:67], 0
    ds_read_b64_tr_b16 v[76:77], v11 offset:32768
    buffer_load_dwordx4 v2, s[12:15], s56 offen offset:0 sc1 lds
    v_mfma_f32_16x16x32_bf16 v[116:119], v[40:43], v[68:71], 0
    ds_read_b64_tr_b16 v[78:79], v11 offset:33792
    v_mfma_f32_16x16x32_bf16 v[120:123], v[44:47], v[56:59], 0
    ds_read_b64_tr_b16 v[80:81], v12 offset:32768
    buffer_load_dwordx4 v3, s[12:15], s56 offen offset:1024 sc1 lds
    v_mfma_f32_16x16x32_bf16 v[124:127], v[44:47], v[60:63], 0
    ds_read_b64_tr_b16 v[82:83], v12 offset:33792
    v_mfma_f32_16x16x32_bf16 v[128:131], v[44:47], v[64:67], 0
    ds_read_b64_tr_b16 v[84:85], v13 offset:32768
    s_add_u32 s56, s56, 128
    v_mfma_f32_16x16x32_bf16 v[132:135], v[44:47], v[68:71], 0
    ds_read_b64_tr_b16 v[86:87], v13 offset:33792
    v_mfma_f32_16x16x32_bf16 v[136:139], v[48:51], v[56:59], 0
    ds_read_b128 v[88:91], v8 offset:32768
    s_add_u32 m0, s58, 0x4000
    v_mfma_f32_16x16x32_bf16 v[140:143], v[48:51], v[60:63], 0
    ds_read_b128 v[92:95], v8 offset:34816
    v_mfma_f32_16x16x32_bf16 v[144:147], v[48:51], v[64:67], 0
    ds_read_b128 v[96:99], v8 offset:36864
    buffer_load_dwordx4 v4, s[16:19], s57 offen offset:0 lds
    v_mfma_f32_16x16x32_bf16 v[148:151], v[48:51], v[68:71], 0
    ds_read_b128 v[100:103], v8 offset:38912
    v_mfma_f32_16x16x32_bf16 v[152:155], v[52:55], v[56:59], 0
    buffer_load_dwordx4 v5, s[16:19], s57 offen offset:1024 lds
    v_mfma_f32_16x16x32_bf16 v[156:159], v[52:55], v[60:63], 0
    v_mfma_f32_16x16x32_bf16 v[160:163], v[52:55], v[64:67], 0
    s_add_u32 s57, s57, 0x20000
    v_mfma_f32_16x16x32_bf16 v[164:167], v[52:55], v[68:71], 0
    s_waitcnt lgkmcnt(0)
    s_waitcnt vmcnt(8)
    s_barrier
    v_mfma_f32_16x16x32_bf16 v[104:107], v[72:75], v[88:91], v[104:107]
    ds_read_b64_tr_b16 v[40:41], v14 offset:0
    s_add_u32 m0, s58, 0x8000
    v_mfma_f32_16x16x32_bf16 v[108:111], v[72:75], v[92:95], v[108:111]
    ds_read_b64_tr_b16 v[42:43], v14 offset:1024
    v_mfma_f32_16x16x32_bf16 v[112:115], v[72:75], v[96:99], v[112:115]
    ds_read_b64_tr_b16 v[44:45], v15 offset:0
    buffer_load_dwordx4 v2, s[12:15], s56 offen offset:0 sc1 lds
    v_mfma_f32_16x16x32_bf16 v[116:119], v[72:75], v[100:103], v[116:119]
    ds_read_b64_tr_b16 v[46:47], v15 offset:1024
    v_mfma_f32_16x16x32_bf16 v[120:123], v[76:79], v[88:91], v[120:123]
    ds_read_b64_tr_b16 v[48:49], v16 offset:0
    buffer_load_dwordx4 v3, s[12:15], s56 offen offset:1024 sc1 lds
    v_mfma_f32_16x16x32_bf16 v[124:127], v[76:79], v[92:95], v[124:127]
    ds_read_b64_tr_b16 v[50:51], v16 offset:1024
    v_mfma_f32_16x16x32_bf16 v[128:131], v[76:79], v[96:99], v[128:131]
    ds_read_b64_tr_b16 v[52:53], v17 offset:0
    s_add_u32 s56, s56, 128
    v_mfma_f32_16x16x32_bf16 v[132:135], v[76:79], v[100:103], v[132:135]
    ds_read_b64_tr_b16 v[54:55], v17 offset:1024
    v_mfma_f32_16x16x32_bf16 v[136:139], v[80:83], v[88:91], v[136:139]
    ds_read_b128 v[56:59], v9 offset:0
    s_add_u32 m0, s58, 0xc000
    v_mfma_f32_16x16x32_bf16 v[140:143], v[80:83], v[92:95], v[140:143]
    ds_read_b128 v[60:63], v9 offset:2048
    v_mfma_f32_16x16x32_bf16 v[144:147], v[80:83], v[96:99], v[144:147]
    ds_read_b128 v[64:67], v9 offset:4096
    buffer_load_dwordx4 v4, s[16:19], s57 offen offset:0 lds
    v_mfma_f32_16x16x32_bf16 v[148:151], v[80:83], v[100:103], v[148:151]
    ds_read_b128 v[68:71], v9 offset:6144
    v_mfma_f32_16x16x32_bf16 v[152:155], v[84:87], v[88:91], v[152:155]
    buffer_load_dwordx4 v5, s[16:19], s57 offen offset:1024 lds
    v_mfma_f32_16x16x32_bf16 v[156:159], v[84:87], v[92:95], v[156:159]
    v_mfma_f32_16x16x32_bf16 v[160:163], v[84:87], v[96:99], v[160:163]
    s_add_u32 s57, s57, 0x20000
    v_mfma_f32_16x16x32_bf16 v[164:167], v[84:87], v[100:103], v[164:167]
    s_waitcnt lgkmcnt(0)
    s_waitcnt vmcnt(8)
    s_barrier
    v_mfma_f32_16x16x32_bf16 v[104:107], v[40:43], v[56:59], v[104:107]
    ds_read_b64_tr_b16 v[72:73], v14 offset:32768
    s_add_u32 m0, s58, 0x10000
    v_mfma_f32_16x16x32_bf16 v[108:111], v[40:43], v[60:63], v[108:111]
    ds_read_b64_tr_b16 v[74:75], v14 offset:33792
    v_mfma_f32_16x16x32_bf16 v[112:115], v[40:43], v[64:67], v[112:115]
    ds_read_b64_tr_b16 v[76:77], v15 offset:32768
    buffer_load_dwordx4 v2, s[12:15], s56 offen offset:0 sc1 lds
    v_mfma_f32_16x16x32_bf16 v[116:119], v[40:43], v[68:71], v[116:119]
    ds_read_b64_tr_b16 v[78:79], v15 offset:33792
    v_mfma_f32_16x16x32_bf16 v[120:123], v[44:47], v[56:59], v[120:123]
    ds_read_b64_tr_b16 v[80:81], v16 offset:32768
    buffer_load_dwordx4 v3, s[12:15], s56 offen offset:1024 sc1 lds
    v_mfma_f32_16x16x32_bf16 v[124:127], v[44:47], v[60:63], v[124:127]
    ds_read_b64_tr_b16 v[82:83], v16 offset:33792
    v_mfma_f32_16x16x32_bf16 v[128:131], v[44:47], v[64:67], v[128:131]
    ds_read_b64_tr_b16 v[84:85], v17 offset:32768
    s_add_u32 s56, s56, 128
    v_mfma_f32_16x16x32_bf16 v[132:135], v[44:47], v[68:71], v[132:135]
    ds_read_b64_tr_b16 v[86:87], v17 offset:33792
    v_mfma_f32_16x16x32_bf16 v[136:139], v[48:51], v[56:59], v[136:139]
    ds_read_b128 v[88:91], v9 offset:32768
    s_add_u32 m0, s58, 0x14000
    v_mfma_f32_16x16x32_bf16 v[140:143], v[48:51], v[60:63], v[140:143]
    ds_read_b128 v[92:95], v9 offset:34816
    v_mfma_f32_16x16x32_bf16 v[144:147], v[48:51], v[64:67], v[144:147]
    ds_read_b128 v[96:99], v9 offset:36864
    buffer_load_dwordx4 v4, s[16:19], s57 offen offset:0 lds
    v_mfma_f32_16x16x32_bf16 v[148:151], v[48:51], v[68:71], v[148:151]
    ds_read_b128 v[100:103], v9 offset:38912
    v_mfma_f32_16x16x32_bf16 v[152:155], v[52:55], v[56:59], v[152:155]
    buffer_load_dwordx4 v5, s[16:19], s57 offen offset:1024 lds
    v_mfma_f32_16x16x32_bf16 v[156:159], v[52:55], v[60:63], v[156:159]
    v_mfma_f32_16x16x32_bf16 v[160:163], v[52:55], v[64:67], v[160:163]
    s_add_u32 s57, s57, 0x20000
    v_mfma_f32_16x16x32_bf16 v[164:167], v[52:55], v[68:71], v[164:167]
    s_waitcnt lgkmcnt(0)
    s_waitcnt vmcnt(8)
    s_barrier
    v_mfma_f32_16x16x32_bf16 v[104:107], v[72:75], v[88:91], v[104:107]
    ds_read_b64_tr_b16 v[40:41], v10 offset:0
    s_add_u32 m0, s58, 0x18000
    v_mfma_f32_16x16x32_bf16 v[108:111], v[72:75], v[92:95], v[108:111]
    ds_read_b64_tr_b16 v[42:43], v10 offset:1024
    v_mfma_f32_16x16x32_bf16 v[112:115], v[72:75], v[96:99], v[112:115]
    ds_read_b64_tr_b16 v[44:45], v11 offset:0
    buffer_load_dwordx4 v2, s[12:15], s56 offen offset:0 sc1 lds
    v_mfma_f32_16x16x32_bf16 v[116:119], v[72:75], v[100:103], v[116:119]
    ds_read_b64_tr_b16 v[46:47], v11 offset:1024
    v_mfma_f32_16x16x32_bf16 v[120:123], v[76:79], v[88:91], v[120:123]
    ds_read_b64_tr_b16 v[48:49], v12 offset:0
    buffer_load_dwordx4 v3, s[12:15], s56 offen offset:1024 sc1 lds
    v_mfma_f32_16x16x32_bf16 v[124:127], v[76:79], v[92:95], v[124:127]
    ds_read_b64_tr_b16 v[50:51], v12 offset:1024
    v_mfma_f32_16x16x32_bf16 v[128:131], v[76:79], v[96:99], v[128:131]
    ds_read_b64_tr_b16 v[52:53], v13 offset:0
    s_add_u32 s56, s56, 128
    v_mfma_f32_16x16x32_bf16 v[132:135], v[76:79], v[100:103], v[132:135]
    ds_read_b64_tr_b16 v[54:55], v13 offset:1024
    v_mfma_f32_16x16x32_bf16 v[136:139], v[80:83], v[88:91], v[136:139]
    ds_read_b128 v[56:59], v8 offset:0
    s_add_u32 m0, s58, 0x1c000
    v_mfma_f32_16x16x32_bf16 v[140:143], v[80:83], v[92:95], v[140:143]
    ds_read_b128 v[60:63], v8 offset:2048
    v_mfma_f32_16x16x32_bf16 v[144:147], v[80:83], v[96:99], v[144:147]
    ds_read_b128 v[64:67], v8 offset:4096
    buffer_load_dwordx4 v4, s[16:19], s57 offen offset:0 lds
    v_mfma_f32_16x16x32_bf16 v[148:151], v[80:83], v[100:103], v[148:151]
    ds_read_b128 v[68:71], v8 offset:6144
    v_mfma_f32_16x16x32_bf16 v[152:155], v[84:87], v[88:91], v[152:155]
    buffer_load_dwordx4 v5, s[16:19], s57 offen offset:1024 lds
    v_mfma_f32_16x16x32_bf16 v[156:159], v[84:87], v[92:95], v[156:159]
    v_mfma_f32_16x16x32_bf16 v[160:163], v[84:87], v[96:99], v[160:163]
    s_add_u32 s57, s57, 0x20000
    v_mfma_f32_16x16x32_bf16 v[164:167], v[84:87], v[100:103], v[164:167]
    s_waitcnt lgkmcnt(0)
    s_waitcnt vmcnt(8)
    s_barrier
    v_mfma_f32_16x16x32_bf16 v[104:107], v[40:43], v[56:59], v[104:107]
    ds_read_b64_tr_b16 v[72:73], v10 offset:32768
    s_add_u32 m0, s58, 0x0
    v_mfma_f32_16x16x32_bf16 v[108:111], v[40:43], v[60:63], v[108:111]
    ds_read_b64_tr_b16 v[74:75], v10 offset:33792
    v_mfma_f32_16x16x32_bf16 v[112:115], v[40:43], v[64:67], v[112:115]
    ds_read_b64_tr_b16 v[76:77], v11 offset:32768
    buffer_load_dwordx4 v2, s[12:15], s56 offen offset:0 sc1 lds
    v_mfma_f32_16x16x32_bf16 v[116:119], v[40:43], v[68:71], v[116:119]
    ds_read_b64_tr_b16 v[78:79], v11 offset:33792
    v_mfma_f32_16x16x32_bf16 v[120:123], v[44:47], v[56:59], v[120:123]
    ds_read_b64_tr_b16 v[80:81], v12 offset:32768
    buffer_load_dwordx4 v3, s[12:15], s56 offen offset:1024 sc1 lds
    v_mfma_f32_16x16x32_bf16 v[124:127], v[44:47], v[60:63], v[124:127]
    ds_read_b64_tr_b16 v[82:83], v12 offset:33792
    v_mfma_f32_16x16x32_bf16 v[128:131], v[44:47], v[64:67], v[128:131]
    ds_read_b64_tr_b16 v[84:85], v13 offset:32768
    s_add_u32 s56, s56, 128
    v_mfma_f32_16x16x32_bf16 v[132:135], v[44:47], v[68:71], v[132:135]
    ds_read_b64_tr_b16 v[86:87], v13 offset:33792
    v_mfma_f32_16x16x32_bf16 v[136:139], v[48:51], v[56:59], v[136:139]
    ds_read_b128 v[88:91], v8 offset:32768
    s_add_u32 m0, s58, 0x4000
    v_mfma_f32_16x16x32_bf16 v[140:143], v[48:51], v[60:63], v[140:143]
    ds_read_b128 v[92:95], v8 offset:34816
    v_mfma_f32_16x16x32_bf16 v[144:147], v[48:51], v[64:67], v[144:147]
    ds_read_b128 v[96:99], v8 offset:36864
    buffer_load_dwordx4 v4, s[16:19], s57 offen offset:0 lds
    v_mfma_f32_16x16x32_bf16 v[148:151], v[48:51], v[68:71], v[148:151]
    ds_read_b128 v[100:103], v8 offset:38912
    v_mfma_f32_16x16x32_bf16 v[152:155], v[52:55], v[56:59], v[152:155]
    buffer_load_dwordx4 v5, s[16:19], s57 offen offset:1024 lds
    v_mfma_f32_16x16x32_bf16 v[156:159], v[52:55], v[60:63], v[156:159]
    v_mfma_f32_16x16x32_bf16 v[160:163], v[52:55], v[64:67], v[160:163]
    s_add_u32 s57, s57, 0x20000
    v_mfma_f32_16x16x32_bf16 v[164:167], v[52:55], v[68:71], v[164:167]
    s_waitcnt lgkmcnt(0)
    s_waitcnt vmcnt(8)
    s_barrier
    v_mfma_f32_16x16x32_bf16 v[104:107], v[72:75], v[88:91], v[104:107]
    ds_read_b64_tr_b16 v[40:41], v14 offset:0
    s_add_u32 m0, s58, 0x8000
    v_mfma_f32_16x16x32_bf16 v[108:111], v[72:75], v[92:95], v[108:111]
    ds_read_b64_tr_b16 v[42:43], v14 offset:1024
    v_mfma_f32_16x16x32_bf16 v[112:115], v[72:75], v[96:99], v[112:115]
    ds_read_b64_tr_b16 v[44:45], v15 offset:0
    buffer_load_dwordx4 v2, s[12:15], s56 offen offset:0 sc1 lds
    v_mfma_f32_16x16x32_bf16 v[116:119], v[72:75], v[100:103], v[116:119]
    ds_read_b64_tr_b16 v[46:47], v15 offset:1024
    v_mfma_f32_16x16x32_bf16 v[120:123], v[76:79], v[88:91], v[120:123]
    ds_read_b64_tr_b16 v[48:49], v16 offset:0
    buffer_load_dwordx4 v3, s[12:15], s56 offen offset:1024 sc1 lds
    v_mfma_f32_16x16x32_bf16 v[124:127], v[76:79], v[92:95], v[124:127]
    ds_read_b64_tr_b16 v[50:51], v16 offset:1024
    v_mfma_f32_16x16x32_bf16 v[128:131], v[76:79], v[96:99], v[128:131]
    ds_read_b64_tr_b16 v[52:53], v17 offset:0
    s_add_u32 s56, s56, 128
    v_mfma_f32_16x16x32_bf16 v[132:135], v[76:79], v[100:103], v[132:135]
    ds_read_b64_tr_b16 v[54:55], v17 offset:1024
    v_mfma_f32_16x16x32_bf16 v[136:139], v[80:83], v[88:91], v[136:139]
    ds_read_b128 v[56:59], v9 offset:0
    s_add_u32 m0, s58, 0xc000
    v_mfma_f32_16x16x32_bf16 v[140:143], v[80:83], v[92:95], v[140:143]
    ds_read_b128 v[60:63], v9 offset:2048
    v_mfma_f32_16x16x32_bf16 v[144:147], v[80:83], v[96:99], v[144:147]
    ds_read_b128 v[64:67], v9 offset:4096
    buffer_load_dwordx4 v4, s[16:19], s57 offen offset:0 lds
    v_mfma_f32_16x16x32_bf16 v[148:151], v[80:83], v[100:103], v[148:151]
    ds_read_b128 v[68:71], v9 offset:6144
    v_mfma_f32_16x16x32_bf16 v[152:155], v[84:87], v[88:91], v[152:155]
    buffer_load_dwordx4 v5, s[16:19], s57 offen offset:1024 lds
    v_mfma_f32_16x16x32_bf16 v[156:159], v[84:87], v[92:95], v[156:159]
    v_mfma_f32_16x16x32_bf16 v[160:163], v[84:87], v[96:99], v[160:163]
    s_add_u32 s57, s57, 0x20000
    v_mfma_f32_16x16x32_bf16 v[164:167], v[84:87], v[100:103], v[164:167]
    s_waitcnt lgkmcnt(0)
    s_waitcnt vmcnt(8)
    s_barrier
    v_mfma_f32_16x16x32_bf16 v[104:107], v[40:43], v[56:59], v[104:107]
    ds_read_b64_tr_b16 v[72:73], v14 offset:32768
    s_add_u32 m0, s58, 0x10000
    v_mfma_f32_16x16x32_bf16 v[108:111], v[40:43], v[60:63], v[108:111]
    ds_read_b64_tr_b16 v[74:75], v14 offset:33792
    v_mfma_f32_16x16x32_bf16 v[112:115], v[40:43], v[64:67], v[112:115]
    ds_read_b64_tr_b16 v[76:77], v15 offset:32768
    buffer_load_dwordx4 v2, s[12:15], s56 offen offset:0 sc1 lds
    v_mfma_f32_16x16x32_bf16 v[116:119], v[40:43], v[68:71], v[116:119]
    ds_read_b64_tr_b16 v[78:79], v15 offset:33792
    v_mfma_f32_16x16x32_bf16 v[120:123], v[44:47], v[56:59], v[120:123]
    ds_read_b64_tr_b16 v[80:81], v16 offset:32768
    buffer_load_dwordx4 v3, s[12:15], s56 offen offset:1024 sc1 lds
    v_mfma_f32_16x16x32_bf16 v[124:127], v[44:47], v[60:63], v[124:127]
    ds_read_b64_tr_b16 v[82:83], v16 offset:33792
    v_mfma_f32_16x16x32_bf16 v[128:131], v[44:47], v[64:67], v[128:131]
    ds_read_b64_tr_b16 v[84:85], v17 offset:32768
    s_add_u32 s56, s56, 128
    v_mfma_f32_16x16x32_bf16 v[132:135], v[44:47], v[68:71], v[132:135]
    ds_read_b64_tr_b16 v[86:87], v17 offset:33792
    v_mfma_f32_16x16x32_bf16 v[136:139], v[48:51], v[56:59], v[136:139]
    ds_read_b128 v[88:91], v9 offset:32768
    s_add_u32 m0, s58, 0x14000
    v_mfma_f32_16x16x32_bf16 v[140:143], v[48:51], v[60:63], v[140:143]
    ds_read_b128 v[92:95], v9 offset:34816
    v_mfma_f32_16x16x32_bf16 v[144:147], v[48:51], v[64:67], v[144:147]
    ds_read_b128 v[96:99], v9 offset:36864
    buffer_load_dwordx4 v4, s[16:19], s57 offen offset:0 lds
    v_mfma_f32_16x16x32_bf16 v[148:151], v[48:51], v[68:71], v[148:151]
    ds_read_b128 v[100:103], v9 offset:38912
    v_mfma_f32_16x16x32_bf16 v[152:155], v[52:55], v[56:59], v[152:155]
    buffer_load_dwordx4 v5, s[16:19], s57 offen offset:1024 lds
    v_mfma_f32_16x16x32_bf16 v[156:159], v[52:55], v[60:63], v[156:159]
    v_mfma_f32_16x16x32_bf16 v[160:163], v[52:55], v[64:67], v[160:163]
    s_add_u32 s57, s57, 0x20000
    v_mfma_f32_16x16x32_bf16 v[164:167], v[52:55], v[68:71], v[164:167]
    s_waitcnt lgkmcnt(0)
    s_waitcnt vmcnt(8)
    s_barrier
    v_mfma_f32_16x16x32_bf16 v[104:107], v[72:75], v[88:91], v[104:107]
    ds_read_b64_tr_b16 v[40:41], v10 offset:0
    s_add_u32 m0, s58, 0x18000
    v_mfma_f32_16x16x32_bf16 v[108:111], v[72:75], v[92:95], v[108:111]
    ds_read_b64_tr_b16 v[42:43], v10 offset:1024
    v_mfma_f32_16x16x32_bf16 v[112:115], v[72:75], v[96:99], v[112:115]
    ds_read_b64_tr_b16 v[44:45], v11 offset:0
    buffer_load_dwordx4 v2, s[12:15], s56 offen offset:0 sc1 lds
    v_mfma_f32_16x16x32_bf16 v[116:119], v[72:75], v[100:103], v[116:119]
    ds_read_b64_tr_b16 v[46:47], v11 offset:1024
    v_mfma_f32_16x16x32_bf16 v[120:123], v[76:79], v[88:91], v[120:123]
    ds_read_b64_tr_b16 v[48:49], v12 offset:0
    buffer_load_dwordx4 v3, s[12:15], s56 offen offset:1024 sc1 lds
    v_mfma_f32_16x16x32_bf16 v[124:127], v[76:79], v[92:95], v[124:127]
    ds_read_b64_tr_b16 v[50:51], v12 offset:1024
    v_mfma_f32_16x16x32_bf16 v[128:131], v[76:79], v[96:99], v[128:131]
    ds_read_b64_tr_b16 v[52:53], v13 offset:0
    s_add_u32 s56, s56, 128
    v_mfma_f32_16x16x32_bf16 v[132:135], v[76:79], v[100:103], v[132:135]
    ds_read_b64_tr_b16 v[54:55], v13 offset:1024
    v_mfma_f32_16x16x32_bf16 v[136:139], v[80:83], v[88:91], v[136:139]
    ds_read_b128 v[56:59], v8 offset:0
    s_add_u32 m0, s58, 0x1c000
    v_mfma_f32_16x16x32_bf16 v[140:143], v[80:83], v[92:95], v[140:143]
    ds_read_b128 v[60:63], v8 offset:2048
    v_mfma_f32_16x16x32_bf16 v[144:147], v[80:83], v[96:99], v[144:147]
    ds_read_b128 v[64:67], v8 offset:4096
    buffer_load_dwordx4 v4, s[16:19], s57 offen offset:0 lds
    v_mfma_f32_16x16x32_bf16 v[148:151], v[80:83], v[100:103], v[148:151]
    ds_read_b128 v[68:71], v8 offset:6144
    v_mfma_f32_16x16x32_bf16 v[152:155], v[84:87], v[88:91], v[152:155]
    buffer_load_dwordx4 v5, s[16:19], s57 offen offset:1024 lds
    v_mfma_f32_16x16x32_bf16 v[156:159], v[84:87], v[92:95], v[156:159]
    v_mfma_f32_16x16x32_bf16 v[160:163], v[84:87], v[96:99], v[160:163]
    s_add_u32 s57, s57, 0x20000
    v_mfma_f32_16x16x32_bf16 v[164:167], v[84:87], v[100:103], v[164:167]
    s_waitcnt lgkmcnt(0)
    s_waitcnt vmcnt(8)
    s_barrier
    v_mfma_f32_16x16x32_bf16 v[104:107], v[40:43], v[56:59], v[104:107]
    ds_read_b64_tr_b16 v[72:73], v10 offset:32768
    s_add_u32 m0, s58, 0x0
    v_mfma_f32_16x16x32_bf16 v[108:111], v[40:43], v[60:63], v[108:111]
    ds_read_b64_tr_b16 v[74:75], v10 offset:33792
    v_mfma_f32_16x16x32_bf16 v[112:115], v[40:43], v[64:67], v[112:115]
    ds_read_b64_tr_b16 v[76:77], v11 offset:32768
    buffer_load_dwordx4 v2, s[12:15], s56 offen offset:0 sc1 lds
    v_mfma_f32_16x16x32_bf16 v[116:119], v[40:43], v[68:71], v[116:119]
    ds_read_b64_tr_b16 v[78:79], v11 offset:33792
    v_mfma_f32_16x16x32_bf16 v[120:123], v[44:47], v[56:59], v[120:123]
    ds_read_b64_tr_b16 v[80:81], v12 offset:32768
    buffer_load_dwordx4 v3, s[12:15], s56 offen offset:1024 sc1 lds
    v_mfma_f32_16x16x32_bf16 v[124:127], v[44:47], v[60:63], v[124:127]
    ds_read_b64_tr_b16 v[82:83], v12 offset:33792
    v_mfma_f32_16x16x32_bf16 v[128:131], v[44:47], v[64:67], v[128:131]
    ds_read_b64_tr_b16 v[84:85], v13 offset:32768
    s_add_u32 s56, s56, 128
    v_mfma_f32_16x16x32_bf16 v[132:135], v[44:47], v[68:71], v[132:135]
    ds_read_b64_tr_b16 v[86:87], v13 offset:33792
    v_mfma_f32_16x16x32_bf16 v[136:139], v[48:51], v[56:59], v[136:139]
    ds_read_b128 v[88:91], v8 offset:32768
    s_add_u32 m0, s58, 0x4000
    v_mfma_f32_16x16x32_bf16 v[140:143], v[48:51], v[60:63], v[140:143]
    ds_read_b128 v[92:95], v8 offset:34816
    v_mfma_f32_16x16x32_bf16 v[144:147], v[48:51], v[64:67], v[144:147]
    ds_read_b128 v[96:99], v8 offset:36864
    buffer_load_dwordx4 v4, s[16:19], s57 offen offset:0 lds
    v_mfma_f32_16x16x32_bf16 v[148:151], v[48:51], v[68:71], v[148:151]
    ds_read_b128 v[100:103], v8 offset:38912
    v_mfma_f32_16x16x32_bf16 v[152:155], v[52:55], v[56:59], v[152:155]
    buffer_load_dwordx4 v5, s[16:19], s57 offen offset:1024 lds
    v_mfma_f32_16x16x32_bf16 v[156:159], v[52:55], v[60:63], v[156:159]
    v_mfma_f32_16x16x32_bf16 v[160:163], v[52:55], v[64:67], v[160:163]
    s_add_u32 s57, s57, 0x20000
    v_mfma_f32_16x16x32_bf16 v[164:167], v[52:55], v[68:71], v[164:167]
    s_waitcnt lgkmcnt(0)
    s_waitcnt vmcnt(8)
    s_barrier
    v_mfma_f32_16x16x32_bf16 v[104:107], v[72:75], v[88:91], v[104:107]
    ds_read_b64_tr_b16 v[40:41], v14 offset:0
    s_add_u32 m0, s58, 0x8000
    v_mfma_f32_16x16x32_bf16 v[108:111], v[72:75], v[92:95], v[108:111]
    ds_read_b64_tr_b16 v[42:43], v14 offset:1024
    v_mfma_f32_16x16x32_bf16 v[112:115], v[72:75], v[96:99], v[112:115]
    ds_read_b64_tr_b16 v[44:45], v15 offset:0
    buffer_load_dwordx4 v2, s[12:15], s56 offen offset:0 sc1 lds
    v_mfma_f32_16x16x32_bf16 v[116:119], v[72:75], v[100:103], v[116:119]
    ds_read_b64_tr_b16 v[46:47], v15 offset:1024
    v_mfma_f32_16x16x32_bf16 v[120:123], v[76:79], v[88:91], v[120:123]
    ds_read_b64_tr_b16 v[48:49], v16 offset:0
    buffer_load_dwordx4 v3, s[12:15], s56 offen offset:1024 sc1 lds
    v_mfma_f32_16x16x32_bf16 v[124:127], v[76:79], v[92:95], v[124:127]
    ds_read_b64_tr_b16 v[50:51], v16 offset:1024
    v_mfma_f32_16x16x32_bf16 v[128:131], v[76:79], v[96:99], v[128:131]
    ds_read_b64_tr_b16 v[52:53], v17 offset:0
    s_add_u32 s56, s56, 128
    v_mfma_f32_16x16x32_bf16 v[132:135], v[76:79], v[100:103], v[132:135]
    ds_read_b64_tr_b16 v[54:55], v17 offset:1024
    v_mfma_f32_16x16x32_bf16 v[136:139], v[80:83], v[88:91], v[136:139]
    ds_read_b128 v[56:59], v9 offset:0
    s_add_u32 m0, s58, 0xc000
    v_mfma_f32_16x16x32_bf16 v[140:143], v[80:83], v[92:95], v[140:143]
    ds_read_b128 v[60:63], v9 offset:2048
    v_mfma_f32_16x16x32_bf16 v[144:147], v[80:83], v[96:99], v[144:147]
    ds_read_b128 v[64:67], v9 offset:4096
    buffer_load_dwordx4 v4, s[16:19], s57 offen offset:0 lds
    v_mfma_f32_16x16x32_bf16 v[148:151], v[80:83], v[100:103], v[148:151]
    ds_read_b128 v[68:71], v9 offset:6144
    v_mfma_f32_16x16x32_bf16 v[152:155], v[84:87], v[88:91], v[152:155]
    buffer_load_dwordx4 v5, s[16:19], s57 offen offset:1024 lds
    v_mfma_f32_16x16x32_bf16 v[156:159], v[84:87], v[92:95], v[156:159]
    v_mfma_f32_16x16x32_bf16 v[160:163], v[84:87], v[96:99], v[160:163]
    s_add_u32 s57, s57, 0x20000
    v_mfma_f32_16x16x32_bf16 v[164:167], v[84:87], v[100:103], v[164:167]
    s_waitcnt lgkmcnt(0)
    s_waitcnt vmcnt(8)
    s_barrier
    v_mfma_f32_16x16x32_bf16 v[104:107], v[40:43], v[56:59], v[104:107]
    ds_read_b64_tr_b16 v[72:73], v14 offset:32768
    s_add_u32 m0, s58, 0x10000
    v_mfma_f32_16x16x32_bf16 v[108:111], v[40:43], v[60:63], v[108:111]
    ds_read_b64_tr_b16 v[74:75], v14 offset:33792
    v_mfma_f32_16x16x32_bf16 v[112:115], v[40:43], v[64:67], v[112:115]
    ds_read_b64_tr_b16 v[76:77], v15 offset:32768
    buffer_load_dwordx4 v2, s[12:15], s56 offen offset:0 sc1 lds
    v_mfma_f32_16x16x32_bf16 v[116:119], v[40:43], v[68:71], v[116:119]
    ds_read_b64_tr_b16 v[78:79], v15 offset:33792
    v_mfma_f32_16x16x32_bf16 v[120:123], v[44:47], v[56:59], v[120:123]
    ds_read_b64_tr_b16 v[80:81], v16 offset:32768
    buffer_load_dwordx4 v3, s[12:15], s56 offen offset:1024 sc1 lds
    v_mfma_f32_16x16x32_bf16 v[124:127], v[44:47], v[60:63], v[124:127]
    ds_read_b64_tr_b16 v[82:83], v16 offset:33792
    v_mfma_f32_16x16x32_bf16 v[128:131], v[44:47], v[64:67], v[128:131]
    ds_read_b64_tr_b16 v[84:85], v17 offset:32768
    s_add_u32 s56, s56, 128
    v_mfma_f32_16x16x32_bf16 v[132:135], v[44:47], v[68:71], v[132:135]
    ds_read_b64_tr_b16 v[86:87], v17 offset:33792
    v_mfma_f32_16x16x32_bf16 v[136:139], v[48:51], v[56:59], v[136:139]
    ds_read_b128 v[88:91], v9 offset:32768
    s_add_u32 m0, s58, 0x14000
    v_mfma_f32_16x16x32_bf16 v[140:143], v[48:51], v[60:63], v[140:143]
    ds_read_b128 v[92:95], v9 offset:34816
    v_mfma_f32_16x16x32_bf16 v[144:147], v[48:51], v[64:67], v[144:147]
    ds_read_b128 v[96:99], v9 offset:36864
    buffer_load_dwordx4 v4, s[16:19], s57 offen offset:0 lds
    v_mfma_f32_16x16x32_bf16 v[148:151], v[48:51], v[68:71], v[148:151]
    ds_read_b128 v[100:103], v9 offset:38912
    v_mfma_f32_16x16x32_bf16 v[152:155], v[52:55], v[56:59], v[152:155]
    buffer_load_dwordx4 v5, s[16:19], s57 offen offset:1024 lds
    v_mfma_f32_16x16x32_bf16 v[156:159], v[52:55], v[60:63], v[156:159]
    v_mfma_f32_16x16x32_bf16 v[160:163], v[52:55], v[64:67], v[160:163]
    s_add_u32 s57, s57, 0x20000
    v_mfma_f32_16x16x32_bf16 v[164:167], v[52:55], v[68:71], v[164:167]
    s_waitcnt lgkmcnt(0)
    s_waitcnt vmcnt(8)
    s_barrier
    v_mfma_f32_16x16x32_bf16 v[104:107], v[72:75], v[88:91], v[104:107]
    ds_read_b64_tr_b16 v[40:41], v10 offset:0
    s_add_u32 m0, s58, 0x18000
    v_mfma_f32_16x16x32_bf16 v[108:111], v[72:75], v[92:95], v[108:111]
    ds_read_b64_tr_b16 v[42:43], v10 offset:1024
    v_mfma_f32_16x16x32_bf16 v[112:115], v[72:75], v[96:99], v[112:115]
    ds_read_b64_tr_b16 v[44:45], v11 offset:0
    buffer_load_dwordx4 v2, s[12:15], s56 offen offset:0 sc1 lds
    v_mfma_f32_16x16x32_bf16 v[116:119], v[72:75], v[100:103], v[116:119]
    ds_read_b64_tr_b16 v[46:47], v11 offset:1024
    v_mfma_f32_16x16x32_bf16 v[120:123], v[76:79], v[88:91], v[120:123]
    ds_read_b64_tr_b16 v[48:49], v12 offset:0
    buffer_load_dwordx4 v3, s[12:15], s56 offen offset:1024 sc1 lds
    v_mfma_f32_16x16x32_bf16 v[124:127], v[76:79], v[92:95], v[124:127]
    ds_read_b64_tr_b16 v[50:51], v12 offset:1024
    v_mfma_f32_16x16x32_bf16 v[128:131], v[76:79], v[96:99], v[128:131]
    ds_read_b64_tr_b16 v[52:53], v13 offset:0
    s_add_u32 s56, s56, 128
    v_mfma_f32_16x16x32_bf16 v[132:135], v[76:79], v[100:103], v[132:135]
    ds_read_b64_tr_b16 v[54:55], v13 offset:1024
    v_mfma_f32_16x16x32_bf16 v[136:139], v[80:83], v[88:91], v[136:139]
    ds_read_b128 v[56:59], v8 offset:0
    s_add_u32 m0, s58, 0x1c000
    v_mfma_f32_16x16x32_bf16 v[140:143], v[80:83], v[92:95], v[140:143]
    ds_read_b128 v[60:63], v8 offset:2048
    v_mfma_f32_16x16x32_bf16 v[144:147], v[80:83], v[96:99], v[144:147]
    ds_read_b128 v[64:67], v8 offset:4096
    buffer_load_dwordx4 v4, s[16:19], s57 offen offset:0 lds
    v_mfma_f32_16x16x32_bf16 v[148:151], v[80:83], v[100:103], v[148:151]
    ds_read_b128 v[68:71], v8 offset:6144
    v_mfma_f32_16x16x32_bf16 v[152:155], v[84:87], v[88:91], v[152:155]
    buffer_load_dwordx4 v5, s[16:19], s57 offen offset:1024 lds
    v_mfma_f32_16x16x32_bf16 v[156:159], v[84:87], v[92:95], v[156:159]
    v_mfma_f32_16x16x32_bf16 v[160:163], v[84:87], v[96:99], v[160:163]
    s_add_u32 s57, s57, 0x20000
    v_mfma_f32_16x16x32_bf16 v[164:167], v[84:87], v[100:103], v[164:167]
    s_waitcnt lgkmcnt(0)
    s_waitcnt vmcnt(8)
    s_barrier
    v_mfma_f32_16x16x32_bf16 v[104:107], v[40:43], v[56:59], v[104:107]
    ds_read_b64_tr_b16 v[72:73], v10 offset:32768
    s_add_u32 m0, s58, 0x0
    v_mfma_f32_16x16x32_bf16 v[108:111], v[40:43], v[60:63], v[108:111]
    ds_read_b64_tr_b16 v[74:75], v10 offset:33792
    v_mfma_f32_16x16x32_bf16 v[112:115], v[40:43], v[64:67], v[112:115]
    ds_read_b64_tr_b16 v[76:77], v11 offset:32768
    buffer_load_dwordx4 v2, s[12:15], s56 offen offset:0 sc1 lds
    v_mfma_f32_16x16x32_bf16 v[116:119], v[40:43], v[68:71], v[116:119]
    ds_read_b64_tr_b16 v[78:79], v11 offset:33792
    v_mfma_f32_16x16x32_bf16 v[120:123], v[44:47], v[56:59], v[120:123]
    ds_read_b64_tr_b16 v[80:81], v12 offset:32768
    buffer_load_dwordx4 v3, s[12:15], s56 offen offset:1024 sc1 lds
    v_mfma_f32_16x16x32_bf16 v[124:127], v[44:47], v[60:63], v[124:127]
    ds_read_b64_tr_b16 v[82:83], v12 offset:33792
    v_mfma_f32_16x16x32_bf16 v[128:131], v[44:47], v[64:67], v[128:131]
    ds_read_b64_tr_b16 v[84:85], v13 offset:32768
    s_add_u32 s56, s56, 128
    v_mfma_f32_16x16x32_bf16 v[132:135], v[44:47], v[68:71], v[132:135]
    ds_read_b64_tr_b16 v[86:87], v13 offset:33792
    v_mfma_f32_16x16x32_bf16 v[136:139], v[48:51], v[56:59], v[136:139]
    ds_read_b128 v[88:91], v8 offset:32768
    s_add_u32 m0, s58, 0x4000
    v_mfma_f32_16x16x32_bf16 v[140:143], v[48:51], v[60:63], v[140:143]
    ds_read_b128 v[92:95], v8 offset:34816
    v_mfma_f32_16x16x32_bf16 v[144:147], v[48:51], v[64:67], v[144:147]
    ds_read_b128 v[96:99], v8 offset:36864
    buffer_load_dwordx4 v4, s[16:19], s57 offen offset:0 lds
    v_mfma_f32_16x16x32_bf16 v[148:151], v[48:51], v[68:71], v[148:151]
    ds_read_b128 v[100:103], v8 offset:38912
    v_mfma_f32_16x16x32_bf16 v[152:155], v[52:55], v[56:59], v[152:155]
    buffer_load_dwordx4 v5, s[16:19], s57 offen offset:1024 lds
    v_mfma_f32_16x16x32_bf16 v[156:159], v[52:55], v[60:63], v[156:159]
    v_mfma_f32_16x16x32_bf16 v[160:163], v[52:55], v[64:67], v[160:163]
    s_add_u32 s57, s57, 0x20000
    v_mfma_f32_16x16x32_bf16 v[164:167], v[52:55], v[68:71], v[164:167]
    s_waitcnt lgkmcnt(0)
    s_waitcnt vmcnt(8)
    s_barrier
    v_mfma_f32_16x16x32_bf16 v[104:107], v[72:75], v[88:91], v[104:107]
    ds_read_b64_tr_b16 v[40:41], v14 offset:0
    s_add_u32 m0, s58, 0x8000
    v_mfma_f32_16x16x32_bf16 v[108:111], v[72:75], v[92:95], v[108:111]
    ds_read_b64_tr_b16 v[42:43], v14 offset:1024
    v_mfma_f32_16x16x32_bf16 v[112:115], v[72:75], v[96:99], v[112:115]
    ds_read_b64_tr_b16 v[44:45], v15 offset:0
    buffer_load_dwordx4 v2, s[12:15], s56 offen offset:0 sc1 lds
    v_mfma_f32_16x16x32_bf16 v[116:119], v[72:75], v[100:103], v[116:119]
    ds_read_b64_tr_b16 v[46:47], v15 offset:1024
    v_mfma_f32_16x16x32_bf16 v[120:123], v[76:79], v[88:91], v[120:123]
    ds_read_b64_tr_b16 v[48:49], v16 offset:0
    buffer_load_dwordx4 v3, s[12:15], s56 offen offset:1024 sc1 lds
    v_mfma_f32_16x16x32_bf16 v[124:127], v[76:79], v[92:95], v[124:127]
    ds_read_b64_tr_b16 v[50:51], v16 offset:1024
    v_mfma_f32_16x16x32_bf16 v[128:131], v[76:79], v[96:99], v[128:131]
    ds_read_b64_tr_b16 v[52:53], v17 offset:0
    s_add_u32 s56, s56, 128
    v_mfma_f32_16x16x32_bf16 v[132:135], v[76:79], v[100:103], v[132:135]
    ds_read_b64_tr_b16 v[54:55], v17 offset:1024
    v_mfma_f32_16x16x32_bf16 v[136:139], v[80:83], v[88:91], v[136:139]
    ds_read_b128 v[56:59], v9 offset:0
    s_add_u32 m0, s58, 0xc000
    v_mfma_f32_16x16x32_bf16 v[140:143], v[80:83], v[92:95], v[140:143]
    ds_read_b128 v[60:63], v9 offset:2048
    v_mfma_f32_16x16x32_bf16 v[144:147], v[80:83], v[96:99], v[144:147]
    ds_read_b128 v[64:67], v9 offset:4096
    buffer_load_dwordx4 v4, s[16:19], s57 offen offset:0 lds
    v_mfma_f32_16x16x32_bf16 v[148:151], v[80:83], v[100:103], v[148:151]
    ds_read_b128 v[68:71], v9 offset:6144
    v_mfma_f32_16x16x32_bf16 v[152:155], v[84:87], v[88:91], v[152:155]
    buffer_load_dwordx4 v5, s[16:19], s57 offen offset:1024 lds
    v_mfma_f32_16x16x32_bf16 v[156:159], v[84:87], v[92:95], v[156:159]
    v_mfma_f32_16x16x32_bf16 v[160:163], v[84:87], v[96:99], v[160:163]
    s_add_u32 s57, s57, 0x20000
    v_mfma_f32_16x16x32_bf16 v[164:167], v[84:87], v[100:103], v[164:167]
    s_waitcnt lgkmcnt(0)
    s_waitcnt vmcnt(8)
    s_barrier
    v_mfma_f32_16x16x32_bf16 v[104:107], v[40:43], v[56:59], v[104:107]
    ds_read_b64_tr_b16 v[72:73], v14 offset:32768
    s_add_u32 m0, s58, 0x10000
    v_mfma_f32_16x16x32_bf16 v[108:111], v[40:43], v[60:63], v[108:111]
    ds_read_b64_tr_b16 v[74:75], v14 offset:33792
    v_mfma_f32_16x16x32_bf16 v[112:115], v[40:43], v[64:67], v[112:115]
    ds_read_b64_tr_b16 v[76:77], v15 offset:32768
    buffer_load_dwordx4 v2, s[12:15], s56 offen offset:0 sc1 lds
    v_mfma_f32_16x16x32_bf16 v[116:119], v[40:43], v[68:71], v[116:119]
    ds_read_b64_tr_b16 v[78:79], v15 offset:33792
    v_mfma_f32_16x16x32_bf16 v[120:123], v[44:47], v[56:59], v[120:123]
    ds_read_b64_tr_b16 v[80:81], v16 offset:32768
    buffer_load_dwordx4 v3, s[12:15], s56 offen offset:1024 sc1 lds
    v_mfma_f32_16x16x32_bf16 v[124:127], v[44:47], v[60:63], v[124:127]
    ds_read_b64_tr_b16 v[82:83], v16 offset:33792
    v_mfma_f32_16x16x32_bf16 v[128:131], v[44:47], v[64:67], v[128:131]
    ds_read_b64_tr_b16 v[84:85], v17 offset:32768
    s_add_u32 s56, s56, 128
    v_mfma_f32_16x16x32_bf16 v[132:135], v[44:47], v[68:71], v[132:135]
    ds_read_b64_tr_b16 v[86:87], v17 offset:33792
    v_mfma_f32_16x16x32_bf16 v[136:139], v[48:51], v[56:59], v[136:139]
    ds_read_b128 v[88:91], v9 offset:32768
    s_add_u32 m0, s58, 0x14000
    v_mfma_f32_16x16x32_bf16 v[140:143], v[48:51], v[60:63], v[140:143]
    ds_read_b128 v[92:95], v9 offset:34816
    v_mfma_f32_16x16x32_bf16 v[144:147], v[48:51], v[64:67], v[144:147]
    ds_read_b128 v[96:99], v9 offset:36864
    buffer_load_dwordx4 v4, s[16:19], s57 offen offset:0 lds
    v_mfma_f32_16x16x32_bf16 v[148:151], v[48:51], v[68:71], v[148:151]
    ds_read_b128 v[100:103], v9 offset:38912
    v_mfma_f32_16x16x32_bf16 v[152:155], v[52:55], v[56:59], v[152:155]
    buffer_load_dwordx4 v5, s[16:19], s57 offen offset:1024 lds
    v_mfma_f32_16x16x32_bf16 v[156:159], v[52:55], v[60:63], v[156:159]
    v_mfma_f32_16x16x32_bf16 v[160:163], v[52:55], v[64:67], v[160:163]
    s_add_u32 s57, s57, 0x20000
    v_mfma_f32_16x16x32_bf16 v[164:167], v[52:55], v[68:71], v[164:167]
    s_waitcnt lgkmcnt(0)
    s_waitcnt vmcnt(8)
    s_barrier
    v_mfma_f32_16x16x32_bf16 v[104:107], v[72:75], v[88:91], v[104:107]
    ds_read_b64_tr_b16 v[40:41], v10 offset:0
    s_add_u32 m0, s58, 0x18000
    v_mfma_f32_16x16x32_bf16 v[108:111], v[72:75], v[92:95], v[108:111]
    ds_read_b64_tr_b16 v[42:43], v10 offset:1024
    v_mfma_f32_16x16x32_bf16 v[112:115], v[72:75], v[96:99], v[112:115]
    ds_read_b64_tr_b16 v[44:45], v11 offset:0
    buffer_load_dwordx4 v2, s[12:15], s56 offen offset:0 sc1 lds
    v_mfma_f32_16x16x32_bf16 v[116:119], v[72:75], v[100:103], v[116:119]
    ds_read_b64_tr_b16 v[46:47], v11 offset:1024
    v_mfma_f32_16x16x32_bf16 v[120:123], v[76:79], v[88:91], v[120:123]
    ds_read_b64_tr_b16 v[48:49], v12 offset:0
    buffer_load_dwordx4 v3, s[12:15], s56 offen offset:1024 sc1 lds
    v_mfma_f32_16x16x32_bf16 v[124:127], v[76:79], v[92:95], v[124:127]
    ds_read_b64_tr_b16 v[50:51], v12 offset:1024
    v_mfma_f32_16x16x32_bf16 v[128:131], v[76:79], v[96:99], v[128:131]
    ds_read_b64_tr_b16 v[52:53], v13 offset:0
    s_add_u32 s56, s56, 128
    v_mfma_f32_16x16x32_bf16 v[132:135], v[76:79], v[100:103], v[132:135]
    ds_read_b64_tr_b16 v[54:55], v13 offset:1024
    v_mfma_f32_16x16x32_bf16 v[136:139], v[80:83], v[88:91], v[136:139]
    ds_read_b128 v[56:59], v8 offset:0
    s_add_u32 m0, s58, 0x1c000
    v_mfma_f32_16x16x32_bf16 v[140:143], v[80:83], v[92:95], v[140:143]
    ds_read_b128 v[60:63], v8 offset:2048
    v_mfma_f32_16x16x32_bf16 v[144:147], v[80:83], v[96:99], v[144:147]
    ds_read_b128 v[64:67], v8 offset:4096
    buffer_load_dwordx4 v4, s[16:19], s57 offen offset:0 lds
    v_mfma_f32_16x16x32_bf16 v[148:151], v[80:83], v[100:103], v[148:151]
    ds_read_b128 v[68:71], v8 offset:6144
    v_mfma_f32_16x16x32_bf16 v[152:155], v[84:87], v[88:91], v[152:155]
    buffer_load_dwordx4 v5, s[16:19], s57 offen offset:1024 lds
    v_mfma_f32_16x16x32_bf16 v[156:159], v[84:87], v[92:95], v[156:159]
    v_mfma_f32_16x16x32_bf16 v[160:163], v[84:87], v[96:99], v[160:163]
    s_add_u32 s57, s57, 0x20000
    v_mfma_f32_16x16x32_bf16 v[164:167], v[84:87], v[100:103], v[164:167]
    s_waitcnt lgkmcnt(0)
    s_waitcnt vmcnt(8)
    s_barrier
    v_mfma_f32_16x16x32_bf16 v[104:107], v[40:43], v[56:59], v[104:107]
    ds_read_b64_tr_b16 v[72:73], v10 offset:32768
    s_add_u32 m0, s58, 0x0
    v_mfma_f32_16x16x32_bf16 v[108:111], v[40:43], v[60:63], v[108:111]
    ds_read_b64_tr_b16 v[74:75], v10 offset:33792
    v_mfma_f32_16x16x32_bf16 v[112:115], v[40:43], v[64:67], v[112:115]
    ds_read_b64_tr_b16 v[76:77], v11 offset:32768
    buffer_load_dwordx4 v2, s[12:15], s56 offen offset:0 sc1 lds
    v_mfma_f32_16x16x32_bf16 v[116:119], v[40:43], v[68:71], v[116:119]
    ds_read_b64_tr_b16 v[78:79], v11 offset:33792
    v_mfma_f32_16x16x32_bf16 v[120:123], v[44:47], v[56:59], v[120:123]
    ds_read_b64_tr_b16 v[80:81], v12 offset:32768
    buffer_load_dwordx4 v3, s[12:15], s56 offen offset:1024 sc1 lds
    v_mfma_f32_16x16x32_bf16 v[124:127], v[44:47], v[60:63], v[124:127]
    ds_read_b64_tr_b16 v[82:83], v12 offset:33792
    v_mfma_f32_16x16x32_bf16 v[128:131], v[44:47], v[64:67], v[128:131]
    ds_read_b64_tr_b16 v[84:85], v13 offset:32768
    s_add_u32 s56, s56, 128
    v_mfma_f32_16x16x32_bf16 v[132:135], v[44:47], v[68:71], v[132:135]
    ds_read_b64_tr_b16 v[86:87], v13 offset:33792
    v_mfma_f32_16x16x32_bf16 v[136:139], v[48:51], v[56:59], v[136:139]
    ds_read_b128 v[88:91], v8 offset:32768
    s_add_u32 m0, s58, 0x4000
    v_mfma_f32_16x16x32_bf16 v[140:143], v[48:51], v[60:63], v[140:143]
    ds_read_b128 v[92:95], v8 offset:34816
    v_mfma_f32_16x16x32_bf16 v[144:147], v[48:51], v[64:67], v[144:147]
    ds_read_b128 v[96:99], v8 offset:36864
    buffer_load_dwordx4 v4, s[16:19], s57 offen offset:0 lds
    v_mfma_f32_16x16x32_bf16 v[148:151], v[48:51], v[68:71], v[148:151]
    ds_read_b128 v[100:103], v8 offset:38912
    v_mfma_f32_16x16x32_bf16 v[152:155], v[52:55], v[56:59], v[152:155]
    buffer_load_dwordx4 v5, s[16:19], s57 offen offset:1024 lds
    v_mfma_f32_16x16x32_bf16 v[156:159], v[52:55], v[60:63], v[156:159]
    v_mfma_f32_16x16x32_bf16 v[160:163], v[52:55], v[64:67], v[160:163]
    s_add_u32 s57, s57, 0x20000
    v_mfma_f32_16x16x32_bf16 v[164:167], v[52:55], v[68:71], v[164:167]
    s_waitcnt lgkmcnt(0)
    s_waitcnt vmcnt(8)
    s_barrier
    v_mfma_f32_16x16x32_bf16 v[104:107], v[72:75], v[88:91], v[104:107]
    ds_read_b64_tr_b16 v[40:41], v14 offset:0
    s_add_u32 m0, s58, 0x8000
    v_mfma_f32_16x16x32_bf16 v[108:111], v[72:75], v[92:95], v[108:111]
    ds_read_b64_tr_b16 v[42:43], v14 offset:1024
    v_mfma_f32_16x16x32_bf16 v[112:115], v[72:75], v[96:99], v[112:115]
    ds_read_b64_tr_b16 v[44:45], v15 offset:0
    buffer_load_dwordx4 v2, s[12:15], s56 offen offset:0 sc1 lds
    v_mfma_f32_16x16x32_bf16 v[116:119], v[72:75], v[100:103], v[116:119]
    ds_read_b64_tr_b16 v[46:47], v15 offset:1024
    v_mfma_f32_16x16x32_bf16 v[120:123], v[76:79], v[88:91], v[120:123]
    ds_read_b64_tr_b16 v[48:49], v16 offset:0
    buffer_load_dwordx4 v3, s[12:15], s56 offen offset:1024 sc1 lds
    v_mfma_f32_16x16x32_bf16 v[124:127], v[76:79], v[92:95], v[124:127]
    ds_read_b64_tr_b16 v[50:51], v16 offset:1024
    v_mfma_f32_16x16x32_bf16 v[128:131], v[76:79], v[96:99], v[128:131]
    ds_read_b64_tr_b16 v[52:53], v17 offset:0
    s_add_u32 s56, s56, 128
    v_mfma_f32_16x16x32_bf16 v[132:135], v[76:79], v[100:103], v[132:135]
    ds_read_b64_tr_b16 v[54:55], v17 offset:1024
    v_mfma_f32_16x16x32_bf16 v[136:139], v[80:83], v[88:91], v[136:139]
    ds_read_b128 v[56:59], v9 offset:0
    s_add_u32 m0, s58, 0xc000
    v_mfma_f32_16x16x32_bf16 v[140:143], v[80:83], v[92:95], v[140:143]
    ds_read_b128 v[60:63], v9 offset:2048
    v_mfma_f32_16x16x32_bf16 v[144:147], v[80:83], v[96:99], v[144:147]
    ds_read_b128 v[64:67], v9 offset:4096
    buffer_load_dwordx4 v4, s[16:19], s57 offen offset:0 lds
    v_mfma_f32_16x16x32_bf16 v[148:151], v[80:83], v[100:103], v[148:151]
    ds_read_b128 v[68:71], v9 offset:6144
    v_mfma_f32_16x16x32_bf16 v[152:155], v[84:87], v[88:91], v[152:155]
    buffer_load_dwordx4 v5, s[16:19], s57 offen offset:1024 lds
    v_mfma_f32_16x16x32_bf16 v[156:159], v[84:87], v[92:95], v[156:159]
    v_mfma_f32_16x16x32_bf16 v[160:163], v[84:87], v[96:99], v[160:163]
    s_add_u32 s57, s57, 0x20000
    v_mfma_f32_16x16x32_bf16 v[164:167], v[84:87], v[100:103], v[164:167]
    s_waitcnt lgkmcnt(0)
    s_waitcnt vmcnt(8)
    s_barrier
    v_mfma_f32_16x16x32_bf16 v[104:107], v[40:43], v[56:59], v[104:107]
    ds_read_b64_tr_b16 v[72:73], v14 offset:32768
    s_add_u32 m0, s58, 0x10000
    v_mfma_f32_16x16x32_bf16 v[108:111], v[40:43], v[60:63], v[108:111]
    ds_read_b64_tr_b16 v[74:75], v14 offset:33792
    v_mfma_f32_16x16x32_bf16 v[112:115], v[40:43], v[64:67], v[112:115]
    ds_read_b64_tr_b16 v[76:77], v15 offset:32768
    buffer_load_dwordx4 v2, s[12:15], s56 offen offset:0 sc1 lds
    v_mfma_f32_16x16x32_bf16 v[116:119], v[40:43], v[68:71], v[116:119]
    ds_read_b64_tr_b16 v[78:79], v15 offset:33792
    v_mfma_f32_16x16x32_bf16 v[120:123], v[44:47], v[56:59], v[120:123]
    ds_read_b64_tr_b16 v[80:81], v16 offset:32768
    buffer_load_dwordx4 v3, s[12:15], s56 offen offset:1024 sc1 lds
    v_mfma_f32_16x16x32_bf16 v[124:127], v[44:47], v[60:63], v[124:127]
    ds_read_b64_tr_b16 v[82:83], v16 offset:33792
    v_mfma_f32_16x16x32_bf16 v[128:131], v[44:47], v[64:67], v[128:131]
    ds_read_b64_tr_b16 v[84:85], v17 offset:32768
    s_add_u32 s56, s56, 128
    v_mfma_f32_16x16x32_bf16 v[132:135], v[44:47], v[68:71], v[132:135]
    ds_read_b64_tr_b16 v[86:87], v17 offset:33792
    v_mfma_f32_16x16x32_bf16 v[136:139], v[48:51], v[56:59], v[136:139]
    ds_read_b128 v[88:91], v9 offset:32768
    s_add_u32 m0, s58, 0x14000
    v_mfma_f32_16x16x32_bf16 v[140:143], v[48:51], v[60:63], v[140:143]
    ds_read_b128 v[92:95], v9 offset:34816
    v_mfma_f32_16x16x32_bf16 v[144:147], v[48:51], v[64:67], v[144:147]
    ds_read_b128 v[96:99], v9 offset:36864
    buffer_load_dwordx4 v4, s[16:19], s57 offen offset:0 lds
    v_mfma_f32_16x16x32_bf16 v[148:151], v[48:51], v[68:71], v[148:151]
    ds_read_b128 v[100:103], v9 offset:38912
    v_mfma_f32_16x16x32_bf16 v[152:155], v[52:55], v[56:59], v[152:155]
    buffer_load_dwordx4 v5, s[16:19], s57 offen offset:1024 lds
    v_mfma_f32_16x16x32_bf16 v[156:159], v[52:55], v[60:63], v[156:159]
    v_mfma_f32_16x16x32_bf16 v[160:163], v[52:55], v[64:67], v[160:163]
    s_add_u32 s57, s57, 0x20000
    v_mfma_f32_16x16x32_bf16 v[164:167], v[52:55], v[68:71], v[164:167]
    s_waitcnt lgkmcnt(0)
    s_waitcnt vmcnt(8)
    s_barrier
    v_mfma_f32_16x16x32_bf16 v[104:107], v[72:75], v[88:91], v[104:107]
    ds_read_b64_tr_b16 v[40:41], v10 offset:0
    s_add_u32 m0, s58, 0x18000
    v_mfma_f32_16x16x32_bf16 v[108:111], v[72:75], v[92:95], v[108:111]
    ds_read_b64_tr_b16 v[42:43], v10 offset:1024
    v_mfma_f32_16x16x32_bf16 v[112:115], v[72:75], v[96:99], v[112:115]
    ds_read_b64_tr_b16 v[44:45], v11 offset:0
    buffer_load_dwordx4 v2, s[12:15], s56 offen offset:0 sc1 lds
    v_mfma_f32_16x16x32_bf16 v[116:119], v[72:75], v[100:103], v[116:119]
    ds_read_b64_tr_b16 v[46:47], v11 offset:1024
    v_mfma_f32_16x16x32_bf16 v[120:123], v[76:79], v[88:91], v[120:123]
    ds_read_b64_tr_b16 v[48:49], v12 offset:0
    buffer_load_dwordx4 v3, s[12:15], s56 offen offset:1024 sc1 lds
    v_mfma_f32_16x16x32_bf16 v[124:127], v[76:79], v[92:95], v[124:127]
    ds_read_b64_tr_b16 v[50:51], v12 offset:1024
    v_mfma_f32_16x16x32_bf16 v[128:131], v[76:79], v[96:99], v[128:131]
    ds_read_b64_tr_b16 v[52:53], v13 offset:0
    s_add_u32 s56, s56, 128
    v_mfma_f32_16x16x32_bf16 v[132:135], v[76:79], v[100:103], v[132:135]
    ds_read_b64_tr_b16 v[54:55], v13 offset:1024
    v_mfma_f32_16x16x32_bf16 v[136:139], v[80:83], v[88:91], v[136:139]
    ds_read_b128 v[56:59], v8 offset:0
    s_add_u32 m0, s58, 0x1c000
    v_mfma_f32_16x16x32_bf16 v[140:143], v[80:83], v[92:95], v[140:143]
    ds_read_b128 v[60:63], v8 offset:2048
    v_mfma_f32_16x16x32_bf16 v[144:147], v[80:83], v[96:99], v[144:147]
    ds_read_b128 v[64:67], v8 offset:4096
    buffer_load_dwordx4 v4, s[16:19], s57 offen offset:0 lds
    v_mfma_f32_16x16x32_bf16 v[148:151], v[80:83], v[100:103], v[148:151]
    ds_read_b128 v[68:71], v8 offset:6144
    v_mfma_f32_16x16x32_bf16 v[152:155], v[84:87], v[88:91], v[152:155]
    buffer_load_dwordx4 v5, s[16:19], s57 offen offset:1024 lds
    v_mfma_f32_16x16x32_bf16 v[156:159], v[84:87], v[92:95], v[156:159]
    v_mfma_f32_16x16x32_bf16 v[160:163], v[84:87], v[96:99], v[160:163]
    s_add_u32 s57, s57, 0x20000
    v_mfma_f32_16x16x32_bf16 v[164:167], v[84:87], v[100:103], v[164:167]
    s_waitcnt lgkmcnt(0)
    s_waitcnt vmcnt(8)
    s_barrier
    v_mfma_f32_16x16x32_bf16 v[104:107], v[40:43], v[56:59], v[104:107]
    ds_read_b64_tr_b16 v[72:73], v10 offset:32768
    s_add_u32 m0, s58, 0x0
    v_mfma_f32_16x16x32_bf16 v[108:111], v[40:43], v[60:63], v[108:111]
    ds_read_b64_tr_b16 v[74:75], v10 offset:33792
    v_mfma_f32_16x16x32_bf16 v[112:115], v[40:43], v[64:67], v[112:115]
    ds_read_b64_tr_b16 v[76:77], v11 offset:32768
    buffer_load_dwordx4 v2, s[12:15], s56 offen offset:0 sc1 lds
    v_mfma_f32_16x16x32_bf16 v[116:119], v[40:43], v[68:71], v[116:119]
    ds_read_b64_tr_b16 v[78:79], v11 offset:33792
    v_mfma_f32_16x16x32_bf16 v[120:123], v[44:47], v[56:59], v[120:123]
    ds_read_b64_tr_b16 v[80:81], v12 offset:32768
    buffer_load_dwordx4 v3, s[12:15], s56 offen offset:1024 sc1 lds
    v_mfma_f32_16x16x32_bf16 v[124:127], v[44:47], v[60:63], v[124:127]
    ds_read_b64_tr_b16 v[82:83], v12 offset:33792
    v_mfma_f32_16x16x32_bf16 v[128:131], v[44:47], v[64:67], v[128:131]
    ds_read_b64_tr_b16 v[84:85], v13 offset:32768
    s_add_u32 s56, s56, 128
    v_mfma_f32_16x16x32_bf16 v[132:135], v[44:47], v[68:71], v[132:135]
    ds_read_b64_tr_b16 v[86:87], v13 offset:33792
    v_mfma_f32_16x16x32_bf16 v[136:139], v[48:51], v[56:59], v[136:139]
    ds_read_b128 v[88:91], v8 offset:32768
    s_add_u32 m0, s58, 0x4000
    v_mfma_f32_16x16x32_bf16 v[140:143], v[48:51], v[60:63], v[140:143]
    ds_read_b128 v[92:95], v8 offset:34816
    v_mfma_f32_16x16x32_bf16 v[144:147], v[48:51], v[64:67], v[144:147]
    ds_read_b128 v[96:99], v8 offset:36864
    buffer_load_dwordx4 v4, s[16:19], s57 offen offset:0 lds
    v_mfma_f32_16x16x32_bf16 v[148:151], v[48:51], v[68:71], v[148:151]
    ds_read_b128 v[100:103], v8 offset:38912
    v_mfma_f32_16x16x32_bf16 v[152:155], v[52:55], v[56:59], v[152:155]
    buffer_load_dwordx4 v5, s[16:19], s57 offen offset:1024 lds
    v_mfma_f32_16x16x32_bf16 v[156:159], v[52:55], v[60:63], v[156:159]
    v_mfma_f32_16x16x32_bf16 v[160:163], v[52:55], v[64:67], v[160:163]
    s_add_u32 s57, s57, 0x20000
    v_mfma_f32_16x16x32_bf16 v[164:167], v[52:55], v[68:71], v[164:167]
    s_waitcnt lgkmcnt(0)
    s_waitcnt vmcnt(8)
    s_barrier
    v_mfma_f32_16x16x32_bf16 v[104:107], v[72:75], v[88:91], v[104:107]
    ds_read_b64_tr_b16 v[40:41], v14 offset:0
    s_add_u32 m0, s58, 0x8000
    v_mfma_f32_16x16x32_bf16 v[108:111], v[72:75], v[92:95], v[108:111]
    ds_read_b64_tr_b16 v[42:43], v14 offset:1024
    v_mfma_f32_16x16x32_bf16 v[112:115], v[72:75], v[96:99], v[112:115]
    ds_read_b64_tr_b16 v[44:45], v15 offset:0
    buffer_load_dwordx4 v2, s[12:15], s56 offen offset:0 sc1 lds
    v_mfma_f32_16x16x32_bf16 v[116:119], v[72:75], v[100:103], v[116:119]
    ds_read_b64_tr_b16 v[46:47], v15 offset:1024
    v_mfma_f32_16x16x32_bf16 v[120:123], v[76:79], v[88:91], v[120:123]
    ds_read_b64_tr_b16 v[48:49], v16 offset:0
    buffer_load_dwordx4 v3, s[12:15], s56 offen offset:1024 sc1 lds
    v_mfma_f32_16x16x32_bf16 v[124:127], v[76:79], v[92:95], v[124:127]
    ds_read_b64_tr_b16 v[50:51], v16 offset:1024
    v_mfma_f32_16x16x32_bf16 v[128:131], v[76:79], v[96:99], v[128:131]
    ds_read_b64_tr_b16 v[52:53], v17 offset:0
    s_add_u32 s56, s56, 128
    v_mfma_f32_16x16x32_bf16 v[132:135], v[76:79], v[100:103], v[132:135]
    ds_read_b64_tr_b16 v[54:55], v17 offset:1024
    v_mfma_f32_16x16x32_bf16 v[136:139], v[80:83], v[88:91], v[136:139]
    ds_read_b128 v[56:59], v9 offset:0
    s_add_u32 m0, s58, 0xc000
    v_mfma_f32_16x16x32_bf16 v[140:143], v[80:83], v[92:95], v[140:143]
    ds_read_b128 v[60:63], v9 offset:2048
    v_mfma_f32_16x16x32_bf16 v[144:147], v[80:83], v[96:99], v[144:147]
    ds_read_b128 v[64:67], v9 offset:4096
    buffer_load_dwordx4 v4, s[16:19], s57 offen offset:0 lds
    v_mfma_f32_16x16x32_bf16 v[148:151], v[80:83], v[100:103], v[148:151]
    ds_read_b128 v[68:71], v9 offset:6144
    v_mfma_f32_16x16x32_bf16 v[152:155], v[84:87], v[88:91], v[152:155]
    buffer_load_dwordx4 v5, s[16:19], s57 offen offset:1024 lds
    v_mfma_f32_16x16x32_bf16 v[156:159], v[84:87], v[92:95], v[156:159]
    v_mfma_f32_16x16x32_bf16 v[160:163], v[84:87], v[96:99], v[160:163]
    s_add_u32 s57, s57, 0x20000
    v_mfma_f32_16x16x32_bf16 v[164:167], v[84:87], v[100:103], v[164:167]
    s_waitcnt lgkmcnt(0)
    s_waitcnt vmcnt(8)
    s_barrier
    v_mfma_f32_16x16x32_bf16 v[104:107], v[40:43], v[56:59], v[104:107]
    ds_read_b64_tr_b16 v[72:73], v14 offset:32768
    s_add_u32 m0, s58, 0x10000
    v_mfma_f32_16x16x32_bf16 v[108:111], v[40:43], v[60:63], v[108:111]
    ds_read_b64_tr_b16 v[74:75], v14 offset:33792
    v_mfma_f32_16x16x32_bf16 v[112:115], v[40:43], v[64:67], v[112:115]
    ds_read_b64_tr_b16 v[76:77], v15 offset:32768
    buffer_load_dwordx4 v2, s[12:15], s56 offen offset:0 sc1 lds
    v_mfma_f32_16x16x32_bf16 v[116:119], v[40:43], v[68:71], v[116:119]
    ds_read_b64_tr_b16 v[78:79], v15 offset:33792
    v_mfma_f32_16x16x32_bf16 v[120:123], v[44:47], v[56:59], v[120:123]
    ds_read_b64_tr_b16 v[80:81], v16 offset:32768
    buffer_load_dwordx4 v3, s[12:15], s56 offen offset:1024 sc1 lds
    v_mfma_f32_16x16x32_bf16 v[124:127], v[44:47], v[60:63], v[124:127]
    ds_read_b64_tr_b16 v[82:83], v16 offset:33792
    v_mfma_f32_16x16x32_bf16 v[128:131], v[44:47], v[64:67], v[128:131]
    ds_read_b64_tr_b16 v[84:85], v17 offset:32768
    s_add_u32 s56, s56, 128
    v_mfma_f32_16x16x32_bf16 v[132:135], v[44:47], v[68:71], v[132:135]
    ds_read_b64_tr_b16 v[86:87], v17 offset:33792
    v_mfma_f32_16x16x32_bf16 v[136:139], v[48:51], v[56:59], v[136:139]
    ds_read_b128 v[88:91], v9 offset:32768
    s_add_u32 m0, s58, 0x14000
    v_mfma_f32_16x16x32_bf16 v[140:143], v[48:51], v[60:63], v[140:143]
    ds_read_b128 v[92:95], v9 offset:34816
    v_mfma_f32_16x16x32_bf16 v[144:147], v[48:51], v[64:67], v[144:147]
    ds_read_b128 v[96:99], v9 offset:36864
    buffer_load_dwordx4 v4, s[16:19], s57 offen offset:0 lds
    v_mfma_f32_16x16x32_bf16 v[148:151], v[48:51], v[68:71], v[148:151]
    ds_read_b128 v[100:103], v9 offset:38912
    v_mfma_f32_16x16x32_bf16 v[152:155], v[52:55], v[56:59], v[152:155]
    buffer_load_dwordx4 v5, s[16:19], s57 offen offset:1024 lds
    v_mfma_f32_16x16x32_bf16 v[156:159], v[52:55], v[60:63], v[156:159]
    v_mfma_f32_16x16x32_bf16 v[160:163], v[52:55], v[64:67], v[160:163]
    s_add_u32 s57, s57, 0x20000
    v_mfma_f32_16x16x32_bf16 v[164:167], v[52:55], v[68:71], v[164:167]
    s_waitcnt lgkmcnt(0)
    s_waitcnt vmcnt(8)
    s_barrier
    v_mfma_f32_16x16x32_bf16 v[104:107], v[72:75], v[88:91], v[104:107]
    ds_read_b64_tr_b16 v[40:41], v10 offset:0
    s_add_u32 m0, s58, 0x18000
    v_mfma_f32_16x16x32_bf16 v[108:111], v[72:75], v[92:95], v[108:111]
    ds_read_b64_tr_b16 v[42:43], v10 offset:1024
    v_mfma_f32_16x16x32_bf16 v[112:115], v[72:75], v[96:99], v[112:115]
    ds_read_b64_tr_b16 v[44:45], v11 offset:0
    buffer_load_dwordx4 v2, s[12:15], s56 offen offset:0 sc1 lds
    v_mfma_f32_16x16x32_bf16 v[116:119], v[72:75], v[100:103], v[116:119]
    ds_read_b64_tr_b16 v[46:47], v11 offset:1024
    v_mfma_f32_16x16x32_bf16 v[120:123], v[76:79], v[88:91], v[120:123]
    ds_read_b64_tr_b16 v[48:49], v12 offset:0
    buffer_load_dwordx4 v3, s[12:15], s56 offen offset:1024 sc1 lds
    v_mfma_f32_16x16x32_bf16 v[124:127], v[76:79], v[92:95], v[124:127]
    ds_read_b64_tr_b16 v[50:51], v12 offset:1024
    v_mfma_f32_16x16x32_bf16 v[128:131], v[76:79], v[96:99], v[128:131]
    ds_read_b64_tr_b16 v[52:53], v13 offset:0
    s_add_u32 s56, s56, 128
    v_mfma_f32_16x16x32_bf16 v[132:135], v[76:79], v[100:103], v[132:135]
    ds_read_b64_tr_b16 v[54:55], v13 offset:1024
    v_mfma_f32_16x16x32_bf16 v[136:139], v[80:83], v[88:91], v[136:139]
    ds_read_b128 v[56:59], v8 offset:0
    s_add_u32 m0, s58, 0x1c000
    v_mfma_f32_16x16x32_bf16 v[140:143], v[80:83], v[92:95], v[140:143]
    ds_read_b128 v[60:63], v8 offset:2048
    v_mfma_f32_16x16x32_bf16 v[144:147], v[80:83], v[96:99], v[144:147]
    ds_read_b128 v[64:67], v8 offset:4096
    buffer_load_dwordx4 v4, s[16:19], s57 offen offset:0 lds
    v_mfma_f32_16x16x32_bf16 v[148:151], v[80:83], v[100:103], v[148:151]
    ds_read_b128 v[68:71], v8 offset:6144
    v_mfma_f32_16x16x32_bf16 v[152:155], v[84:87], v[88:91], v[152:155]
    buffer_load_dwordx4 v5, s[16:19], s57 offen offset:1024 lds
    v_mfma_f32_16x16x32_bf16 v[156:159], v[84:87], v[92:95], v[156:159]
    v_mfma_f32_16x16x32_bf16 v[160:163], v[84:87], v[96:99], v[160:163]
    s_add_u32 s57, s57, 0x20000
    v_mfma_f32_16x16x32_bf16 v[164:167], v[84:87], v[100:103], v[164:167]
    s_waitcnt lgkmcnt(0)
    s_waitcnt vmcnt(8)
    s_barrier
    v_mfma_f32_16x16x32_bf16 v[104:107], v[40:43], v[56:59], v[104:107]
    ds_read_b64_tr_b16 v[72:73], v10 offset:32768
    v_mfma_f32_16x16x32_bf16 v[108:111], v[40:43], v[60:63], v[108:111]
    ds_read_b64_tr_b16 v[74:75], v10 offset:33792
    v_mfma_f32_16x16x32_bf16 v[112:115], v[40:43], v[64:67], v[112:115]
    ds_read_b64_tr_b16 v[76:77], v11 offset:32768
    v_mfma_f32_16x16x32_bf16 v[116:119], v[40:43], v[68:71], v[116:119]
    ds_read_b64_tr_b16 v[78:79], v11 offset:33792
    v_mfma_f32_16x16x32_bf16 v[120:123], v[44:47], v[56:59], v[120:123]
    ds_read_b64_tr_b16 v[80:81], v12 offset:32768
    v_mfma_f32_16x16x32_bf16 v[124:127], v[44:47], v[60:63], v[124:127]
    ds_read_b64_tr_b16 v[82:83], v12 offset:33792
    v_mfma_f32_16x16x32_bf16 v[128:131], v[44:47], v[64:67], v[128:131]
    ds_read_b64_tr_b16 v[84:85], v13 offset:32768
    v_mfma_f32_16x16x32_bf16 v[132:135], v[44:47], v[68:71], v[132:135]
    ds_read_b64_tr_b16 v[86:87], v13 offset:33792
    v_mfma_f32_16x16x32_bf16 v[136:139], v[48:51], v[56:59], v[136:139]
    ds_read_b128 v[88:91], v8 offset:32768
    v_mfma_f32_16x16x32_bf16 v[140:143], v[48:51], v[60:63], v[140:143]
    ds_read_b128 v[92:95], v8 offset:34816
    v_mfma_f32_16x16x32_bf16 v[144:147], v[48:51], v[64:67], v[144:147]
    ds_read_b128 v[96:99], v8 offset:36864
    v_mfma_f32_16x16x32_bf16 v[148:151], v[48:51], v[68:71], v[148:151]
    ds_read_b128 v[100:103], v8 offset:38912
    v_mfma_f32_16x16x32_bf16 v[152:155], v[52:55], v[56:59], v[152:155]
    v_mfma_f32_16x16x32_bf16 v[156:159], v[52:55], v[60:63], v[156:159]
    v_mfma_f32_16x16x32_bf16 v[160:163], v[52:55], v[64:67], v[160:163]
    v_mfma_f32_16x16x32_bf16 v[164:167], v[52:55], v[68:71], v[164:167]
    s_waitcnt lgkmcnt(0)
    s_waitcnt vmcnt(4)
    s_barrier
    v_mfma_f32_16x16x32_bf16 v[104:107], v[72:75], v[88:91], v[104:107]
    ds_read_b64_tr_b16 v[40:41], v14 offset:0
    v_mfma_f32_16x16x32_bf16 v[108:111], v[72:75], v[92:95], v[108:111]
    ds_read_b64_tr_b16 v[42:43], v14 offset:1024
    v_mfma_f32_16x16x32_bf16 v[112:115], v[72:75], v[96:99], v[112:115]
    ds_read_b64_tr_b16 v[44:45], v15 offset:0
    v_mfma_f32_16x16x32_bf16 v[116:119], v[72:75], v[100:103], v[116:119]
    ds_read_b64_tr_b16 v[46:47], v15 offset:1024
    v_mfma_f32_16x16x32_bf16 v[120:123], v[76:79], v[88:91], v[120:123]
    ds_read_b64_tr_b16 v[48:49], v16 offset:0
    v_mfma_f32_16x16x32_bf16 v[124:127], v[76:79], v[92:95], v[124:127]
    ds_read_b64_tr_b16 v[50:51], v16 offset:1024
    v_mfma_f32_16x16x32_bf16 v[128:131], v[76:79], v[96:99], v[128:131]
    ds_read_b64_tr_b16 v[52:53], v17 offset:0
    v_mfma_f32_16x16x32_bf16 v[132:135], v[76:79], v[100:103], v[132:135]
    ds_read_b64_tr_b16 v[54:55], v17 offset:1024
    v_mfma_f32_16x16x32_bf16 v[136:139], v[80:83], v[88:91], v[136:139]
    ds_read_b128 v[56:59], v9 offset:0
    v_mfma_f32_16x16x32_bf16 v[140:143], v[80:83], v[92:95], v[140:143]
    ds_read_b128 v[60:63], v9 offset:2048
    v_mfma_f32_16x16x32_bf16 v[144:147], v[80:83], v[96:99], v[144:147]
    ds_read_b128 v[64:67], v9 offset:4096
    v_mfma_f32_16x16x32_bf16 v[148:151], v[80:83], v[100:103], v[148:151]
    ds_read_b128 v[68:71], v9 offset:6144
    v_mfma_f32_16x16x32_bf16 v[152:155], v[84:87], v[88:91], v[152:155]
    v_mfma_f32_16x16x32_bf16 v[156:159], v[84:87], v[92:95], v[156:159]
    v_mfma_f32_16x16x32_bf16 v[160:163], v[84:87], v[96:99], v[160:163]
    v_mfma_f32_16x16x32_bf16 v[164:167], v[84:87], v[100:103], v[164:167]
    s_waitcnt lgkmcnt(0)
    s_waitcnt vmcnt(0)
    s_barrier
    v_mfma_f32_16x16x32_bf16 v[104:107], v[40:43], v[56:59], v[104:107]
    ds_read_b64_tr_b16 v[72:73], v14 offset:32768
    v_mfma_f32_16x16x32_bf16 v[108:111], v[40:43], v[60:63], v[108:111]
    ds_read_b64_tr_b16 v[74:75], v14 offset:33792
    v_mfma_f32_16x16x32_bf16 v[112:115], v[40:43], v[64:67], v[112:115]
    ds_read_b64_tr_b16 v[76:77], v15 offset:32768
    v_mfma_f32_16x16x32_bf16 v[116:119], v[40:43], v[68:71], v[116:119]
    ds_read_b64_tr_b16 v[78:79], v15 offset:33792
    v_mfma_f32_16x16x32_bf16 v[120:123], v[44:47], v[56:59], v[120:123]
    ds_read_b64_tr_b16 v[80:81], v16 offset:32768
    v_mfma_f32_16x16x32_bf16 v[124:127], v[44:47], v[60:63], v[124:127]
    ds_read_b64_tr_b16 v[82:83], v16 offset:33792
    v_mfma_f32_16x16x32_bf16 v[128:131], v[44:47], v[64:67], v[128:131]
    ds_read_b64_tr_b16 v[84:85], v17 offset:32768
    v_mfma_f32_16x16x32_bf16 v[132:135], v[44:47], v[68:71], v[132:135]
    ds_read_b64_tr_b16 v[86:87], v17 offset:33792
    v_mfma_f32_16x16x32_bf16 v[136:139], v[48:51], v[56:59], v[136:139]
    ds_read_b128 v[88:91], v9 offset:32768
    v_mfma_f32_16x16x32_bf16 v[140:143], v[48:51], v[60:63], v[140:143]
    ds_read_b128 v[92:95], v9 offset:34816
    v_mfma_f32_16x16x32_bf16 v[144:147], v[48:51], v[64:67], v[144:147]
    ds_read_b128 v[96:99], v9 offset:36864
    v_mfma_f32_16x16x32_bf16 v[148:151], v[48:51], v[68:71], v[148:151]
    ds_read_b128 v[100:103], v9 offset:38912
    v_mfma_f32_16x16x32_bf16 v[152:155], v[52:55], v[56:59], v[152:155]
    v_mfma_f32_16x16x32_bf16 v[156:159], v[52:55], v[60:63], v[156:159]
    v_mfma_f32_16x16x32_bf16 v[160:163], v[52:55], v[64:67], v[160:163]
    v_mfma_f32_16x16x32_bf16 v[164:167], v[52:55], v[68:71], v[164:167]
    s_waitcnt lgkmcnt(0)
    s_lshl_b32 s42, s96, 13
    v_lshlrev_b32 v23, 4, v0
    v_add_u32 v20, s42, v23
    s_xor_b32 s43, s96, 4
    s_lshl_b32 s43, s43, 13
    v_add_u32 v21, s43, v23
    s_lshl_b32 s42, s2, 3
    s_add_u32 s42, s42, s96
    s_lshl_b32 s45, s42, 2
    s_add_u32 s45, s45, 4352
    s_lshl_b32 s42, s42, 12
    s_xor_b32 s43, s2, 4
    s_lshl_b32 s44, s43, 3
    s_add_u32 s44, s44, s96
    s_lshl_b32 s46, s44, 2
    s_add_u32 s46, s46, 4352
    s_lshl_b32 s44, s44, 12
    s_lshr_b32 s47, s96, 2
    v_mfma_f32_16x16x32_bf16 v[136:139], v[80:83], v[88:91], v[136:139]
    v_mfma_f32_16x16x32_bf16 v[140:143], v[80:83], v[92:95], v[140:143]
    v_mfma_f32_16x16x32_bf16 v[144:147], v[80:83], v[96:99], v[144:147]
    v_mfma_f32_16x16x32_bf16 v[148:151], v[80:83], v[100:103], v[148:151]
    v_mfma_f32_16x16x32_bf16 v[152:155], v[84:87], v[88:91], v[152:155]
    v_mfma_f32_16x16x32_bf16 v[156:159], v[84:87], v[92:95], v[156:159]
    v_mfma_f32_16x16x32_bf16 v[160:163], v[84:87], v[96:99], v[160:163]
    v_mfma_f32_16x16x32_bf16 v[164:167], v[84:87], v[100:103], v[164:167]
    ds_read_b64_tr_b16 v[232:233], v19 offset:0
    ds_read_b64_tr_b16 v[234:235], v19 offset:32
    ds_read_b64_tr_b16 v[236:237], v19 offset:64
    ds_read_b64_tr_b16 v[238:239], v19 offset:96
    s_nop 3
    s_cmp_eq_u32 s47, 0
    s_cbranch_scc0 TAIL_16_1
    v_mfma_f32_16x16x32_bf16 v[104:107], v[72:75], v[88:91], v[104:107]
    v_mfma_f32_16x16x32_bf16 v[108:111], v[72:75], v[92:95], v[108:111]
    v_mfma_f32_16x16x32_bf16 v[112:115], v[72:75], v[96:99], v[112:115]
    v_mfma_f32_16x16x32_bf16 v[116:119], v[72:75], v[100:103], v[116:119]
    v_mfma_f32_16x16x32_bf16 v[120:123], v[76:79], v[88:91], v[120:123]
    ds_write_b128 v20, v[152:155] offset:4096
    v_mfma_f32_16x16x32_bf16 v[124:127], v[76:79], v[92:95], v[124:127]
    ds_write_b128 v20, v[156:159] offset:5120
    v_mfma_f32_16x16x32_bf16 v[128:131], v[76:79], v[96:99], v[128:131]
    ds_write_b128 v20, v[160:163] offset:6144
    v_mfma_f32_16x16x32_bf16 v[132:135], v[76:79], v[100:103], v[132:135]
    ds_write_b128 v20, v[164:167] offset:7168
    s_waitcnt lgkmcnt(0)
    s_barrier
    ds_read_b128 v[200:203], v21 offset:4096
    ds_read_b128 v[204:207], v21 offset:5120
    ds_read_b128 v[208:211], v21 offset:6144
    ds_read_b128 v[212:215], v21 offset:7168
    s_nop 4
    ds_write_b128 v20, v[120:123] offset:0
    ds_write_b128 v20, v[124:127] offset:1024
    ds_write_b128 v20, v[128:131] offset:2048
    ds_write_b128 v20, v[132:135] offset:3072
    s_waitcnt lgkmcnt(7)
    v_pk_add_f32 v[200:201], v[136:137], v[200:201]
    v_pk_add_f32 v[202:203], v[138:139], v[202:203]
    v_cvt_pk_bf16_f32 v184, v200, v201
    v_cvt_pk_bf16_f32 v185, v202, v203
    s_waitcnt lgkmcnt(6)
    v_pk_add_f32 v[204:205], v[140:141], v[204:205]
    v_pk_add_f32 v[206:207], v[142:143], v[206:207]
    v_cvt_pk_bf16_f32 v186, v204, v205
    v_cvt_pk_bf16_f32 v187, v206, v207
    buffer_store_dwordx4 v[184:187], v23, s[32:35], s42 offen offset:0 sc1
    s_waitcnt lgkmcnt(5)
    v_pk_add_f32 v[208:209], v[144:145], v[208:209]
    v_pk_add_f32 v[210:211], v[146:147], v[210:211]
    v_cvt_pk_bf16_f32 v188, v208, v209
    v_cvt_pk_bf16_f32 v189, v210, v211
    s_waitcnt lgkmcnt(4)
    v_pk_add_f32 v[212:213], v[148:149], v[212:213]
    v_pk_add_f32 v[214:215], v[150:151], v[214:215]
    v_cvt_pk_bf16_f32 v190, v212, v213
    v_cvt_pk_bf16_f32 v191, v214, v215
    buffer_store_dwordx4 v[188:191], v23, s[32:35], s42 offen offset:1024 sc1
    s_waitcnt lgkmcnt(0)
    s_barrier
    ds_read_b128 v[216:219], v21 offset:0
    ds_read_b128 v[220:223], v21 offset:1024
    ds_read_b128 v[224:227], v21 offset:2048
    ds_read_b128 v[228:231], v21 offset:3072
    s_waitcnt lgkmcnt(3)
    v_pk_add_f32 v[168:169], v[104:105], v[216:217]
    v_pk_add_f32 v[170:171], v[106:107], v[218:219]
    s_waitcnt lgkmcnt(2)
    v_pk_add_f32 v[172:173], v[108:109], v[220:221]
    v_pk_add_f32 v[174:175], v[110:111], v[222:223]
    s_waitcnt lgkmcnt(1)
    v_pk_add_f32 v[176:177], v[112:113], v[224:225]
    v_pk_add_f32 v[178:179], v[114:115], v[226:227]
    s_waitcnt lgkmcnt(0)
    v_pk_add_f32 v[180:181], v[116:117], v[228:229]
    v_pk_add_f32 v[182:183], v[118:119], v[230:231]
    s_branch TAIL_16_J
TAIL_16_1:
    v_mfma_f32_16x16x32_bf16 v[104:107], v[72:75], v[88:91], v[104:107]
    v_mfma_f32_16x16x32_bf16 v[108:111], v[72:75], v[92:95], v[108:111]
    ds_write_b128 v20, v[136:139] offset:4096
    v_mfma_f32_16x16x32_bf16 v[112:115], v[72:75], v[96:99], v[112:115]
    ds_write_b128 v20, v[140:143] offset:5120
    v_mfma_f32_16x16x32_bf16 v[116:119], v[72:75], v[100:103], v[116:119]
    ds_write_b128 v20, v[144:147] offset:6144
    v_mfma_f32_16x16x32_bf16 v[120:123], v[76:79], v[88:91], v[120:123]
    ds_write_b128 v20, v[148:151] offset:7168
    v_mfma_f32_16x16x32_bf16 v[124:127], v[76:79], v[92:95], v[124:127]
    v_mfma_f32_16x16x32_bf16 v[128:131], v[76:79], v[96:99], v[128:131]
    v_mfma_f32_16x16x32_bf16 v[132:135], v[76:79], v[100:103], v[132:135]
    s_waitcnt lgkmcnt(0)
    s_barrier
    ds_read_b128 v[200:203], v21 offset:4096
    ds_read_b128 v[204:207], v21 offset:5120
    ds_read_b128 v[208:211], v21 offset:6144
    ds_read_b128 v[212:215], v21 offset:7168
    s_nop 4
    ds_write_b128 v20, v[104:107] offset:0
    ds_write_b128 v20, v[108:111] offset:1024
    ds_write_b128 v20, v[112:115] offset:2048
    ds_write_b128 v20, v[116:119] offset:3072
    s_waitcnt lgkmcnt(7)
    v_pk_add_f32 v[200:201], v[152:153], v[200:201]
    v_pk_add_f32 v[202:203], v[154:155], v[202:203]
    v_cvt_pk_bf16_f32 v184, v200, v201
    v_cvt_pk_bf16_f32 v185, v202, v203
    s_waitcnt lgkmcnt(6)
    v_pk_add_f32 v[204:205], v[156:157], v[204:205]
    v_pk_add_f32 v[206:207], v[158:159], v[206:207]
    v_cvt_pk_bf16_f32 v186, v204, v205
    v_cvt_pk_bf16_f32 v187, v206, v207
    buffer_store_dwordx4 v[184:187], v23, s[32:35], s42 offen offset:0 sc1
    s_waitcnt lgkmcnt(5)
    v_pk_add_f32 v[208:209], v[160:161], v[208:209]
    v_pk_add_f32 v[210:211], v[162:163], v[210:211]
    v_cvt_pk_bf16_f32 v188, v208, v209
    v_cvt_pk_bf16_f32 v189, v210, v211
    s_waitcnt lgkmcnt(4)
    v_pk_add_f32 v[212:213], v[164:165], v[212:213]
    v_pk_add_f32 v[214:215], v[166:167], v[214:215]
    v_cvt_pk_bf16_f32 v190, v212, v213
    v_cvt_pk_bf16_f32 v191, v214, v215
    buffer_store_dwordx4 v[188:191], v23, s[32:35], s42 offen offset:1024 sc1
    s_waitcnt lgkmcnt(0)
    s_barrier
    ds_read_b128 v[216:219], v21 offset:0
    ds_read_b128 v[220:223], v21 offset:1024
    ds_read_b128 v[224:227], v21 offset:2048
    ds_read_b128 v[228:231], v21 offset:3072
    s_waitcnt lgkmcnt(3)
    v_pk_add_f32 v[168:169], v[120:121], v[216:217]
    v_pk_add_f32 v[170:171], v[122:123], v[218:219]
    s_waitcnt lgkmcnt(2)
    v_pk_add_f32 v[172:173], v[124:125], v[220:221]
    v_pk_add_f32 v[174:175], v[126:127], v[222:223]
    s_waitcnt lgkmcnt(1)
    v_pk_add_f32 v[176:177], v[128:129], v[224:225]
    v_pk_add_f32 v[178:179], v[130:131], v[226:227]
    s_waitcnt lgkmcnt(0)
    v_pk_add_f32 v[180:181], v[132:133], v[228:229]
    v_pk_add_f32 v[182:183], v[134:135], v[230:231]
TAIL_16_J:
    s_waitcnt vmcnt(0)
    v_mov_b32 v28, s97
    v_mov_b32 v29, s45
    s_mov_b64 exec, 1
    buffer_store_dword v28, v29, s[80:83], 0 offen sc0 sc1
    s_mov_b64 exec, -1
    s_mov_b32 s45, 0xffff0000
    v_lshlrev_b32 v184, 16, v232
    v_and_b32 v185, s45, v232
    v_lshlrev_b32 v186, 16, v233
    v_and_b32 v187, s45, v233
    v_lshlrev_b32 v188, 16, v234
    v_and_b32 v189, s45, v234
    v_lshlrev_b32 v190, 16, v235
    v_and_b32 v191, s45, v235
    v_lshlrev_b32 v192, 16, v236
    v_and_b32 v193, s45, v236
    v_lshlrev_b32 v194, 16, v237
    v_and_b32 v195, s45, v237
    v_lshlrev_b32 v196, 16, v238
    v_and_b32 v197, s45, v238
    v_lshlrev_b32 v198, 16, v239
    v_and_b32 v199, s45, v239
    v_lshlrev_b32 v200, 16, v32
    v_and_b32 v201, s45, v32
    v_lshlrev_b32 v202, 16, v33
    v_and_b32 v203, s45, v33
    v_lshlrev_b32 v204, 16, v34
    v_and_b32 v205, s45, v34
    v_lshlrev_b32 v206, 16, v35
    v_and_b32 v207, s45, v35
    v_lshlrev_b32 v208, 16, v36
    v_and_b32 v209, s45, v36
    v_lshlrev_b32 v210, 16, v37
    v_and_b32 v211, s45, v37
    v_lshlrev_b32 v212, 16, v38
    v_and_b32 v213, s45, v38
    v_lshlrev_b32 v214, 16, v39
    v_and_b32 v215, s45, v39
    s_mov_b64 exec, 1
    v_mov_b32 v29, s46
    s_mov_b32 s48, 0x40000
XP_17:
    buffer_load_dword v28, v29, s[80:83], 0 offen sc0 sc1
    s_waitcnt vmcnt(0)
    v_cmp_ne_u32 vcc, s97, v28
    s_nop 4
    s_cbranch_vccz XP_17_OK
    s_sub_u32 s48, s48, 1
    s_cmp_lg_u32 s48, 0
    s_cbranch_scc1 XP_17
XP_17_OK:
    s_mov_b64 exec, -1
    buffer_load_dwordx4 v[136:139], v23, s[32:35], s44 offen offset:0 sc1
    buffer_load_dwordx4 v[140:143], v23, s[32:35], s44 offen offset:1024 sc1
    s_mov_b32 s40, 0xbfb8aa3b
    s_mov_b32 s41, 0xbfb8aa3b
    s_mov_b32 s42, 1.0
    s_mov_b32 s43, 1.0
    s_mov_b32 s45, 0xffff0000
    s_mov_b32 s44, 0
    s_waitcnt vmcnt(0) lgkmcnt(0)
    v_lshlrev_b32 v120, 16, v136
    v_and_b32 v121, s45, v136
    v_lshlrev_b32 v122, 16, v137
    v_and_b32 v123, s45, v137
    v_lshlrev_b32 v124, 16, v138
    v_and_b32 v125, s45, v138
    v_lshlrev_b32 v126, 16, v139
    v_and_b32 v127, s45, v139
    v_lshlrev_b32 v128, 16, v140
    v_and_b32 v129, s45, v140
    v_lshlrev_b32 v130, 16, v141
    v_and_b32 v131, s45, v141
    v_lshlrev_b32 v132, 16, v142
    v_and_b32 v133, s45, v142
    v_lshlrev_b32 v134, 16, v143
    v_and_b32 v135, s45, v143
    v_pk_add_f32 v[104:105], v[168:169], v[120:121]
    v_pk_add_f32 v[106:107], v[170:171], v[122:123]
    v_pk_add_f32 v[108:109], v[172:173], v[124:125]
    v_pk_add_f32 v[110:111], v[174:175], v[126:127]
    v_pk_add_f32 v[112:113], v[176:177], v[128:129]
    v_pk_add_f32 v[114:115], v[178:179], v[130:131]
    v_pk_add_f32 v[116:117], v[180:181], v[132:133]
    v_pk_add_f32 v[118:119], v[182:183], v[134:135]
    v_cvt_pk_bf16_f32 v168, v104, v105
    v_cvt_pk_bf16_f32 v169, v106, v107
    v_cvt_pk_bf16_f32 v170, v108, v109
    v_cvt_pk_bf16_f32 v171, v110, v111
    v_cvt_pk_bf16_f32 v172, v112, v113
    v_cvt_pk_bf16_f32 v173, v114, v115
    v_cvt_pk_bf16_f32 v174, v116, v117
    v_cvt_pk_bf16_f32 v175, v118, v119
    v_lshlrev_b32 v104, 16, v168
    v_and_b32 v105, s45, v168
    v_lshlrev_b32 v106, 16, v169
    v_and_b32 v107, s45, v169
    v_lshlrev_b32 v108, 16, v170
    v_and_b32 v109, s45, v170
    v_lshlrev_b32 v110, 16, v171
    v_and_b32 v111, s45, v171
    v_lshlrev_b32 v112, 16, v172
    v_and_b32 v113, s45, v172
    v_lshlrev_b32 v114, 16, v173
    v_and_b32 v115, s45, v173
    v_lshlrev_b32 v116, 16, v174
    v_and_b32 v117, s45, v174
    v_lshlrev_b32 v118, 16, v175
    v_and_b32 v119, s45, v175
    v_pk_mul_f32 v[168:169], v[104:105], s[40:41]
    v_pk_mul_f32 v[170:171], v[106:107], s[40:41]
    v_pk_mul_f32 v[172:173], v[108:109], s[40:41]
    v_pk_mul_f32 v[174:175], v[110:111], s[40:41]
    v_pk_mul_f32 v[176:177], v[112:113], s[40:41]
    v_pk_mul_f32 v[178:179], v[114:115], s[40:41]
    v_pk_mul_f32 v[180:181], v[116:117], s[40:41]
    v_pk_mul_f32 v[182:183], v[118:119], s[40:41]
    v_exp_f32 v168, v168
    v_exp_f32 v169, v169
    v_exp_f32 v170, v170
    v_exp_f32 v171, v171
    v_exp_f32 v172, v172
    v_exp_f32 v173, v173
    v_exp_f32 v174, v174
    v_exp_f32 v175, v175
    v_exp_f32 v176, v176
    v_exp_f32 v177, v177
    v_exp_f32 v178, v178
    v_exp_f32 v179, v179
    v_exp_f32 v180, v180
    v_exp_f32 v181, v181
    v_exp_f32 v182, v182
    v_exp_f32 v183, v183
    v_pk_add_f32 v[168:169], v[168:169], s[42:43]
    v_pk_add_f32 v[170:171], v[170:171], s[42:43]
    v_pk_add_f32 v[172:173], v[172:173], s[42:43]
    v_pk_add_f32 v[174:175], v[174:175], s[42:43]
    v_pk_add_f32 v[176:177], v[176:177], s[42:43]
    v_pk_add_f32 v[178:179], v[178:179], s[42:43]
    v_pk_add_f32 v[180:181], v[180:181], s[42:43]
    v_pk_add_f32 v[182:183], v[182:183], s[42:43]
    v_rcp_f32 v168, v168
    v_rcp_f32 v169, v169
    v_rcp_f32 v170, v170
    v_rcp_f32 v171, v171
    v_rcp_f32 v172, v172
    v_rcp_f32 v173, v173
    v_rcp_f32 v174, v174
    v_rcp_f32 v175, v175
    v_rcp_f32 v176, v176
    v_rcp_f32 v177, v177
    v_rcp_f32 v178, v178
    v_rcp_f32 v179, v179
    v_rcp_f32 v180, v180
    v_rcp_f32 v181, v181
    v_rcp_f32 v182, v182
    v_rcp_f32 v183, v183
    v_pk_mul_f32 v[104:105], v[104:105], v[184:185]
    v_pk_mul_f32 v[106:107], v[106:107], v[186:187]
    v_pk_mul_f32 v[108:109], v[108:109], v[188:189]
    v_pk_mul_f32 v[110:111], v[110:111], v[190:191]
    v_pk_mul_f32 v[112:113], v[112:113], v[192:193]
    v_pk_mul_f32 v[114:115], v[114:115], v[194:195]
    v_pk_mul_f32 v[116:117], v[116:117], v[196:197]
    v_pk_mul_f32 v[118:119], v[118:119], v[198:199]
    v_pk_mul_f32 v[104:105], v[104:105], v[168:169]
    v_pk_mul_f32 v[106:107], v[106:107], v[170:171]
    v_pk_mul_f32 v[108:109], v[108:109], v[172:173]
    v_pk_mul_f32 v[110:111], v[110:111], v[174:175]
    v_pk_mul_f32 v[112:113], v[112:113], v[176:177]
    v_pk_mul_f32 v[114:115], v[114:115], v[178:179]
    v_pk_mul_f32 v[116:117], v[116:117], v[180:181]
    v_pk_mul_f32 v[118:119], v[118:119], v[182:183]
    s_nop 1
    v_permlane16_swap_b32 v104, v108
    v_permlane16_swap_b32 v105, v109
    v_permlane16_swap_b32 v106, v110
    v_permlane16_swap_b32 v107, v111
    v_permlane16_swap_b32 v112, v116
    v_permlane16_swap_b32 v113, v117
    v_permlane16_swap_b32 v114, v118
    v_permlane16_swap_b32 v115, v119
    s_nop 1
    v_pk_add_f32 v[104:105], v[104:105], v[200:201]
    v_pk_add_f32 v[106:107], v[106:107], v[202:203]
    v_pk_add_f32 v[108:109], v[108:109], v[204:205]
    v_pk_add_f32 v[110:111], v[110:111], v[206:207]
    v_pk_add_f32 v[112:113], v[112:113], v[208:209]
    v_pk_add_f32 v[114:115], v[114:115], v[210:211]
    v_pk_add_f32 v[116:117], v[116:117], v[212:213]
    v_pk_add_f32 v[118:119], v[118:119], v[214:215]
    v_cvt_pk_bf16_f32 v216, v104, v105
    v_cvt_pk_bf16_f32 v217, v106, v107
    v_cvt_pk_bf16_f32 v218, v108, v109
    v_cvt_pk_bf16_f32 v219, v110, v111
    v_cvt_pk_bf16_f32 v220, v112, v113
    v_cvt_pk_bf16_f32 v221, v114, v115
    v_cvt_pk_bf16_f32 v222, v116, v117
    v_cvt_pk_bf16_f32 v223, v118, v119
    s_mov_b32 s42, 0x10000
    buffer_store_dwordx4 v[216:219], v18, s[28:31], 0 offen
    buffer_store_dwordx4 v[220:223], v18, s[28:31], s42 offen
EXIT:
    s_endpgm
.section .rodata,"a"
.p2align 6
.amdhsa_kernel recurrent_scan__spectral_fnet__swiglu_ffn__prompt_kernel
  .amdhsa_next_free_vgpr 256
  .amdhsa_next_free_sgpr 100
  .amdhsa_accum_offset 256
  .amdhsa_group_segment_fixed_size 0
  .amdhsa_kernarg_size 96
  .amdhsa_user_sgpr_count 2
  .amdhsa_user_sgpr_kernarg_segment_ptr 1
  .amdhsa_system_sgpr_workgroup_id_x 1
.end_amdhsa_kernel
```
